```python
import torch

def _softmax(x, axis=-1):
    return torch.softmax(x, dim=axis)

def _gelu(x):
    return torch.nn.functional.gelu(x, approximate='tanh')

def _silu(x):
    return torch.nn.functional.silu(x)

def _sigmoid(x):
    return torch.sigmoid(x)

def _layernorm(x, axis=-1, eps=1e-05):
    m = x.mean(dim=axis, keepdim=True)
    v = x.var(dim=axis, keepdim=True, unbiased=False)
    return (x - m) / torch.sqrt(v + eps)

def _scatter_add(tgt, idx, src, axis=0):
    return tgt.clone().index_add_(axis, idx, src)

def _segment_sum(src, seg, n):
    out = torch.zeros((n,) + src.shape[1:], dtype=src.dtype)
    return out.index_add_(0, seg, src)

def _pad(x, pw):
    flat = tuple((v for pair in reversed(pw) for v in pair))
    return torch.nn.functional.pad(x, flat)
kernel_name = 'adaLN_cond__sliding_local_dilated__glu_gated_reglu__prompt'

def setup_inputs():

    _w = lambda a: (lambda t: t.to(torch.bfloat16) if t.is_floating_point() else t)(torch.as_tensor(a))

    def _A_setup():
        B, S, D = (1, 2048, 512)
        return {'x': _w((lambda *s: torch.randn(*s, dtype=torch.bfloat16) * 0.05)(B, S, D)), 'wqkv': _w((lambda *s: torch.randn(*s, dtype=torch.bfloat16) * 0.05)(D, 3 * D)), 'wo': _w((lambda *s: torch.randn(*s, dtype=torch.bfloat16) * 0.05)(D, D))}
    _A_in = _A_setup()

    def _B_setup():
        B, S, D, F = (1, 2048, 512, 1792)
        return {'x': _w((lambda *s: torch.randn(*s, dtype=torch.bfloat16) * 0.05)(B, S, D)), 'W_gate': _w((lambda *s: torch.randn(*s, dtype=torch.bfloat16) * 0.8)(D, F) * (2.0 / D) ** 0.5), 'W_up': _w((lambda *s: torch.randn(*s, dtype=torch.bfloat16) * 0.8)(D, F) * (2.0 / D) ** 0.5), 'W_down': _w((lambda *s: torch.randn(*s, dtype=torch.bfloat16) * 0.8)(F, D) * (1.0 / F) ** 0.5)}
    _B_in = _B_setup()
    return {'A_x': _A_in['x'], 'A_wqkv': _A_in['wqkv'], 'A_wo': _A_in['wo'], 'B_x': _B_in['x'], 'B_W_gate': _B_in['W_gate'], 'B_W_up': _B_in['W_up'], 'B_W_down': _B_in['W_down'], 'c': _w((lambda *s: torch.randn(*s, dtype=torch.bfloat16) * 0.1)(1, 512) * 8.0), 'w_mod': _w((lambda *s: torch.randn(*s, dtype=torch.bfloat16) * 0.1)(512, 6 * 512) * 512 ** (-0.5) * 8.0)}

def reference(A_x, A_wqkv, A_wo, B_x, B_W_gate, B_W_up, B_W_down, c, w_mod):

    def _A_ref(x, wqkv, wo):
        B, S, D = x.shape
        H = 32
        Dh = D // H
        W, dil = (8, 2)
        qkv = (lambda x, *d: x.permute(*d))((x @ wqkv).reshape(B, S, 3, H, Dh), 2, 0, 3, 1, 4)
        q, k, v = (qkv[0], qkv[1], qkv[2])
        scale = Dh ** (-0.5)
        pos = torch.arange(S)
        off = torch.arange(W) * dil
        idx = pos[:, None] - off[None, :]
        mask = idx >= 0
        idx_c = torch.where(mask, idx, 0).reshape(-1)
        kg = k[:, :, idx_c, :].reshape(B, H, S, W, Dh)
        vg = v[:, :, idx_c, :].reshape(B, H, S, W, Dh)
        logits = torch.einsum('bhsd,bhswd->bhsw', q, kg) * scale
        logits = torch.where(mask[None, None, :, :], logits, -1000000000.0)
        attn = _softmax(logits, axis=-1)
        o = torch.einsum('bhsw,bhswd->bhsd', attn, vg)
        return (lambda x, *d: x.permute(*d))(o, 0, 2, 1, 3).reshape(B, S, D) @ wo

    def _B_ref(x, W_gate, W_up, W_down):
        gate = torch.einsum('bsd,df->bsf', x, W_gate)
        up = torch.einsum('bsd,df->bsf', x, W_up)
        gate = gate * (lambda x, dt: x.to(dt))(gate > 0, gate.dtype)
        h = gate * up
        return torch.einsum('bsf,fd->bsd', h, W_down)
    x = A_x
    mod = (_silu(c) @ w_mod).reshape(c.shape[0], 6, 1, -1)
    sa, ca, ga, sb, cb, gb = (mod[:, 0].clone(), mod[:, 1].clone(), mod[:, 2].clone(), mod[:, 3].clone(), mod[:, 4].clone(), mod[:, 5].clone())
    h = _layernorm(x, axis=-1) * (1 + ca) + sa
    x = x + ga * _A_ref(h, A_wqkv, A_wo)
    h = _layernorm(x, axis=-1) * (1 + cb) + sb
    x = x + gb * _B_ref(h, B_W_gate, B_W_up, B_W_down)
    return x
```

```asm
; @launch grid=(256,1,1) block=(512,1,1) lds=163840
.amdgcn_target "amdgcn-amd-amdhsa--gfx950"
.text
.globl adaLN_cond__sliding_local_dilated__glu_gated_reglu__prompt_kernel
.p2align 8
.type adaLN_cond__sliding_local_dilated__glu_gated_reglu__prompt_kernel,@function
adaLN_cond__sliding_local_dilated__glu_gated_reglu__prompt_kernel:
    s_cmp_ge_u32 s2, 256
    s_cbranch_scc1 END
    s_load_dwordx16 s[8:23], s[0:1], 0
    s_load_dwordx8 s[24:31], s[0:1], 64
    v_and_b32 v15, 63, v0
    v_lshrrev_b32 v1, 6, v0
    s_nop 0
    v_readfirstlane_b32 s3, v1
    s_and_b32 s4, s2, 7
    s_lshr_b32 s5, s2, 3
    s_lshr_b32 s7, s5, 4
    s_lshl1_add_u32 s72, s4, s7
    s_bfe_u32 s6, s5, 0x10003
    s_lshl_b32 s7, s6, 3
    s_and_b32 s79, s5, 7
    s_add_u32 s73, s7, s79
    s_and_b32 s74, s79, 1
    s_lshr_b32 s7, s79, 1
    s_lshl_b32 s75, s6, 2
    s_add_u32 s75, s75, s7
    s_mul_i32 s78, s6, 7
    s_add_u32 s78, s78, s79
    s_lshl_b32 s76, s72, 7
    s_lshl_b32 s7, s74, 6
    s_add_u32 s76, s76, s7
    s_and_b32 s89, s3, 3
    s_lshr_b32 s87, s89, 1
    s_and_b32 s88, s3, 1
    v_lshlrev_b32 v14, 4, v15
    s_lshl1_add_u32 s6, s72, s75
    s_add_u32 s6, s6, s4
    s_and_b32 s6, s6, 3
    s_lshl2_add_u32 s7, s72, s79
    s_add_u32 s7, s7, s4
    s_and_b32 s7, s7, 7
    s_cmp_lg_u32 s3, 7
    s_cbranch_scc1 NOTM
    s_setprio 3
    s_movk_i32 s80, 6144
    v_mul_u32_u24 v9, s80, v15
    v_lshlrev_b32 v8, 1, v15
    s_lshl_b32 s81, s4, 5
    s_add_u32 s81, s81, s5
    s_and_b32 s82, s81, 127
    s_lshl_b32 s90, s82, 4
    s_lshl_b32 s91, s81, 4
    s_add_u32 s91, s91, 2048
    s_lshl_b32 s92, s82, 7
    s_add_u32 s92, s92, 0xa0000
    s_lshl_b32 s93, s81, 7
    s_add_u32 s93, s93, 0xa4000
    s_cmp_ge_u32 s82, 64
    s_cselect_b32 s94, 1.0, 0
    s_lshr_b32 s81, s81, 6
    s_cmp_eq_u32 s81, 2
    s_cselect_b32 s101, 1.0, 0
    s_mov_b32 s85, 0xa0000
    s_add_u32 s40, s5, 0
    s_and_b32 s40, s40, 7
    s_lshl_b32 s48, s40, 7
    s_mul_i32 s40, s40, 393216
    s_add_u32 s40, s40, s90
    s_add_u32 s41, s5, 1
    s_and_b32 s41, s41, 7
    s_lshl_b32 s49, s41, 7
    s_mul_i32 s41, s41, 393216
    s_add_u32 s41, s41, s90
    s_add_u32 s42, s5, 2
    s_and_b32 s42, s42, 7
    s_lshl_b32 s50, s42, 7
    s_mul_i32 s42, s42, 393216
    s_add_u32 s42, s42, s90
    s_add_u32 s43, s5, 3
    s_and_b32 s43, s43, 7
    s_lshl_b32 s51, s43, 7
    s_mul_i32 s43, s43, 393216
    s_add_u32 s43, s43, s90
    s_add_u32 s44, s5, 4
    s_and_b32 s44, s44, 7
    s_lshl_b32 s52, s44, 7
    s_mul_i32 s44, s44, 393216
    s_add_u32 s44, s44, s90
    s_add_u32 s45, s5, 5
    s_and_b32 s45, s45, 7
    s_lshl_b32 s53, s45, 7
    s_mul_i32 s45, s45, 393216
    s_add_u32 s45, s45, s90
    s_add_u32 s46, s5, 6
    s_and_b32 s46, s46, 7
    s_lshl_b32 s54, s46, 7
    s_mul_i32 s46, s46, 393216
    s_add_u32 s46, s46, s90
    s_add_u32 s47, s5, 7
    s_and_b32 s47, s47, 7
    s_lshl_b32 s55, s47, 7
    s_mul_i32 s47, s47, 393216
    s_add_u32 s47, s47, s90
    s_waitcnt lgkmcnt(0)
    s_mov_b32 s56, s22
    s_and_b32 s57, s23, 0xffff
    s_mov_b32 s58, 0x400
    s_mov_b32 s59, 0x20000
    s_mov_b32 s60, s24
    s_and_b32 s61, s25, 0xffff
    s_mov_b32 s62, 0x300000
    s_mov_b32 s63, 0x20000
    buffer_load_ushort v20, v8, s[56:59], s48 offen
    buffer_load_ushort v21, v8, s[56:59], s49 offen
    buffer_load_ushort v22, v8, s[56:59], s50 offen
    buffer_load_ushort v23, v8, s[56:59], s51 offen
    buffer_load_ushort v24, v8, s[56:59], s52 offen
    buffer_load_ushort v25, v8, s[56:59], s53 offen
    buffer_load_ushort v26, v8, s[56:59], s54 offen
    buffer_load_ushort v27, v8, s[56:59], s55 offen
    buffer_load_dwordx4 v[80:83], v9, s[60:63], s40 offen
    buffer_load_dwordx4 v[84:87], v9, s[60:63], s41 offen
    buffer_load_dwordx4 v[88:91], v9, s[60:63], s42 offen
    buffer_load_dwordx4 v[92:95], v9, s[60:63], s43 offen
    buffer_load_dwordx4 v[96:99], v9, s[60:63], s44 offen
    buffer_load_dwordx4 v[100:103], v9, s[60:63], s45 offen
    buffer_load_dwordx4 v[104:107], v9, s[60:63], s46 offen
    buffer_load_dwordx4 v[108:111], v9, s[60:63], s47 offen
    s_mov_b32 s68, s30
    s_and_b32 s69, s31, 0xffff
    s_mov_b32 s70, 0xe00000
    s_mov_b32 s71, 0x20000
    buffer_load_dword v31, off, s[68:71], 0 sc1
    s_barrier
    s_branch MW0
NOTM:
    s_cmp_ge_u32 s3, 4
    s_cbranch_scc1 HELPER
    s_mul_i32 s80, s3, 20
    s_add_u32 s81, s80, s76
    s_sub_u32 s81, s81, 16
    v_lshrrev_b32 v11, 4, v15
    v_and_b32 v13, 15, v15
    v_add_u32 v12, s81, v11
    v_max_i32 v240, 0, v12
    v_lshlrev_b32 v240, 10, v240
    v_lshl_add_u32 v240, v13, 4, v240
    v_add_u32 v12, 4, v12
    v_max_i32 v241, 0, v12
    v_lshlrev_b32 v241, 10, v241
    v_lshl_add_u32 v241, v13, 4, v241
    v_add_u32 v12, 4, v12
    v_max_i32 v242, 0, v12
    v_lshlrev_b32 v242, 10, v242
    v_lshl_add_u32 v242, v13, 4, v242
    v_add_u32 v12, 4, v12
    v_max_i32 v243, 0, v12
    v_lshlrev_b32 v243, 10, v243
    v_lshl_add_u32 v243, v13, 4, v243
    v_add_u32 v12, 4, v12
    v_max_i32 v244, 0, v12
    v_lshlrev_b32 v244, 10, v244
    v_lshl_add_u32 v244, v13, 4, v244
    s_and_b32 s40, s6, 3
    s_lshl_b32 s40, s40, 8
    s_add_u32 s41, s6, 1
    s_and_b32 s41, s41, 3
    s_lshl_b32 s41, s41, 8
    s_add_u32 s42, s6, 2
    s_and_b32 s42, s42, 3
    s_lshl_b32 s42, s42, 8
    s_add_u32 s43, s6, 3
    s_and_b32 s43, s43, 3
    s_lshl_b32 s43, s43, 8
    s_lshl_b32 s80, s3, 8
    s_add_u32 s80, s80, 159744
    v_lshlrev_b32 v109, 2, v15
    v_add_u32 v109, s80, v109
    v_and_b32 v108, 3, v15
    v_mul_u32_u24 v108, 260, v108
    v_add_u32 v108, 159744, v108
    v_mov_b32 v0, 0
    ds_write_b32 v109, v0
    s_waitcnt lgkmcnt(0)
    s_mov_b32 s32, s8
    s_and_b32 s33, s9, 0xffff
    s_mov_b32 s34, 0x200000
    s_mov_b32 s35, 0x20000
    s_barrier
    buffer_load_dwordx4 v[164:167], v240, s[32:35], s40 offen
    buffer_load_dwordx4 v[28:31], v240, s[32:35], s41 offen
    buffer_load_dwordx4 v[124:127], v240, s[32:35], s42 offen
    buffer_load_dwordx4 v[76:79], v240, s[32:35], s43 offen
    buffer_load_dwordx4 v[172:175], v241, s[32:35], s40 offen
    buffer_load_dwordx4 v[36:39], v241, s[32:35], s41 offen
    buffer_load_dwordx4 v[132:135], v241, s[32:35], s42 offen
    buffer_load_dwordx4 v[84:87], v241, s[32:35], s43 offen
    buffer_load_dwordx4 v[180:183], v242, s[32:35], s40 offen
    buffer_load_dwordx4 v[44:47], v242, s[32:35], s41 offen
    buffer_load_dwordx4 v[140:143], v242, s[32:35], s42 offen
    buffer_load_dwordx4 v[92:95], v242, s[32:35], s43 offen
    buffer_load_dwordx4 v[188:191], v243, s[32:35], s40 offen
    buffer_load_dwordx4 v[52:55], v243, s[32:35], s41 offen
    buffer_load_dwordx4 v[148:151], v243, s[32:35], s42 offen
    buffer_load_dwordx4 v[100:103], v243, s[32:35], s43 offen
    buffer_load_dwordx4 v[20:23], v244, s[32:35], s40 offen
    buffer_load_dwordx4 v[60:63], v244, s[32:35], s41 offen
    buffer_load_dwordx4 v[156:159], v244, s[32:35], s42 offen
    buffer_load_dwordx4 v[116:119], v244, s[32:35], s43 offen
    s_branch CMAIN
MW0:
    s_nop 7
    s_nop 7
    s_mov_b32 s40, s12
    s_and_b32 s41, s13, 0xffff
    s_mov_b32 s42, 0x80000
    s_mov_b32 s43, 0x20000
    s_mov_b32 s44, s16
    s_and_b32 s45, s17, 0xffff
    s_mov_b32 s46, 0x1c0000
    s_mov_b32 s47, 0x20000
    s_mov_b32 s48, s18
    s_and_b32 s49, s19, 0xffff
    s_mov_b32 s50, 0x1c0000
    s_mov_b32 s51, 0x20000
    s_mov_b32 s52, s20
    s_and_b32 s53, s21, 0xffff
    s_mov_b32 s54, 0x1c0000
    s_mov_b32 s55, 0x20000
    s_lshl_b32 s80, s3, 8
    s_add_u32 s80, s80, 159744
    v_lshlrev_b32 v29, 2, v15
    v_add_u32 v29, s80, v29
    v_and_b32 v28, 3, v15
    v_mul_u32_u24 v28, 260, v28
    v_add_u32 v28, 159744, v28
    v_mov_b32 v12, 1
    s_waitcnt vmcnt(9)
    v_lshlrev_b32 v20, 16, v20
    v_lshlrev_b32 v21, 16, v21
    v_lshlrev_b32 v22, 16, v22
    v_lshlrev_b32 v23, 16, v23
    v_lshlrev_b32 v24, 16, v24
    v_lshlrev_b32 v25, 16, v25
    v_lshlrev_b32 v26, 16, v26
    v_lshlrev_b32 v27, 16, v27
    v_mul_f32 v120, 0xbfb8aa3b, v20
    v_mul_f32 v121, 0xbfb8aa3b, v21
    v_mul_f32 v122, 0xbfb8aa3b, v22
    v_mul_f32 v123, 0xbfb8aa3b, v23
    v_mul_f32 v124, 0xbfb8aa3b, v24
    v_mul_f32 v125, 0xbfb8aa3b, v25
    v_mul_f32 v126, 0xbfb8aa3b, v26
    v_mul_f32 v127, 0xbfb8aa3b, v27
    v_exp_f32 v120, v120
    v_exp_f32 v121, v121
    v_exp_f32 v122, v122
    v_exp_f32 v123, v123
    v_exp_f32 v124, v124
    v_exp_f32 v125, v125
    v_exp_f32 v126, v126
    v_exp_f32 v127, v127
    v_add_f32 v120, 1.0, v120
    v_add_f32 v121, 1.0, v121
    v_add_f32 v122, 1.0, v122
    v_add_f32 v123, 1.0, v123
    v_add_f32 v124, 1.0, v124
    v_add_f32 v125, 1.0, v125
    v_add_f32 v126, 1.0, v126
    v_add_f32 v127, 1.0, v127
    v_rcp_f32 v120, v120
    v_rcp_f32 v121, v121
    v_rcp_f32 v122, v122
    v_rcp_f32 v123, v123
    v_rcp_f32 v124, v124
    v_rcp_f32 v125, v125
    v_rcp_f32 v126, v126
    v_rcp_f32 v127, v127
    v_mul_f32 v20, v20, v120
    v_mul_f32 v21, v21, v121
    v_mul_f32 v22, v22, v122
    v_mul_f32 v23, v23, v123
    v_mul_f32 v24, v24, v124
    v_mul_f32 v25, v25, v125
    v_mul_f32 v26, v26, v126
    v_mul_f32 v27, v27, v127
    v_cvt_pk_bf16_f32 v16, v20, v21
    v_cvt_pk_bf16_f32 v17, v22, v23
    v_cvt_pk_bf16_f32 v18, v24, v25
    v_cvt_pk_bf16_f32 v19, v26, v27
    s_mov_b32 s81, 0x05040100
    s_mov_b32 s82, 0x07060302
    s_waitcnt vmcnt(7)
    v_perm_b32 v120, v84, v80, s81
    v_perm_b32 v121, v84, v80, s82
    v_perm_b32 v122, v85, v81, s81
    v_perm_b32 v123, v85, v81, s82
    v_perm_b32 v124, v86, v82, s81
    v_perm_b32 v125, v86, v82, s82
    v_perm_b32 v126, v87, v83, s81
    v_perm_b32 v127, v87, v83, s82
    v_dot2_f32_bf16 v112, v120, v16, 0
    v_dot2_f32_bf16 v113, v121, v16, 0
    v_dot2_f32_bf16 v114, v122, v16, 0
    v_dot2_f32_bf16 v115, v123, v16, 0
    v_dot2_f32_bf16 v116, v124, v16, 0
    v_dot2_f32_bf16 v117, v125, v16, 0
    v_dot2_f32_bf16 v118, v126, v16, 0
    v_dot2_f32_bf16 v119, v127, v16, 0
    s_waitcnt vmcnt(5)
    v_perm_b32 v120, v92, v88, s81
    v_perm_b32 v121, v92, v88, s82
    v_perm_b32 v122, v93, v89, s81
    v_perm_b32 v123, v93, v89, s82
    v_perm_b32 v124, v94, v90, s81
    v_perm_b32 v125, v94, v90, s82
    v_perm_b32 v126, v95, v91, s81
    v_perm_b32 v127, v95, v91, s82
    v_dot2_f32_bf16 v112, v120, v17, v112
    v_dot2_f32_bf16 v113, v121, v17, v113
    v_dot2_f32_bf16 v114, v122, v17, v114
    v_dot2_f32_bf16 v115, v123, v17, v115
    v_dot2_f32_bf16 v116, v124, v17, v116
    v_dot2_f32_bf16 v117, v125, v17, v117
    v_dot2_f32_bf16 v118, v126, v17, v118
    v_dot2_f32_bf16 v119, v127, v17, v119
    s_waitcnt vmcnt(3)
    v_perm_b32 v120, v100, v96, s81
    v_perm_b32 v121, v100, v96, s82
    v_perm_b32 v122, v101, v97, s81
    v_perm_b32 v123, v101, v97, s82
    v_perm_b32 v124, v102, v98, s81
    v_perm_b32 v125, v102, v98, s82
    v_perm_b32 v126, v103, v99, s81
    v_perm_b32 v127, v103, v99, s82
    v_dot2_f32_bf16 v112, v120, v18, v112
    v_dot2_f32_bf16 v113, v121, v18, v113
    v_dot2_f32_bf16 v114, v122, v18, v114
    v_dot2_f32_bf16 v115, v123, v18, v115
    v_dot2_f32_bf16 v116, v124, v18, v116
    v_dot2_f32_bf16 v117, v125, v18, v117
    v_dot2_f32_bf16 v118, v126, v18, v118
    v_dot2_f32_bf16 v119, v127, v18, v119
    s_waitcnt vmcnt(1)
    v_perm_b32 v120, v108, v104, s81
    v_perm_b32 v121, v108, v104, s82
    v_perm_b32 v122, v109, v105, s81
    v_perm_b32 v123, v109, v105, s82
    v_perm_b32 v124, v110, v106, s81
    v_perm_b32 v125, v110, v106, s82
    v_perm_b32 v126, v111, v107, s81
    v_perm_b32 v127, v111, v107, s82
    v_dot2_f32_bf16 v112, v120, v19, v112
    v_dot2_f32_bf16 v113, v121, v19, v113
    v_dot2_f32_bf16 v114, v122, v19, v114
    v_dot2_f32_bf16 v115, v123, v19, v115
    v_dot2_f32_bf16 v116, v124, v19, v116
    v_dot2_f32_bf16 v117, v125, v19, v117
    v_dot2_f32_bf16 v118, v126, v19, v118
    v_dot2_f32_bf16 v119, v127, v19, v119
    s_waitcnt vmcnt(0)
    v_readfirstlane_b32 s77, v31
    s_add_u32 s77, s77, 1
    v_permlane32_swap_b32 v112, v116
    v_permlane32_swap_b32 v113, v117
    v_permlane32_swap_b32 v114, v118
    v_permlane32_swap_b32 v115, v119
    v_add_f32 v112, v112, v116
    v_add_f32 v113, v113, v117
    v_add_f32 v114, v114, v118
    v_add_f32 v115, v115, v119
    s_nop 0
    v_permlane16_swap_b32 v112, v114
    v_permlane16_swap_b32 v113, v115
    v_add_f32 v112, v112, v114
    v_add_f32 v113, v113, v115
    s_nop 0
    v_add_f32_dpp v112, v112, v112 quad_perm:[1,0,3,2] row_mask:0xf bank_mask:0xf
    v_add_f32_dpp v113, v113, v113 quad_perm:[1,0,3,2] row_mask:0xf bank_mask:0xf
    s_nop 0
    v_add_f32_dpp v112, v112, v112 quad_perm:[2,3,0,1] row_mask:0xf bank_mask:0xf
    v_add_f32_dpp v113, v113, v113 quad_perm:[2,3,0,1] row_mask:0xf bank_mask:0xf
    s_nop 0
    v_add_f32_dpp v112, v112, v112 row_half_mirror row_mask:0xf bank_mask:0xf
    v_add_f32_dpp v113, v113, v113 row_half_mirror row_mask:0xf bank_mask:0xf
    s_nop 0
    v_add_f32_dpp v112, v112, v112 row_mirror row_mask:0xf bank_mask:0xf
    v_add_f32_dpp v113, v113, v113 row_mirror row_mask:0xf bank_mask:0xf
    v_cvt_pk_bf16_f32 v114, v112, v113
    v_lshlrev_b32 v112, 16, v114
    v_and_b32 v113, 0xffff0000, v114
    v_add_f32 v112, s94, v112
    v_add_f32 v113, s94, v113
    v_mov_b32 v115, s77
    v_cvt_pk_bf16_f32 v114, v112, v113
    v_lshrrev_b32 v120, 1, v15
    s_mov_b32 exec_lo, 0x00010001
    s_mov_b32 exec_hi, 0x00010001
    buffer_store_dwordx2 v[114:115], v120, s[68:71], s92 offen sc1
    s_mov_b64 exec, -1
    ds_write_b32 v28, v12 offset:2048
    s_and_b32 s64, s6, 3
    s_lshl_b32 s64, s64, 8
    s_add_u32 s65, s6, 1
    s_and_b32 s65, s65, 3
    s_lshl_b32 s65, s65, 8
    s_add_u32 s66, s6, 2
    s_and_b32 s66, s66, 3
    s_lshl_b32 s66, s66, 8
    s_add_u32 s67, s6, 3
    s_and_b32 s67, s67, 3
    s_lshl_b32 s67, s67, 8
    s_lshl_b32 s80, s6, 11
    v_lshrrev_b32 v48, 1, v15
    v_and_b32 v49, 1, v15
    v_lshlrev_b32 v48, 7, v48
    v_lshl_add_u32 v48, v49, 4, v48
    v_add_u32 v48, s80, v48
    v_add_u32 v49, 0x1000, v48
    v_and_b32 v48, 0x1fff, v48
    v_and_b32 v49, 0x1fff, v49
    v_add_u32 v50, 0x2000, v48
    v_add_u32 v51, 0x2000, v49
    v_mov_b32 v12, 162816
    v_mov_b32 v13, s77
    ds_write_b32 v12, v13
    v_lshrrev_b32 v0, 3, v15
    v_and_b32 v11, 7, v15
    v_and_b32 v5, 2, v0
    v_xor_b32 v4, v11, v5
    s_lshl_b32 s81, s88, 2
    v_xor_b32 v4, s81, v4
    v_lshlrev_b32 v5, 1, v5
    v_xor_b32 v5, v11, v5
    s_lshl_b32 s81, s89, 3
    v_add_u32 v1, s81, v0
    v_lshlrev_b32 v1, 10, v1
    v_lshl_add_u32 v1, v5, 4, v1
    s_lshl_b32 s81, s75, 7
    v_add_u32 v1, s81, v1
    s_lshl_b32 s81, s87, 3
    v_add_u32 v2, s81, v0
    s_movk_i32 s81, 3584
    v_mul_u32_u24 v2, s81, v2
    v_lshl_add_u32 v2, v4, 4, v2
    s_lshl_b32 s81, s78, 8
    s_lshr_b32 s83, s73, 3
    s_lshl_b32 s82, s72, 1
    s_add_u32 s83, s83, s82
    s_min_u32 s83, s83, 27
    s_lshl_b32 s83, s83, 7
    s_cmp_eq_u32 s79, 7
    s_cselect_b32 s81, s83, s81
    s_cselect_b32 s83, 0, 0x1c0000
    v_add_u32 v2, s81, v2
    s_lshl_b32 s84, s89, 10
    v_add_u32 v4, s84, v14
    v_add_u32 v5, 0x10000, v4
    s_bitcmp1_b32 s89, 0
    s_cselect_b32 s44, s48, s44
    s_cselect_b32 s45, s49, s45
    s_mov_b32 s48, s44
    s_mov_b32 s49, s45
    s_mov_b32 s50, s83
    s_lshl_b32 s100, s72, 14
    s_add_u32 s100, s100, 0x60000
    s_lshl_b32 s80, s73, 7
    s_add_u32 s95, s100, s80
    v_lshlrev_b32 v3, 7, v15
    v_lshlrev_b32 v13, 3, v15
    v_add_u32 v13, 155648, v13
    s_sleep 24
    v_mov_b32 v12, 2
    buffer_load_dwordx4 v[32:35], v48, s[68:71], s85 offen sc1
    buffer_load_dwordx4 v[36:39], v49, s[68:71], s85 offen sc1
    buffer_load_dwordx4 v[40:43], v50, s[68:71], s85 offen sc1
    buffer_load_dwordx4 v[44:47], v51, s[68:71], s85 offen sc1
    ds_write_b32 v28, v12 offset:2048
    s_waitcnt vmcnt(0)
    s_movk_i32 s86, 3000
    s_branch PCHK_adaLN_cond__sliding_local_dilated__glu_gated_reglu__prompt_kernel_3
POLL_adaLN_cond__sliding_local_dilated__glu_gated_reglu__prompt_kernel_1:
    buffer_load_dwordx4 v[32:35], v48, s[68:71], s85 offen sc1
    buffer_load_dwordx4 v[36:39], v49, s[68:71], s85 offen sc1
    buffer_load_dwordx4 v[40:43], v50, s[68:71], s85 offen sc1
    buffer_load_dwordx4 v[44:47], v51, s[68:71], s85 offen sc1
    s_waitcnt vmcnt(0)
PCHK_adaLN_cond__sliding_local_dilated__glu_gated_reglu__prompt_kernel_3:
    v_xor_b32 v11, s77, v33
    v_xor_b32 v35, s77, v35
    v_xor_b32 v37, s77, v37
    v_xor_b32 v39, s77, v39
    v_xor_b32 v41, s77, v41
    v_xor_b32 v43, s77, v43
    v_xor_b32 v45, s77, v45
    v_xor_b32 v47, s77, v47
    v_or3_b32 v11, v11, v35, v37
    v_or3_b32 v11, v11, v39, v41
    v_or3_b32 v11, v11, v43, v45
    v_or_b32 v11, v11, v47
    v_cmp_ne_u32 vcc, 0, v11
    s_cbranch_vccz PDONE_adaLN_cond__sliding_local_dilated__glu_gated_reglu__prompt_kernel_2
    s_mov_b64 exec, vcc
    s_sub_u32 s86, s86, 1
    s_cmp_lg_u32 s86, 0
    s_cbranch_scc1 POLL_adaLN_cond__sliding_local_dilated__glu_gated_reglu__prompt_kernel_1
PDONE_adaLN_cond__sliding_local_dilated__glu_gated_reglu__prompt_kernel_2:
    s_mov_b64 exec, -1
    v_lshlrev_b32 v120, 16, v32
    v_lshlrev_b32 v121, 16, v34
    v_and_b32 v32, 0xffff0000, v32
    v_and_b32 v33, 0xffff0000, v34
    ds_write2st64_b64 v13, v[120:121], v[32:33] offset0:0 offset1:2
    v_lshlrev_b32 v122, 16, v36
    v_lshlrev_b32 v123, 16, v38
    v_and_b32 v36, 0xffff0000, v36
    v_and_b32 v37, 0xffff0000, v38
    ds_write2st64_b64 v13, v[122:123], v[36:37] offset0:1 offset1:3
    v_lshlrev_b32 v124, 16, v40
    v_lshlrev_b32 v125, 16, v42
    v_and_b32 v40, 0xffff0000, v40
    v_and_b32 v41, 0xffff0000, v42
    ds_write2st64_b64 v13, v[124:125], v[40:41] offset0:4 offset1:6
    v_lshlrev_b32 v126, 16, v44
    v_lshlrev_b32 v127, 16, v46
    v_and_b32 v44, 0xffff0000, v44
    v_and_b32 v45, 0xffff0000, v46
    ds_write2st64_b64 v13, v[126:127], v[44:45] offset0:5 offset1:7
    v_mov_b32 v12, 3
    ds_write_b32 v28, v12 offset:2048
    s_setprio 0
    s_add_u32 s80, s5, 0
    s_and_b32 s80, s80, 7
    s_mul_i32 s80, s80, 393216
    s_add_u32 s80, s80, s91
    buffer_load_dwordx4 v[128:131], v9, s[60:63], s80 offen
    s_add_u32 s80, s5, 1
    s_and_b32 s80, s80, 7
    s_mul_i32 s80, s80, 393216
    s_add_u32 s80, s80, s91
    buffer_load_dwordx4 v[132:135], v9, s[60:63], s80 offen
    s_add_u32 s80, s5, 2
    s_and_b32 s80, s80, 7
    s_mul_i32 s80, s80, 393216
    s_add_u32 s80, s80, s91
    buffer_load_dwordx4 v[136:139], v9, s[60:63], s80 offen
    s_add_u32 s80, s5, 3
    s_and_b32 s80, s80, 7
    s_mul_i32 s80, s80, 393216
    s_add_u32 s80, s80, s91
    buffer_load_dwordx4 v[140:143], v9, s[60:63], s80 offen
    s_add_u32 s80, s5, 4
    s_and_b32 s80, s80, 7
    s_mul_i32 s80, s80, 393216
    s_add_u32 s80, s80, s91
    buffer_load_dwordx4 v[144:147], v9, s[60:63], s80 offen
    s_add_u32 s80, s5, 5
    s_and_b32 s80, s80, 7
    s_mul_i32 s80, s80, 393216
    s_add_u32 s80, s80, s91
    buffer_load_dwordx4 v[148:151], v9, s[60:63], s80 offen
    s_add_u32 s80, s5, 6
    s_and_b32 s80, s80, 7
    s_mul_i32 s80, s80, 393216
    s_add_u32 s80, s80, s91
    buffer_load_dwordx4 v[152:155], v9, s[60:63], s80 offen
    s_add_u32 s80, s5, 7
    s_and_b32 s80, s80, 7
    s_mul_i32 s80, s80, 393216
    s_add_u32 s80, s80, s91
    buffer_load_dwordx4 v[156:159], v9, s[60:63], s80 offen
    s_mov_b32 s81, 0x05040100
    s_mov_b32 s82, 0x07060302
    s_waitcnt vmcnt(6)
    v_perm_b32 v120, v132, v128, s81
    v_perm_b32 v121, v132, v128, s82
    v_perm_b32 v122, v133, v129, s81
    v_perm_b32 v123, v133, v129, s82
    v_perm_b32 v124, v134, v130, s81
    v_perm_b32 v125, v134, v130, s82
    v_perm_b32 v126, v135, v131, s81
    v_perm_b32 v127, v135, v131, s82
    v_dot2_f32_bf16 v112, v120, v16, 0
    v_dot2_f32_bf16 v113, v121, v16, 0
    v_dot2_f32_bf16 v114, v122, v16, 0
    v_dot2_f32_bf16 v115, v123, v16, 0
    v_dot2_f32_bf16 v116, v124, v16, 0
    v_dot2_f32_bf16 v117, v125, v16, 0
    v_dot2_f32_bf16 v118, v126, v16, 0
    v_dot2_f32_bf16 v119, v127, v16, 0
    s_waitcnt vmcnt(4)
    v_perm_b32 v120, v140, v136, s81
    v_perm_b32 v121, v140, v136, s82
    v_perm_b32 v122, v141, v137, s81
    v_perm_b32 v123, v141, v137, s82
    v_perm_b32 v124, v142, v138, s81
    v_perm_b32 v125, v142, v138, s82
    v_perm_b32 v126, v143, v139, s81
    v_perm_b32 v127, v143, v139, s82
    v_dot2_f32_bf16 v112, v120, v17, v112
    v_dot2_f32_bf16 v113, v121, v17, v113
    v_dot2_f32_bf16 v114, v122, v17, v114
    v_dot2_f32_bf16 v115, v123, v17, v115
    v_dot2_f32_bf16 v116, v124, v17, v116
    v_dot2_f32_bf16 v117, v125, v17, v117
    v_dot2_f32_bf16 v118, v126, v17, v118
    v_dot2_f32_bf16 v119, v127, v17, v119
    s_waitcnt vmcnt(2)
    v_perm_b32 v120, v148, v144, s81
    v_perm_b32 v121, v148, v144, s82
    v_perm_b32 v122, v149, v145, s81
    v_perm_b32 v123, v149, v145, s82
    v_perm_b32 v124, v150, v146, s81
    v_perm_b32 v125, v150, v146, s82
    v_perm_b32 v126, v151, v147, s81
    v_perm_b32 v127, v151, v147, s82
    v_dot2_f32_bf16 v112, v120, v18, v112
    v_dot2_f32_bf16 v113, v121, v18, v113
    v_dot2_f32_bf16 v114, v122, v18, v114
    v_dot2_f32_bf16 v115, v123, v18, v115
    v_dot2_f32_bf16 v116, v124, v18, v116
    v_dot2_f32_bf16 v117, v125, v18, v117
    v_dot2_f32_bf16 v118, v126, v18, v118
    v_dot2_f32_bf16 v119, v127, v18, v119
    s_waitcnt vmcnt(0)
    v_perm_b32 v120, v156, v152, s81
    v_perm_b32 v121, v156, v152, s82
    v_perm_b32 v122, v157, v153, s81
    v_perm_b32 v123, v157, v153, s82
    v_perm_b32 v124, v158, v154, s81
    v_perm_b32 v125, v158, v154, s82
    v_perm_b32 v126, v159, v155, s81
    v_perm_b32 v127, v159, v155, s82
    v_dot2_f32_bf16 v112, v120, v19, v112
    v_dot2_f32_bf16 v113, v121, v19, v113
    v_dot2_f32_bf16 v114, v122, v19, v114
    v_dot2_f32_bf16 v115, v123, v19, v115
    v_dot2_f32_bf16 v116, v124, v19, v116
    v_dot2_f32_bf16 v117, v125, v19, v117
    v_dot2_f32_bf16 v118, v126, v19, v118
    v_dot2_f32_bf16 v119, v127, v19, v119
    v_permlane32_swap_b32 v112, v116
    v_permlane32_swap_b32 v113, v117
    v_permlane32_swap_b32 v114, v118
    v_permlane32_swap_b32 v115, v119
    v_add_f32 v112, v112, v116
    v_add_f32 v113, v113, v117
    v_add_f32 v114, v114, v118
    v_add_f32 v115, v115, v119
    s_nop 0
    v_permlane16_swap_b32 v112, v114
    v_permlane16_swap_b32 v113, v115
    v_add_f32 v112, v112, v114
    v_add_f32 v113, v113, v115
    s_nop 0
    v_add_f32_dpp v112, v112, v112 quad_perm:[1,0,3,2] row_mask:0xf bank_mask:0xf
    v_add_f32_dpp v113, v113, v113 quad_perm:[1,0,3,2] row_mask:0xf bank_mask:0xf
    s_nop 0
    v_add_f32_dpp v112, v112, v112 quad_perm:[2,3,0,1] row_mask:0xf bank_mask:0xf
    v_add_f32_dpp v113, v113, v113 quad_perm:[2,3,0,1] row_mask:0xf bank_mask:0xf
    s_nop 0
    v_add_f32_dpp v112, v112, v112 row_half_mirror row_mask:0xf bank_mask:0xf
    v_add_f32_dpp v113, v113, v113 row_half_mirror row_mask:0xf bank_mask:0xf
    s_nop 0
    v_add_f32_dpp v112, v112, v112 row_mirror row_mask:0xf bank_mask:0xf
    v_add_f32_dpp v113, v113, v113 row_mirror row_mask:0xf bank_mask:0xf
    v_cvt_pk_bf16_f32 v114, v112, v113
    v_lshlrev_b32 v112, 16, v114
    v_and_b32 v113, 0xffff0000, v114
    v_add_f32 v112, s101, v112
    v_add_f32 v113, s101, v113
    v_mov_b32 v115, s77
    v_cvt_pk_bf16_f32 v114, v112, v113
    v_lshrrev_b32 v120, 1, v15
    s_mov_b32 exec_lo, 0x00010001
    s_mov_b32 exec_hi, 0x00010001
    buffer_store_dwordx2 v[114:115], v120, s[68:71], s93 offen sc1
    s_mov_b64 exec, -1
    s_branch MWAVE
CMAIN:
    s_nop 7
    s_nop 7
    s_mov_b32 s68, s30
    s_and_b32 s69, s31, 0xffff
    s_mov_b32 s70, 0xe00000
    s_mov_b32 s71, 0x20000
    s_mov_b32 s64, s26
    s_and_b32 s65, s27, 0xffff
    s_mov_b32 s66, 0x200000
    s_mov_b32 s67, 0x20000
    s_mul_i32 s80, s3, 5120
    s_add_u32 s80, s80, 110592
    v_xor_b32 v12, v11, v13
    v_lshlrev_b32 v12, 4, v12
    v_lshl_add_u32 v12, v11, 8, v12
    v_add_u32 v12, s80, v12
    s_add_u32 s81, s3, 0
    s_and_b32 s81, s81, 3
    s_lshl_b32 s81, s81, 6
    v_xor_b32 v104, s81, v12
    s_add_u32 s81, s3, 1
    s_and_b32 s81, s81, 3
    s_lshl_b32 s81, s81, 6
    v_xor_b32 v105, s81, v12
    s_add_u32 s81, s3, 2
    s_and_b32 s81, s81, 3
    s_lshl_b32 s81, s81, 6
    v_xor_b32 v106, s81, v12
    s_add_u32 s81, s3, 3
    s_and_b32 s81, s81, 3
    s_lshl_b32 s81, s81, 6
    v_xor_b32 v107, s81, v12
    v_lshlrev_b32 v13, 4, v13
    v_add_u32 v13, 155648, v13
    v_lshrrev_b32 v2, 4, v15
    v_bfe_u32 v3, v15, 2, 2
    v_bfe_u32 v4, v15, 1, 1
    s_lshl_b32 s81, s3, 1
    v_add_u32 v4, s81, v4
    v_and_b32 v5, 2, v3
    v_xor_b32 v4, v4, v5
    v_and_b32 v5, 1, v2
    v_lshlrev_b32 v5, 2, v5
    v_xor_b32 v4, v4, v5
    v_mul_u32_u24 v1, 3072, v2
    v_lshl_add_u32 v1, v3, 7, v1
    v_lshl_add_u32 v1, v4, 4, v1
    v_and_b32 v5, 1, v15
    v_lshl_add_u32 v1, v5, 3, v1
    v_add_u32 v14, 61440, v1
    v_and_b32 v3, 15, v15
    s_lshl_b32 s81, s74, 3
    v_xor_b32 v12, s81, v3
    v_lshlrev_b32 v10, 8, v3
    v_add_u32 v10, 110592, v10
    v_add_u32 v11, 0, v2
    v_xor_b32 v11, v11, v12
    v_lshl_add_u32 v4, v11, 4, v10
    v_add_u32 v11, 4, v2
    v_xor_b32 v11, v11, v12
    v_lshl_add_u32 v5, v11, 4, v10
    v_add_u32 v11, 8, v2
    v_xor_b32 v11, v11, v12
    v_lshl_add_u32 v6, v11, 4, v10
    v_add_u32 v11, 12, v2
    v_xor_b32 v11, v11, v12
    v_lshl_add_u32 v7, v11, 4, v10
    s_mov_b32 s82, 0x3f803f80
    s_mov_b32 s83, 0xffff0000
    s_mov_b32 s84, 0x3b000000
    s_mov_b32 s85, 0x3727c5ac
    v_mov_b32 v192, 0
    v_mov_b32 v193, 0
    v_mov_b32 v194, 0
    v_mov_b32 v195, 0
    v_mov_b32 v196, 0
    v_mov_b32 v197, 0
    v_mov_b32 v198, 0
    v_mov_b32 v199, 0
    v_mov_b32 v200, 0
    v_mov_b32 v201, 0
    s_waitcnt vmcnt(16)
    v_dot2c_f32_bf16 v193, s82, v164
    v_dot2c_f32_bf16 v192, v164, v164
    v_lshlrev_b32 v160, 16, v164
    v_and_b32 v164, s83, v164
    v_dot2c_f32_bf16 v193, s82, v165
    v_dot2c_f32_bf16 v192, v165, v165
    v_lshlrev_b32 v161, 16, v165
    v_and_b32 v165, s83, v165
    v_dot2c_f32_bf16 v193, s82, v166
    v_dot2c_f32_bf16 v192, v166, v166
    v_lshlrev_b32 v162, 16, v166
    v_and_b32 v166, s83, v166
    v_dot2c_f32_bf16 v193, s82, v167
    v_dot2c_f32_bf16 v192, v167, v167
    v_lshlrev_b32 v163, 16, v167
    v_and_b32 v167, s83, v167
    v_dot2c_f32_bf16 v193, s82, v28
    v_dot2c_f32_bf16 v192, v28, v28
    v_lshlrev_b32 v24, 16, v28
    v_and_b32 v28, s83, v28
    v_dot2c_f32_bf16 v193, s82, v29
    v_dot2c_f32_bf16 v192, v29, v29
    v_lshlrev_b32 v25, 16, v29
    v_and_b32 v29, s83, v29
    v_dot2c_f32_bf16 v193, s82, v30
    v_dot2c_f32_bf16 v192, v30, v30
    v_lshlrev_b32 v26, 16, v30
    v_and_b32 v30, s83, v30
    v_dot2c_f32_bf16 v193, s82, v31
    v_dot2c_f32_bf16 v192, v31, v31
    v_lshlrev_b32 v27, 16, v31
    v_and_b32 v31, s83, v31
    v_dot2c_f32_bf16 v193, s82, v124
    v_dot2c_f32_bf16 v192, v124, v124
    v_lshlrev_b32 v120, 16, v124
    v_and_b32 v124, s83, v124
    v_dot2c_f32_bf16 v193, s82, v125
    v_dot2c_f32_bf16 v192, v125, v125
    v_lshlrev_b32 v121, 16, v125
    v_and_b32 v125, s83, v125
    v_dot2c_f32_bf16 v193, s82, v126
    v_dot2c_f32_bf16 v192, v126, v126
    v_lshlrev_b32 v122, 16, v126
    v_and_b32 v126, s83, v126
    v_dot2c_f32_bf16 v193, s82, v127
    v_dot2c_f32_bf16 v192, v127, v127
    v_lshlrev_b32 v123, 16, v127
    v_and_b32 v127, s83, v127
    v_dot2c_f32_bf16 v193, s82, v76
    v_dot2c_f32_bf16 v192, v76, v76
    v_lshlrev_b32 v72, 16, v76
    v_and_b32 v76, s83, v76
    v_dot2c_f32_bf16 v193, s82, v77
    v_dot2c_f32_bf16 v192, v77, v77
    v_lshlrev_b32 v73, 16, v77
    v_and_b32 v77, s83, v77
    v_dot2c_f32_bf16 v193, s82, v78
    v_dot2c_f32_bf16 v192, v78, v78
    v_lshlrev_b32 v74, 16, v78
    v_and_b32 v78, s83, v78
    v_dot2c_f32_bf16 v193, s82, v79
    v_dot2c_f32_bf16 v192, v79, v79
    v_lshlrev_b32 v75, 16, v79
    v_and_b32 v79, s83, v79
    s_waitcnt vmcnt(12)
    v_dot2c_f32_bf16 v195, s82, v172
    v_dot2c_f32_bf16 v194, v172, v172
    v_lshlrev_b32 v168, 16, v172
    v_add_f32_dpp v192, v192, v192 quad_perm:[1,0,3,2] row_mask:0xf bank_mask:0xf
    v_and_b32 v172, s83, v172
    v_dot2c_f32_bf16 v195, s82, v173
    v_dot2c_f32_bf16 v194, v173, v173
    v_add_f32_dpp v193, v193, v193 quad_perm:[1,0,3,2] row_mask:0xf bank_mask:0xf
    v_lshlrev_b32 v169, 16, v173
    v_and_b32 v173, s83, v173
    v_dot2c_f32_bf16 v195, s82, v174
    v_add_f32_dpp v192, v192, v192 quad_perm:[2,3,0,1] row_mask:0xf bank_mask:0xf
    v_dot2c_f32_bf16 v194, v174, v174
    v_lshlrev_b32 v170, 16, v174
    v_and_b32 v174, s83, v174
    v_add_f32_dpp v193, v193, v193 quad_perm:[2,3,0,1] row_mask:0xf bank_mask:0xf
    v_dot2c_f32_bf16 v195, s82, v175
    v_dot2c_f32_bf16 v194, v175, v175
    v_lshlrev_b32 v171, 16, v175
    v_add_f32_dpp v192, v192, v192 row_half_mirror row_mask:0xf bank_mask:0xf
    v_and_b32 v175, s83, v175
    v_dot2c_f32_bf16 v195, s82, v36
    v_dot2c_f32_bf16 v194, v36, v36
    v_add_f32_dpp v193, v193, v193 row_half_mirror row_mask:0xf bank_mask:0xf
    v_lshlrev_b32 v32, 16, v36
    v_and_b32 v36, s83, v36
    v_dot2c_f32_bf16 v195, s82, v37
    v_add_f32_dpp v192, v192, v192 row_mirror row_mask:0xf bank_mask:0xf
    v_dot2c_f32_bf16 v194, v37, v37
    v_lshlrev_b32 v33, 16, v37
    v_and_b32 v37, s83, v37
    v_add_f32_dpp v193, v193, v193 row_mirror row_mask:0xf bank_mask:0xf
    v_dot2c_f32_bf16 v195, s82, v38
    v_dot2c_f32_bf16 v194, v38, v38
    v_lshlrev_b32 v34, 16, v38
    v_mul_f32 v193, s84, v193
    v_and_b32 v38, s83, v38
    v_dot2c_f32_bf16 v195, s82, v39
    v_dot2c_f32_bf16 v194, v39, v39
    v_mul_f32 v192, s84, v192
    v_lshlrev_b32 v35, 16, v39
    v_and_b32 v39, s83, v39
    v_dot2c_f32_bf16 v195, s82, v132
    v_fma_f32 v192, -v193, v193, v192
    v_dot2c_f32_bf16 v194, v132, v132
    v_lshlrev_b32 v128, 16, v132
    v_and_b32 v132, s83, v132
    v_max_f32 v192, 0, v192
    v_dot2c_f32_bf16 v195, s82, v133
    v_dot2c_f32_bf16 v194, v133, v133
    v_lshlrev_b32 v129, 16, v133
    v_add_f32 v192, s85, v192
    v_and_b32 v133, s83, v133
    v_dot2c_f32_bf16 v195, s82, v134
    v_dot2c_f32_bf16 v194, v134, v134
    v_rsq_f32 v192, v192
    v_lshlrev_b32 v130, 16, v134
    v_and_b32 v134, s83, v134
    v_dot2c_f32_bf16 v195, s82, v135
    v_mul_f32 v193, v193, v192
    v_dot2c_f32_bf16 v194, v135, v135
    v_lshlrev_b32 v131, 16, v135
    v_and_b32 v135, s83, v135
    v_dot2c_f32_bf16 v195, s82, v84
    v_dot2c_f32_bf16 v194, v84, v84
    v_lshlrev_b32 v80, 16, v84
    v_and_b32 v84, s83, v84
    v_dot2c_f32_bf16 v195, s82, v85
    v_dot2c_f32_bf16 v194, v85, v85
    v_lshlrev_b32 v81, 16, v85
    v_and_b32 v85, s83, v85
    v_dot2c_f32_bf16 v195, s82, v86
    v_dot2c_f32_bf16 v194, v86, v86
    v_lshlrev_b32 v82, 16, v86
    v_and_b32 v86, s83, v86
    v_dot2c_f32_bf16 v195, s82, v87
    v_dot2c_f32_bf16 v194, v87, v87
    v_lshlrev_b32 v83, 16, v87
    v_and_b32 v87, s83, v87
    v_pk_fma_f32 v[160:161], v[160:161], v[192:193], v[192:193] op_sel:[0,0,1] op_sel_hi:[1,0,1] neg_lo:[0,0,1] neg_hi:[0,0,1]
    v_pk_fma_f32 v[162:163], v[162:163], v[192:193], v[192:193] op_sel:[0,0,1] op_sel_hi:[1,0,1] neg_lo:[0,0,1] neg_hi:[0,0,1]
    v_pk_fma_f32 v[164:165], v[164:165], v[192:193], v[192:193] op_sel:[0,0,1] op_sel_hi:[1,0,1] neg_lo:[0,0,1] neg_hi:[0,0,1]
    v_pk_fma_f32 v[166:167], v[166:167], v[192:193], v[192:193] op_sel:[0,0,1] op_sel_hi:[1,0,1] neg_lo:[0,0,1] neg_hi:[0,0,1]
    v_pk_fma_f32 v[24:25], v[24:25], v[192:193], v[192:193] op_sel:[0,0,1] op_sel_hi:[1,0,1] neg_lo:[0,0,1] neg_hi:[0,0,1]
    v_pk_fma_f32 v[26:27], v[26:27], v[192:193], v[192:193] op_sel:[0,0,1] op_sel_hi:[1,0,1] neg_lo:[0,0,1] neg_hi:[0,0,1]
    v_pk_fma_f32 v[28:29], v[28:29], v[192:193], v[192:193] op_sel:[0,0,1] op_sel_hi:[1,0,1] neg_lo:[0,0,1] neg_hi:[0,0,1]
    v_pk_fma_f32 v[30:31], v[30:31], v[192:193], v[192:193] op_sel:[0,0,1] op_sel_hi:[1,0,1] neg_lo:[0,0,1] neg_hi:[0,0,1]
    v_pk_fma_f32 v[120:121], v[120:121], v[192:193], v[192:193] op_sel:[0,0,1] op_sel_hi:[1,0,1] neg_lo:[0,0,1] neg_hi:[0,0,1]
    v_pk_fma_f32 v[122:123], v[122:123], v[192:193], v[192:193] op_sel:[0,0,1] op_sel_hi:[1,0,1] neg_lo:[0,0,1] neg_hi:[0,0,1]
    v_pk_fma_f32 v[124:125], v[124:125], v[192:193], v[192:193] op_sel:[0,0,1] op_sel_hi:[1,0,1] neg_lo:[0,0,1] neg_hi:[0,0,1]
    v_pk_fma_f32 v[126:127], v[126:127], v[192:193], v[192:193] op_sel:[0,0,1] op_sel_hi:[1,0,1] neg_lo:[0,0,1] neg_hi:[0,0,1]
    v_pk_fma_f32 v[72:73], v[72:73], v[192:193], v[192:193] op_sel:[0,0,1] op_sel_hi:[1,0,1] neg_lo:[0,0,1] neg_hi:[0,0,1]
    v_pk_fma_f32 v[74:75], v[74:75], v[192:193], v[192:193] op_sel:[0,0,1] op_sel_hi:[1,0,1] neg_lo:[0,0,1] neg_hi:[0,0,1]
    v_pk_fma_f32 v[76:77], v[76:77], v[192:193], v[192:193] op_sel:[0,0,1] op_sel_hi:[1,0,1] neg_lo:[0,0,1] neg_hi:[0,0,1]
    v_pk_fma_f32 v[78:79], v[78:79], v[192:193], v[192:193] op_sel:[0,0,1] op_sel_hi:[1,0,1] neg_lo:[0,0,1] neg_hi:[0,0,1]
    s_waitcnt vmcnt(8)
    v_dot2c_f32_bf16 v197, s82, v180
    v_dot2c_f32_bf16 v196, v180, v180
    v_lshlrev_b32 v176, 16, v180
    v_add_f32_dpp v194, v194, v194 quad_perm:[1,0,3,2] row_mask:0xf bank_mask:0xf
    v_and_b32 v180, s83, v180
    v_dot2c_f32_bf16 v197, s82, v181
    v_dot2c_f32_bf16 v196, v181, v181
    v_add_f32_dpp v195, v195, v195 quad_perm:[1,0,3,2] row_mask:0xf bank_mask:0xf
    v_lshlrev_b32 v177, 16, v181
    v_and_b32 v181, s83, v181
    v_dot2c_f32_bf16 v197, s82, v182
    v_add_f32_dpp v194, v194, v194 quad_perm:[2,3,0,1] row_mask:0xf bank_mask:0xf
    v_dot2c_f32_bf16 v196, v182, v182
    v_lshlrev_b32 v178, 16, v182
    v_and_b32 v182, s83, v182
    v_add_f32_dpp v195, v195, v195 quad_perm:[2,3,0,1] row_mask:0xf bank_mask:0xf
    v_dot2c_f32_bf16 v197, s82, v183
    v_dot2c_f32_bf16 v196, v183, v183
    v_lshlrev_b32 v179, 16, v183
    v_add_f32_dpp v194, v194, v194 row_half_mirror row_mask:0xf bank_mask:0xf
    v_and_b32 v183, s83, v183
    v_dot2c_f32_bf16 v197, s82, v44
    v_dot2c_f32_bf16 v196, v44, v44
    v_add_f32_dpp v195, v195, v195 row_half_mirror row_mask:0xf bank_mask:0xf
    v_lshlrev_b32 v40, 16, v44
    v_and_b32 v44, s83, v44
    v_dot2c_f32_bf16 v197, s82, v45
    v_add_f32_dpp v194, v194, v194 row_mirror row_mask:0xf bank_mask:0xf
    v_dot2c_f32_bf16 v196, v45, v45
    v_lshlrev_b32 v41, 16, v45
    v_and_b32 v45, s83, v45
    v_add_f32_dpp v195, v195, v195 row_mirror row_mask:0xf bank_mask:0xf
    v_dot2c_f32_bf16 v197, s82, v46
    v_dot2c_f32_bf16 v196, v46, v46
    v_lshlrev_b32 v42, 16, v46
    v_mul_f32 v195, s84, v195
    v_and_b32 v46, s83, v46
    v_dot2c_f32_bf16 v197, s82, v47
    v_dot2c_f32_bf16 v196, v47, v47
    v_mul_f32 v194, s84, v194
    v_lshlrev_b32 v43, 16, v47
    v_and_b32 v47, s83, v47
    v_dot2c_f32_bf16 v197, s82, v140
    v_fma_f32 v194, -v195, v195, v194
    v_dot2c_f32_bf16 v196, v140, v140
    v_lshlrev_b32 v136, 16, v140
    v_and_b32 v140, s83, v140
    v_max_f32 v194, 0, v194
    v_dot2c_f32_bf16 v197, s82, v141
    v_dot2c_f32_bf16 v196, v141, v141
    v_lshlrev_b32 v137, 16, v141
    v_add_f32 v194, s85, v194
    v_and_b32 v141, s83, v141
    v_dot2c_f32_bf16 v197, s82, v142
    v_dot2c_f32_bf16 v196, v142, v142
    v_rsq_f32 v194, v194
    v_lshlrev_b32 v138, 16, v142
    v_and_b32 v142, s83, v142
    v_dot2c_f32_bf16 v197, s82, v143
    v_mul_f32 v195, v195, v194
    v_dot2c_f32_bf16 v196, v143, v143
    v_lshlrev_b32 v139, 16, v143
    v_and_b32 v143, s83, v143
    v_dot2c_f32_bf16 v197, s82, v92
    v_dot2c_f32_bf16 v196, v92, v92
    v_lshlrev_b32 v88, 16, v92
    v_and_b32 v92, s83, v92
    v_dot2c_f32_bf16 v197, s82, v93
    v_dot2c_f32_bf16 v196, v93, v93
    v_lshlrev_b32 v89, 16, v93
    v_and_b32 v93, s83, v93
    v_dot2c_f32_bf16 v197, s82, v94
    v_dot2c_f32_bf16 v196, v94, v94
    v_lshlrev_b32 v90, 16, v94
    v_and_b32 v94, s83, v94
    v_dot2c_f32_bf16 v197, s82, v95
    v_dot2c_f32_bf16 v196, v95, v95
    v_lshlrev_b32 v91, 16, v95
    v_and_b32 v95, s83, v95
    v_pk_fma_f32 v[168:169], v[168:169], v[194:195], v[194:195] op_sel:[0,0,1] op_sel_hi:[1,0,1] neg_lo:[0,0,1] neg_hi:[0,0,1]
    v_pk_fma_f32 v[170:171], v[170:171], v[194:195], v[194:195] op_sel:[0,0,1] op_sel_hi:[1,0,1] neg_lo:[0,0,1] neg_hi:[0,0,1]
    v_pk_fma_f32 v[172:173], v[172:173], v[194:195], v[194:195] op_sel:[0,0,1] op_sel_hi:[1,0,1] neg_lo:[0,0,1] neg_hi:[0,0,1]
    v_pk_fma_f32 v[174:175], v[174:175], v[194:195], v[194:195] op_sel:[0,0,1] op_sel_hi:[1,0,1] neg_lo:[0,0,1] neg_hi:[0,0,1]
    v_pk_fma_f32 v[32:33], v[32:33], v[194:195], v[194:195] op_sel:[0,0,1] op_sel_hi:[1,0,1] neg_lo:[0,0,1] neg_hi:[0,0,1]
    v_pk_fma_f32 v[34:35], v[34:35], v[194:195], v[194:195] op_sel:[0,0,1] op_sel_hi:[1,0,1] neg_lo:[0,0,1] neg_hi:[0,0,1]
    v_pk_fma_f32 v[36:37], v[36:37], v[194:195], v[194:195] op_sel:[0,0,1] op_sel_hi:[1,0,1] neg_lo:[0,0,1] neg_hi:[0,0,1]
    v_pk_fma_f32 v[38:39], v[38:39], v[194:195], v[194:195] op_sel:[0,0,1] op_sel_hi:[1,0,1] neg_lo:[0,0,1] neg_hi:[0,0,1]
    v_pk_fma_f32 v[128:129], v[128:129], v[194:195], v[194:195] op_sel:[0,0,1] op_sel_hi:[1,0,1] neg_lo:[0,0,1] neg_hi:[0,0,1]
    v_pk_fma_f32 v[130:131], v[130:131], v[194:195], v[194:195] op_sel:[0,0,1] op_sel_hi:[1,0,1] neg_lo:[0,0,1] neg_hi:[0,0,1]
    v_pk_fma_f32 v[132:133], v[132:133], v[194:195], v[194:195] op_sel:[0,0,1] op_sel_hi:[1,0,1] neg_lo:[0,0,1] neg_hi:[0,0,1]
    v_pk_fma_f32 v[134:135], v[134:135], v[194:195], v[194:195] op_sel:[0,0,1] op_sel_hi:[1,0,1] neg_lo:[0,0,1] neg_hi:[0,0,1]
    v_pk_fma_f32 v[80:81], v[80:81], v[194:195], v[194:195] op_sel:[0,0,1] op_sel_hi:[1,0,1] neg_lo:[0,0,1] neg_hi:[0,0,1]
    v_pk_fma_f32 v[82:83], v[82:83], v[194:195], v[194:195] op_sel:[0,0,1] op_sel_hi:[1,0,1] neg_lo:[0,0,1] neg_hi:[0,0,1]
    v_pk_fma_f32 v[84:85], v[84:85], v[194:195], v[194:195] op_sel:[0,0,1] op_sel_hi:[1,0,1] neg_lo:[0,0,1] neg_hi:[0,0,1]
    v_pk_fma_f32 v[86:87], v[86:87], v[194:195], v[194:195] op_sel:[0,0,1] op_sel_hi:[1,0,1] neg_lo:[0,0,1] neg_hi:[0,0,1]
    s_waitcnt vmcnt(4)
    v_dot2c_f32_bf16 v199, s82, v188
    v_dot2c_f32_bf16 v198, v188, v188
    v_lshlrev_b32 v184, 16, v188
    v_add_f32_dpp v196, v196, v196 quad_perm:[1,0,3,2] row_mask:0xf bank_mask:0xf
    v_and_b32 v188, s83, v188
    v_dot2c_f32_bf16 v199, s82, v189
    v_dot2c_f32_bf16 v198, v189, v189
    v_add_f32_dpp v197, v197, v197 quad_perm:[1,0,3,2] row_mask:0xf bank_mask:0xf
    v_lshlrev_b32 v185, 16, v189
    v_and_b32 v189, s83, v189
    v_dot2c_f32_bf16 v199, s82, v190
    v_add_f32_dpp v196, v196, v196 quad_perm:[2,3,0,1] row_mask:0xf bank_mask:0xf
    v_dot2c_f32_bf16 v198, v190, v190
    v_lshlrev_b32 v186, 16, v190
    v_and_b32 v190, s83, v190
    v_add_f32_dpp v197, v197, v197 quad_perm:[2,3,0,1] row_mask:0xf bank_mask:0xf
    v_dot2c_f32_bf16 v199, s82, v191
    v_dot2c_f32_bf16 v198, v191, v191
    v_lshlrev_b32 v187, 16, v191
    v_add_f32_dpp v196, v196, v196 row_half_mirror row_mask:0xf bank_mask:0xf
    v_and_b32 v191, s83, v191
    v_dot2c_f32_bf16 v199, s82, v52
    v_dot2c_f32_bf16 v198, v52, v52
    v_add_f32_dpp v197, v197, v197 row_half_mirror row_mask:0xf bank_mask:0xf
    v_lshlrev_b32 v48, 16, v52
    v_and_b32 v52, s83, v52
    v_dot2c_f32_bf16 v199, s82, v53
    v_add_f32_dpp v196, v196, v196 row_mirror row_mask:0xf bank_mask:0xf
    v_dot2c_f32_bf16 v198, v53, v53
    v_lshlrev_b32 v49, 16, v53
    v_and_b32 v53, s83, v53
    v_add_f32_dpp v197, v197, v197 row_mirror row_mask:0xf bank_mask:0xf
    v_dot2c_f32_bf16 v199, s82, v54
    v_dot2c_f32_bf16 v198, v54, v54
    v_lshlrev_b32 v50, 16, v54
    v_mul_f32 v197, s84, v197
    v_and_b32 v54, s83, v54
    v_dot2c_f32_bf16 v199, s82, v55
    v_dot2c_f32_bf16 v198, v55, v55
    v_mul_f32 v196, s84, v196
    v_lshlrev_b32 v51, 16, v55
    v_and_b32 v55, s83, v55
    v_dot2c_f32_bf16 v199, s82, v148
    v_fma_f32 v196, -v197, v197, v196
    v_dot2c_f32_bf16 v198, v148, v148
    v_lshlrev_b32 v144, 16, v148
    v_and_b32 v148, s83, v148
    v_max_f32 v196, 0, v196
    v_dot2c_f32_bf16 v199, s82, v149
    v_dot2c_f32_bf16 v198, v149, v149
    v_lshlrev_b32 v145, 16, v149
    v_add_f32 v196, s85, v196
    v_and_b32 v149, s83, v149
    v_dot2c_f32_bf16 v199, s82, v150
    v_dot2c_f32_bf16 v198, v150, v150
    v_rsq_f32 v196, v196
    v_lshlrev_b32 v146, 16, v150
    v_and_b32 v150, s83, v150
    v_dot2c_f32_bf16 v199, s82, v151
    v_mul_f32 v197, v197, v196
    v_dot2c_f32_bf16 v198, v151, v151
    v_lshlrev_b32 v147, 16, v151
    v_and_b32 v151, s83, v151
    v_dot2c_f32_bf16 v199, s82, v100
    v_dot2c_f32_bf16 v198, v100, v100
    v_lshlrev_b32 v96, 16, v100
    v_and_b32 v100, s83, v100
    v_dot2c_f32_bf16 v199, s82, v101
    v_dot2c_f32_bf16 v198, v101, v101
    v_lshlrev_b32 v97, 16, v101
    v_and_b32 v101, s83, v101
    v_dot2c_f32_bf16 v199, s82, v102
    v_dot2c_f32_bf16 v198, v102, v102
    v_lshlrev_b32 v98, 16, v102
    v_and_b32 v102, s83, v102
    v_dot2c_f32_bf16 v199, s82, v103
    v_dot2c_f32_bf16 v198, v103, v103
    v_lshlrev_b32 v99, 16, v103
    v_and_b32 v103, s83, v103
    v_pk_fma_f32 v[176:177], v[176:177], v[196:197], v[196:197] op_sel:[0,0,1] op_sel_hi:[1,0,1] neg_lo:[0,0,1] neg_hi:[0,0,1]
    v_pk_fma_f32 v[178:179], v[178:179], v[196:197], v[196:197] op_sel:[0,0,1] op_sel_hi:[1,0,1] neg_lo:[0,0,1] neg_hi:[0,0,1]
    v_pk_fma_f32 v[180:181], v[180:181], v[196:197], v[196:197] op_sel:[0,0,1] op_sel_hi:[1,0,1] neg_lo:[0,0,1] neg_hi:[0,0,1]
    v_pk_fma_f32 v[182:183], v[182:183], v[196:197], v[196:197] op_sel:[0,0,1] op_sel_hi:[1,0,1] neg_lo:[0,0,1] neg_hi:[0,0,1]
    v_pk_fma_f32 v[40:41], v[40:41], v[196:197], v[196:197] op_sel:[0,0,1] op_sel_hi:[1,0,1] neg_lo:[0,0,1] neg_hi:[0,0,1]
    v_pk_fma_f32 v[42:43], v[42:43], v[196:197], v[196:197] op_sel:[0,0,1] op_sel_hi:[1,0,1] neg_lo:[0,0,1] neg_hi:[0,0,1]
    v_pk_fma_f32 v[44:45], v[44:45], v[196:197], v[196:197] op_sel:[0,0,1] op_sel_hi:[1,0,1] neg_lo:[0,0,1] neg_hi:[0,0,1]
    v_pk_fma_f32 v[46:47], v[46:47], v[196:197], v[196:197] op_sel:[0,0,1] op_sel_hi:[1,0,1] neg_lo:[0,0,1] neg_hi:[0,0,1]
    v_pk_fma_f32 v[136:137], v[136:137], v[196:197], v[196:197] op_sel:[0,0,1] op_sel_hi:[1,0,1] neg_lo:[0,0,1] neg_hi:[0,0,1]
    v_pk_fma_f32 v[138:139], v[138:139], v[196:197], v[196:197] op_sel:[0,0,1] op_sel_hi:[1,0,1] neg_lo:[0,0,1] neg_hi:[0,0,1]
    v_pk_fma_f32 v[140:141], v[140:141], v[196:197], v[196:197] op_sel:[0,0,1] op_sel_hi:[1,0,1] neg_lo:[0,0,1] neg_hi:[0,0,1]
    v_pk_fma_f32 v[142:143], v[142:143], v[196:197], v[196:197] op_sel:[0,0,1] op_sel_hi:[1,0,1] neg_lo:[0,0,1] neg_hi:[0,0,1]
    v_pk_fma_f32 v[88:89], v[88:89], v[196:197], v[196:197] op_sel:[0,0,1] op_sel_hi:[1,0,1] neg_lo:[0,0,1] neg_hi:[0,0,1]
    v_pk_fma_f32 v[90:91], v[90:91], v[196:197], v[196:197] op_sel:[0,0,1] op_sel_hi:[1,0,1] neg_lo:[0,0,1] neg_hi:[0,0,1]
    v_pk_fma_f32 v[92:93], v[92:93], v[196:197], v[196:197] op_sel:[0,0,1] op_sel_hi:[1,0,1] neg_lo:[0,0,1] neg_hi:[0,0,1]
    v_pk_fma_f32 v[94:95], v[94:95], v[196:197], v[196:197] op_sel:[0,0,1] op_sel_hi:[1,0,1] neg_lo:[0,0,1] neg_hi:[0,0,1]
    s_waitcnt vmcnt(0)
    v_dot2c_f32_bf16 v201, s82, v20
    v_dot2c_f32_bf16 v200, v20, v20
    v_lshlrev_b32 v16, 16, v20
    v_add_f32_dpp v198, v198, v198 quad_perm:[1,0,3,2] row_mask:0xf bank_mask:0xf
    v_and_b32 v20, s83, v20
    v_dot2c_f32_bf16 v201, s82, v21
    v_dot2c_f32_bf16 v200, v21, v21
    v_add_f32_dpp v199, v199, v199 quad_perm:[1,0,3,2] row_mask:0xf bank_mask:0xf
    v_lshlrev_b32 v17, 16, v21
    v_and_b32 v21, s83, v21
    v_dot2c_f32_bf16 v201, s82, v22
    v_add_f32_dpp v198, v198, v198 quad_perm:[2,3,0,1] row_mask:0xf bank_mask:0xf
    v_dot2c_f32_bf16 v200, v22, v22
    v_lshlrev_b32 v18, 16, v22
    v_and_b32 v22, s83, v22
    v_add_f32_dpp v199, v199, v199 quad_perm:[2,3,0,1] row_mask:0xf bank_mask:0xf
    v_dot2c_f32_bf16 v201, s82, v23
    v_dot2c_f32_bf16 v200, v23, v23
    v_lshlrev_b32 v19, 16, v23
    v_add_f32_dpp v198, v198, v198 row_half_mirror row_mask:0xf bank_mask:0xf
    v_and_b32 v23, s83, v23
    v_dot2c_f32_bf16 v201, s82, v60
    v_dot2c_f32_bf16 v200, v60, v60
    v_add_f32_dpp v199, v199, v199 row_half_mirror row_mask:0xf bank_mask:0xf
    v_lshlrev_b32 v56, 16, v60
    v_and_b32 v60, s83, v60
    v_dot2c_f32_bf16 v201, s82, v61
    v_add_f32_dpp v198, v198, v198 row_mirror row_mask:0xf bank_mask:0xf
    v_dot2c_f32_bf16 v200, v61, v61
    v_lshlrev_b32 v57, 16, v61
    v_and_b32 v61, s83, v61
    v_add_f32_dpp v199, v199, v199 row_mirror row_mask:0xf bank_mask:0xf
    v_dot2c_f32_bf16 v201, s82, v62
    v_dot2c_f32_bf16 v200, v62, v62
    v_lshlrev_b32 v58, 16, v62
    v_mul_f32 v199, s84, v199
    v_and_b32 v62, s83, v62
    v_dot2c_f32_bf16 v201, s82, v63
    v_dot2c_f32_bf16 v200, v63, v63
    v_mul_f32 v198, s84, v198
    v_lshlrev_b32 v59, 16, v63
    v_and_b32 v63, s83, v63
    v_dot2c_f32_bf16 v201, s82, v156
    v_fma_f32 v198, -v199, v199, v198
    v_dot2c_f32_bf16 v200, v156, v156
    v_lshlrev_b32 v152, 16, v156
    v_and_b32 v156, s83, v156
    v_max_f32 v198, 0, v198
    v_dot2c_f32_bf16 v201, s82, v157
    v_dot2c_f32_bf16 v200, v157, v157
    v_lshlrev_b32 v153, 16, v157
    v_add_f32 v198, s85, v198
    v_and_b32 v157, s83, v157
    v_dot2c_f32_bf16 v201, s82, v158
    v_dot2c_f32_bf16 v200, v158, v158
    v_rsq_f32 v198, v198
    v_lshlrev_b32 v154, 16, v158
    v_and_b32 v158, s83, v158
    v_dot2c_f32_bf16 v201, s82, v159
    v_mul_f32 v199, v199, v198
    v_dot2c_f32_bf16 v200, v159, v159
    v_lshlrev_b32 v155, 16, v159
    v_and_b32 v159, s83, v159
    v_dot2c_f32_bf16 v201, s82, v116
    v_dot2c_f32_bf16 v200, v116, v116
    v_lshlrev_b32 v112, 16, v116
    v_and_b32 v116, s83, v116
    v_dot2c_f32_bf16 v201, s82, v117
    v_dot2c_f32_bf16 v200, v117, v117
    v_lshlrev_b32 v113, 16, v117
    v_and_b32 v117, s83, v117
    v_dot2c_f32_bf16 v201, s82, v118
    v_dot2c_f32_bf16 v200, v118, v118
    v_lshlrev_b32 v114, 16, v118
    v_and_b32 v118, s83, v118
    v_dot2c_f32_bf16 v201, s82, v119
    v_dot2c_f32_bf16 v200, v119, v119
    v_lshlrev_b32 v115, 16, v119
    v_and_b32 v119, s83, v119
    v_pk_fma_f32 v[184:185], v[184:185], v[198:199], v[198:199] op_sel:[0,0,1] op_sel_hi:[1,0,1] neg_lo:[0,0,1] neg_hi:[0,0,1]
    v_add_f32_dpp v200, v200, v200 quad_perm:[1,0,3,2] row_mask:0xf bank_mask:0xf
    v_pk_fma_f32 v[186:187], v[186:187], v[198:199], v[198:199] op_sel:[0,0,1] op_sel_hi:[1,0,1] neg_lo:[0,0,1] neg_hi:[0,0,1]
    v_add_f32_dpp v201, v201, v201 quad_perm:[1,0,3,2] row_mask:0xf bank_mask:0xf
    v_pk_fma_f32 v[188:189], v[188:189], v[198:199], v[198:199] op_sel:[0,0,1] op_sel_hi:[1,0,1] neg_lo:[0,0,1] neg_hi:[0,0,1]
    v_add_f32_dpp v200, v200, v200 quad_perm:[2,3,0,1] row_mask:0xf bank_mask:0xf
    v_pk_fma_f32 v[190:191], v[190:191], v[198:199], v[198:199] op_sel:[0,0,1] op_sel_hi:[1,0,1] neg_lo:[0,0,1] neg_hi:[0,0,1]
    v_add_f32_dpp v201, v201, v201 quad_perm:[2,3,0,1] row_mask:0xf bank_mask:0xf
    v_pk_fma_f32 v[48:49], v[48:49], v[198:199], v[198:199] op_sel:[0,0,1] op_sel_hi:[1,0,1] neg_lo:[0,0,1] neg_hi:[0,0,1]
    v_add_f32_dpp v200, v200, v200 row_half_mirror row_mask:0xf bank_mask:0xf
    v_pk_fma_f32 v[50:51], v[50:51], v[198:199], v[198:199] op_sel:[0,0,1] op_sel_hi:[1,0,1] neg_lo:[0,0,1] neg_hi:[0,0,1]
    v_add_f32_dpp v201, v201, v201 row_half_mirror row_mask:0xf bank_mask:0xf
    v_pk_fma_f32 v[52:53], v[52:53], v[198:199], v[198:199] op_sel:[0,0,1] op_sel_hi:[1,0,1] neg_lo:[0,0,1] neg_hi:[0,0,1]
    v_add_f32_dpp v200, v200, v200 row_mirror row_mask:0xf bank_mask:0xf
    v_pk_fma_f32 v[54:55], v[54:55], v[198:199], v[198:199] op_sel:[0,0,1] op_sel_hi:[1,0,1] neg_lo:[0,0,1] neg_hi:[0,0,1]
    v_add_f32_dpp v201, v201, v201 row_mirror row_mask:0xf bank_mask:0xf
    v_pk_fma_f32 v[144:145], v[144:145], v[198:199], v[198:199] op_sel:[0,0,1] op_sel_hi:[1,0,1] neg_lo:[0,0,1] neg_hi:[0,0,1]
    v_mul_f32 v201, s84, v201
    v_pk_fma_f32 v[146:147], v[146:147], v[198:199], v[198:199] op_sel:[0,0,1] op_sel_hi:[1,0,1] neg_lo:[0,0,1] neg_hi:[0,0,1]
    v_mul_f32 v200, s84, v200
    v_pk_fma_f32 v[148:149], v[148:149], v[198:199], v[198:199] op_sel:[0,0,1] op_sel_hi:[1,0,1] neg_lo:[0,0,1] neg_hi:[0,0,1]
    v_fma_f32 v200, -v201, v201, v200
    v_pk_fma_f32 v[150:151], v[150:151], v[198:199], v[198:199] op_sel:[0,0,1] op_sel_hi:[1,0,1] neg_lo:[0,0,1] neg_hi:[0,0,1]
    v_max_f32 v200, 0, v200
    v_pk_fma_f32 v[96:97], v[96:97], v[198:199], v[198:199] op_sel:[0,0,1] op_sel_hi:[1,0,1] neg_lo:[0,0,1] neg_hi:[0,0,1]
    v_add_f32 v200, s85, v200
    v_pk_fma_f32 v[98:99], v[98:99], v[198:199], v[198:199] op_sel:[0,0,1] op_sel_hi:[1,0,1] neg_lo:[0,0,1] neg_hi:[0,0,1]
    v_rsq_f32 v200, v200
    v_pk_fma_f32 v[100:101], v[100:101], v[198:199], v[198:199] op_sel:[0,0,1] op_sel_hi:[1,0,1] neg_lo:[0,0,1] neg_hi:[0,0,1]
    v_mul_f32 v201, v201, v200
    v_pk_fma_f32 v[102:103], v[102:103], v[198:199], v[198:199] op_sel:[0,0,1] op_sel_hi:[1,0,1] neg_lo:[0,0,1] neg_hi:[0,0,1]
    v_pk_fma_f32 v[16:17], v[16:17], v[200:201], v[200:201] op_sel:[0,0,1] op_sel_hi:[1,0,1] neg_lo:[0,0,1] neg_hi:[0,0,1]
    v_pk_fma_f32 v[18:19], v[18:19], v[200:201], v[200:201] op_sel:[0,0,1] op_sel_hi:[1,0,1] neg_lo:[0,0,1] neg_hi:[0,0,1]
    v_pk_fma_f32 v[20:21], v[20:21], v[200:201], v[200:201] op_sel:[0,0,1] op_sel_hi:[1,0,1] neg_lo:[0,0,1] neg_hi:[0,0,1]
    v_pk_fma_f32 v[22:23], v[22:23], v[200:201], v[200:201] op_sel:[0,0,1] op_sel_hi:[1,0,1] neg_lo:[0,0,1] neg_hi:[0,0,1]
    v_pk_fma_f32 v[56:57], v[56:57], v[200:201], v[200:201] op_sel:[0,0,1] op_sel_hi:[1,0,1] neg_lo:[0,0,1] neg_hi:[0,0,1]
    v_pk_fma_f32 v[58:59], v[58:59], v[200:201], v[200:201] op_sel:[0,0,1] op_sel_hi:[1,0,1] neg_lo:[0,0,1] neg_hi:[0,0,1]
    v_pk_fma_f32 v[60:61], v[60:61], v[200:201], v[200:201] op_sel:[0,0,1] op_sel_hi:[1,0,1] neg_lo:[0,0,1] neg_hi:[0,0,1]
    v_pk_fma_f32 v[62:63], v[62:63], v[200:201], v[200:201] op_sel:[0,0,1] op_sel_hi:[1,0,1] neg_lo:[0,0,1] neg_hi:[0,0,1]
    v_pk_fma_f32 v[152:153], v[152:153], v[200:201], v[200:201] op_sel:[0,0,1] op_sel_hi:[1,0,1] neg_lo:[0,0,1] neg_hi:[0,0,1]
    v_pk_fma_f32 v[154:155], v[154:155], v[200:201], v[200:201] op_sel:[0,0,1] op_sel_hi:[1,0,1] neg_lo:[0,0,1] neg_hi:[0,0,1]
    v_pk_fma_f32 v[156:157], v[156:157], v[200:201], v[200:201] op_sel:[0,0,1] op_sel_hi:[1,0,1] neg_lo:[0,0,1] neg_hi:[0,0,1]
    v_pk_fma_f32 v[158:159], v[158:159], v[200:201], v[200:201] op_sel:[0,0,1] op_sel_hi:[1,0,1] neg_lo:[0,0,1] neg_hi:[0,0,1]
    v_pk_fma_f32 v[112:113], v[112:113], v[200:201], v[200:201] op_sel:[0,0,1] op_sel_hi:[1,0,1] neg_lo:[0,0,1] neg_hi:[0,0,1]
    v_pk_fma_f32 v[114:115], v[114:115], v[200:201], v[200:201] op_sel:[0,0,1] op_sel_hi:[1,0,1] neg_lo:[0,0,1] neg_hi:[0,0,1]
    v_pk_fma_f32 v[116:117], v[116:117], v[200:201], v[200:201] op_sel:[0,0,1] op_sel_hi:[1,0,1] neg_lo:[0,0,1] neg_hi:[0,0,1]
    v_pk_fma_f32 v[118:119], v[118:119], v[200:201], v[200:201] op_sel:[0,0,1] op_sel_hi:[1,0,1] neg_lo:[0,0,1] neg_hi:[0,0,1]
    s_movk_i32 s86, 30000
WL_adaLN_cond__sliding_local_dilated__glu_gated_reglu__prompt_kernel_4:
    ds_read_b32 v0, v108 offset:2048
    s_waitcnt lgkmcnt(0)
    v_cmp_gt_u32 vcc, 3, v0
    s_cbranch_vccz WD_adaLN_cond__sliding_local_dilated__glu_gated_reglu__prompt_kernel_5
    s_sub_u32 s86, s86, 1
    s_cmp_lg_u32 s86, 0
    s_cbranch_scc1 WL_adaLN_cond__sliding_local_dilated__glu_gated_reglu__prompt_kernel_4
WD_adaLN_cond__sliding_local_dilated__glu_gated_reglu__prompt_kernel_5:
    ds_read_b128 v[224:227], v13
    ds_read_b128 v[228:231], v13 offset:1024
    ds_read_b128 v[232:235], v13 offset:2048
    ds_read_b128 v[236:239], v13 offset:3072
    ds_read_b128 v[240:243], v13 offset:256
    ds_read_b128 v[244:247], v13 offset:1280
    ds_read_b128 v[248:251], v13 offset:2304
    ds_read_b128 v[252:255], v13 offset:3328
    v_mov_b32 v10, 162816
    ds_read_b32 v10, v10
    ds_read_b32 v0, v108 offset:1024
    s_waitcnt lgkmcnt(6)
    v_pk_fma_f32 v[160:161], v[160:161], v[232:233], v[224:225]
    v_pk_fma_f32 v[162:163], v[162:163], v[234:235], v[226:227]
    v_pk_fma_f32 v[164:165], v[164:165], v[236:237], v[228:229]
    v_pk_fma_f32 v[166:167], v[166:167], v[238:239], v[230:231]
    v_pk_fma_f32 v[168:169], v[168:169], v[232:233], v[224:225]
    v_pk_fma_f32 v[170:171], v[170:171], v[234:235], v[226:227]
    v_pk_fma_f32 v[172:173], v[172:173], v[236:237], v[228:229]
    v_pk_fma_f32 v[174:175], v[174:175], v[238:239], v[230:231]
    v_pk_fma_f32 v[176:177], v[176:177], v[232:233], v[224:225]
    v_pk_fma_f32 v[178:179], v[178:179], v[234:235], v[226:227]
    v_pk_fma_f32 v[180:181], v[180:181], v[236:237], v[228:229]
    v_pk_fma_f32 v[182:183], v[182:183], v[238:239], v[230:231]
    v_pk_fma_f32 v[184:185], v[184:185], v[232:233], v[224:225]
    v_pk_fma_f32 v[186:187], v[186:187], v[234:235], v[226:227]
    v_pk_fma_f32 v[188:189], v[188:189], v[236:237], v[228:229]
    v_pk_fma_f32 v[190:191], v[190:191], v[238:239], v[230:231]
    v_pk_fma_f32 v[16:17], v[16:17], v[232:233], v[224:225]
    v_pk_fma_f32 v[18:19], v[18:19], v[234:235], v[226:227]
    v_pk_fma_f32 v[20:21], v[20:21], v[236:237], v[228:229]
    v_pk_fma_f32 v[22:23], v[22:23], v[238:239], v[230:231]
    v_cvt_pk_bf16_f32 v160, v160, v164
    v_cvt_pk_bf16_f32 v161, v161, v165
    v_cvt_pk_bf16_f32 v162, v162, v166
    v_cvt_pk_bf16_f32 v163, v163, v167
    ds_write_b128 v104, v[160:163]
    v_cvt_pk_bf16_f32 v168, v168, v172
    v_cvt_pk_bf16_f32 v169, v169, v173
    v_cvt_pk_bf16_f32 v170, v170, v174
    v_cvt_pk_bf16_f32 v171, v171, v175
    ds_write_b128 v105, v[168:171] offset:1024
    v_cvt_pk_bf16_f32 v176, v176, v180
    v_cvt_pk_bf16_f32 v177, v177, v181
    v_cvt_pk_bf16_f32 v178, v178, v182
    v_cvt_pk_bf16_f32 v179, v179, v183
    ds_write_b128 v106, v[176:179] offset:2048
    v_cvt_pk_bf16_f32 v184, v184, v188
    v_cvt_pk_bf16_f32 v185, v185, v189
    v_cvt_pk_bf16_f32 v186, v186, v190
    v_cvt_pk_bf16_f32 v187, v187, v191
    ds_write_b128 v107, v[184:187] offset:3072
    v_cvt_pk_bf16_f32 v16, v16, v20
    v_cvt_pk_bf16_f32 v17, v17, v21
    v_cvt_pk_bf16_f32 v18, v18, v22
    v_cvt_pk_bf16_f32 v19, v19, v23
    ds_write_b128 v104, v[16:19] offset:4096
    ds_inc_u32 v109, v109
    s_setprio 2
    ds_read_b128 v[224:227], v13 offset:512
    ds_read_b128 v[228:231], v13 offset:1536
    ds_read_b128 v[232:235], v13 offset:2560
    ds_read_b128 v[236:239], v13 offset:3584
    s_waitcnt lgkmcnt(11)
    v_readfirstlane_b32 s77, v10
    v_pk_fma_f32 v[24:25], v[24:25], v[248:249], v[240:241]
    v_pk_fma_f32 v[26:27], v[26:27], v[250:251], v[242:243]
    v_pk_fma_f32 v[28:29], v[28:29], v[252:253], v[244:245]
    v_pk_fma_f32 v[30:31], v[30:31], v[254:255], v[246:247]
    v_pk_fma_f32 v[32:33], v[32:33], v[248:249], v[240:241]
    v_pk_fma_f32 v[34:35], v[34:35], v[250:251], v[242:243]
    v_pk_fma_f32 v[36:37], v[36:37], v[252:253], v[244:245]
    v_pk_fma_f32 v[38:39], v[38:39], v[254:255], v[246:247]
    v_pk_fma_f32 v[40:41], v[40:41], v[248:249], v[240:241]
    v_pk_fma_f32 v[42:43], v[42:43], v[250:251], v[242:243]
    v_pk_fma_f32 v[44:45], v[44:45], v[252:253], v[244:245]
    v_pk_fma_f32 v[46:47], v[46:47], v[254:255], v[246:247]
    v_pk_fma_f32 v[48:49], v[48:49], v[248:249], v[240:241]
    v_pk_fma_f32 v[50:51], v[50:51], v[250:251], v[242:243]
    v_pk_fma_f32 v[52:53], v[52:53], v[252:253], v[244:245]
    v_pk_fma_f32 v[54:55], v[54:55], v[254:255], v[246:247]
    v_pk_fma_f32 v[56:57], v[56:57], v[248:249], v[240:241]
    v_pk_fma_f32 v[58:59], v[58:59], v[250:251], v[242:243]
    v_pk_fma_f32 v[60:61], v[60:61], v[252:253], v[244:245]
    v_pk_fma_f32 v[62:63], v[62:63], v[254:255], v[246:247]
    ds_read_b32 v110, v108
    ds_read_b128 v[240:243], v13 offset:768
    ds_read_b128 v[244:247], v13 offset:1792
    ds_read_b128 v[248:251], v13 offset:2816
    ds_read_b128 v[252:255], v13 offset:3840
    s_waitcnt lgkmcnt(15)
    v_cmp_gt_u32 vcc, 2, v0
    s_cbranch_vccnz SLOW_adaLN_cond__sliding_local_dilated__glu_gated_reglu__prompt_kernel_6
BACK_adaLN_cond__sliding_local_dilated__glu_gated_reglu__prompt_kernel_7:
    s_waitcnt lgkmcnt(4)
    v_cmp_gt_u32 vcc, 1, v110
    s_cbranch_vccnz SLOW_adaLN_cond__sliding_local_dilated__glu_gated_reglu__prompt_kernel_8
BACK_adaLN_cond__sliding_local_dilated__glu_gated_reglu__prompt_kernel_9:
    ds_read_b64_tr_b16 v[164:165], v1 offset:25600
    ds_read_b64_tr_b16 v[166:167], v1 offset:26112
    ds_read_b128 v[172:175], v4
    ds_read_b64_tr_b16 v[168:169], v1 offset:26624
    ds_read_b64_tr_b16 v[170:171], v1 offset:27136
    ds_read_b128 v[176:179], v4 offset:4096
    ds_read_b64_tr_b16 v[160:161], v1 offset:24576
    ds_read_b64_tr_b16 v[162:163], v1 offset:25088
    ds_read_b128 v[180:183], v4 offset:8192
    ds_read_b128 v[184:187], v4 offset:12288
    ds_read_b128 v[188:191], v4 offset:16384
    ds_inc_u32 v109, v109
    v_cvt_pk_bf16_f32 v24, v24, v28
    v_cvt_pk_bf16_f32 v25, v25, v29
    v_cvt_pk_bf16_f32 v26, v26, v30
    v_cvt_pk_bf16_f32 v27, v27, v31
    ds_write_b128 v104, v[24:27] offset:20480
    v_cvt_pk_bf16_f32 v32, v32, v36
    v_cvt_pk_bf16_f32 v33, v33, v37
    v_cvt_pk_bf16_f32 v34, v34, v38
    v_cvt_pk_bf16_f32 v35, v35, v39
    ds_write_b128 v105, v[32:35] offset:21504
    v_cvt_pk_bf16_f32 v40, v40, v44
    v_cvt_pk_bf16_f32 v41, v41, v45
    v_cvt_pk_bf16_f32 v42, v42, v46
    v_cvt_pk_bf16_f32 v43, v43, v47
    ds_write_b128 v106, v[40:43] offset:22528
    v_cvt_pk_bf16_f32 v48, v48, v52
    v_cvt_pk_bf16_f32 v49, v49, v53
    v_cvt_pk_bf16_f32 v50, v50, v54
    v_cvt_pk_bf16_f32 v51, v51, v55
    ds_write_b128 v107, v[48:51] offset:23552
    v_cvt_pk_bf16_f32 v56, v56, v60
    v_cvt_pk_bf16_f32 v57, v57, v61
    v_cvt_pk_bf16_f32 v58, v58, v62
    v_cvt_pk_bf16_f32 v59, v59, v63
    ds_write_b128 v104, v[56:59] offset:24576
    s_waitcnt lgkmcnt(11)
    v_mfma_f32_16x16x32_bf16 v[16:19], v[164:167], v[172:175], 0
    ds_read_b64_tr_b16 v[196:197], v1 offset:37888
    v_fma_f32 v120, v120, v232, v224
    v_mfma_f32_16x16x32_bf16 v[36:39], v[172:175], v[168:171], 0
    ds_read_b64_tr_b16 v[198:199], v1 offset:38400
    v_fma_f32 v121, v121, v233, v225
    v_mfma_f32_16x16x32_bf16 v[20:23], v[164:167], v[176:179], 0
    ds_read_b128 v[204:207], v5
    v_fma_f32 v122, v122, v234, v226
    v_mfma_f32_16x16x32_bf16 v[40:43], v[176:179], v[168:171], 0
    ds_read_b64_tr_b16 v[200:201], v1 offset:38912
    v_fma_f32 v123, v123, v235, v227
    s_waitcnt lgkmcnt(10)
    v_mfma_f32_16x16x32_bf16 v[56:59], v[160:163], v[176:179], 0
    ds_read_b64_tr_b16 v[202:203], v1 offset:39424
    v_fma_f32 v124, v124, v236, v228
    v_mfma_f32_16x16x32_bf16 v[24:27], v[164:167], v[180:183], 0
    ds_read_b128 v[208:211], v5 offset:4096
    v_fma_f32 v125, v125, v237, v229
    v_mfma_f32_16x16x32_bf16 v[44:47], v[180:183], v[168:171], 0
    ds_read_b64_tr_b16 v[192:193], v1 offset:36864
    v_fma_f32 v126, v126, v238, v230
    v_mfma_f32_16x16x32_bf16 v[60:63], v[160:163], v[180:183], 0
    ds_read_b64_tr_b16 v[194:195], v1 offset:37376
    v_fma_f32 v127, v127, v239, v231
    v_mfma_f32_16x16x32_bf16 v[28:31], v[164:167], v[184:187], 0
    ds_read_b128 v[212:215], v5 offset:8192
    ds_read_b32 v0, v108 offset:1024
    v_mfma_f32_16x16x32_bf16 v[48:51], v[184:187], v[168:171], 0
    ds_read_b128 v[216:219], v5 offset:12288
    v_fma_f32 v128, v128, v232, v224
    v_mfma_f32_16x16x32_bf16 v[64:67], v[160:163], v[184:187], 0
    ds_read_b128 v[220:223], v5 offset:16384
    ds_inc_u32 v109, v109
    v_mfma_f32_16x16x32_bf16 v[32:35], v[164:167], v[188:191], 0
    v_fma_f32 v129, v129, v233, v225
    v_fma_f32 v130, v130, v234, v226
    v_mfma_f32_16x16x32_bf16 v[52:55], v[188:191], v[168:171], 0
    v_fma_f32 v131, v131, v235, v227
    v_fma_f32 v132, v132, v236, v228
    v_mfma_f32_16x16x32_bf16 v[68:71], v[160:163], v[188:191], 0
    v_fma_f32 v133, v133, v237, v229
    v_fma_f32 v134, v134, v238, v230
    s_waitcnt lgkmcnt(7)
    v_mfma_f32_16x16x32_bf16 v[16:19], v[196:199], v[204:207], v[16:19]
    s_waitcnt lgkmcnt(3)
    v_cmp_gt_u32 vcc, 4, v0
    s_cbranch_vccnz SLOW_adaLN_cond__sliding_local_dilated__glu_gated_reglu__prompt_kernel_10
BACK_adaLN_cond__sliding_local_dilated__glu_gated_reglu__prompt_kernel_11:
    ds_read_b64_tr_b16 v[164:165], v1 offset:50176
    v_fma_f32 v135, v135, v239, v231
    v_mfma_f32_16x16x32_bf16 v[36:39], v[204:207], v[200:203], v[36:39]
    ds_read_b64_tr_b16 v[166:167], v1 offset:50688
    v_fma_f32 v136, v136, v232, v224
    v_mfma_f32_16x16x32_bf16 v[20:23], v[196:199], v[208:211], v[20:23]
    ds_read_b128 v[172:175], v6
    v_fma_f32 v137, v137, v233, v225
    v_mfma_f32_16x16x32_bf16 v[40:43], v[208:211], v[200:203], v[40:43]
    ds_read_b64_tr_b16 v[168:169], v1 offset:51200
    v_fma_f32 v138, v138, v234, v226
    s_waitcnt lgkmcnt(5)
    v_mfma_f32_16x16x32_bf16 v[56:59], v[192:195], v[208:211], v[56:59]
    ds_read_b64_tr_b16 v[170:171], v1 offset:51712
    v_fma_f32 v139, v139, v235, v227
    v_mfma_f32_16x16x32_bf16 v[24:27], v[196:199], v[212:215], v[24:27]
    ds_read_b128 v[176:179], v6 offset:4096
    v_fma_f32 v140, v140, v236, v228
    v_mfma_f32_16x16x32_bf16 v[44:47], v[212:215], v[200:203], v[44:47]
    ds_read_b64_tr_b16 v[160:161], v1 offset:49152
    v_fma_f32 v141, v141, v237, v229
    v_mfma_f32_16x16x32_bf16 v[60:63], v[192:195], v[212:215], v[60:63]
    ds_read_b64_tr_b16 v[162:163], v1 offset:49664
    v_fma_f32 v142, v142, v238, v230
    v_mfma_f32_16x16x32_bf16 v[28:31], v[196:199], v[216:219], v[28:31]
    ds_read_b128 v[180:183], v6 offset:8192
    v_fma_f32 v143, v143, v239, v231
    v_mfma_f32_16x16x32_bf16 v[48:51], v[216:219], v[200:203], v[48:51]
    ds_read_b128 v[184:187], v6 offset:12288
    v_fma_f32 v144, v144, v232, v224
    v_mfma_f32_16x16x32_bf16 v[64:67], v[192:195], v[216:219], v[64:67]
    ds_read_b128 v[188:191], v6 offset:16384
    ds_inc_u32 v109, v109
    v_mfma_f32_16x16x32_bf16 v[32:35], v[196:199], v[220:223], v[32:35]
    v_fma_f32 v145, v145, v233, v225
    v_fma_f32 v146, v146, v234, v226
    v_mfma_f32_16x16x32_bf16 v[52:55], v[220:223], v[200:203], v[52:55]
    v_fma_f32 v147, v147, v235, v227
    v_fma_f32 v148, v148, v236, v228
    v_mfma_f32_16x16x32_bf16 v[68:71], v[192:195], v[220:223], v[68:71]
    v_fma_f32 v149, v149, v237, v229
    v_fma_f32 v150, v150, v238, v230
    s_waitcnt lgkmcnt(6)
    v_mfma_f32_16x16x32_bf16 v[16:19], v[164:167], v[172:175], v[16:19]
    ds_read_b64_tr_b16 v[196:197], v14 offset:1024
    v_fma_f32 v151, v151, v239, v231
    v_mfma_f32_16x16x32_bf16 v[36:39], v[172:175], v[168:171], v[36:39]
    ds_read_b64_tr_b16 v[198:199], v14 offset:1536
    v_fma_f32 v152, v152, v232, v224
    v_mfma_f32_16x16x32_bf16 v[20:23], v[164:167], v[176:179], v[20:23]
    ds_read_b128 v[204:207], v7
    v_fma_f32 v153, v153, v233, v225
    v_mfma_f32_16x16x32_bf16 v[40:43], v[176:179], v[168:171], v[40:43]
    ds_read_b64_tr_b16 v[200:201], v14 offset:2048
    v_fma_f32 v154, v154, v234, v226
    s_waitcnt lgkmcnt(5)
    v_mfma_f32_16x16x32_bf16 v[56:59], v[160:163], v[176:179], v[56:59]
    ds_read_b64_tr_b16 v[202:203], v14 offset:2560
    v_fma_f32 v155, v155, v235, v227
    v_mfma_f32_16x16x32_bf16 v[24:27], v[164:167], v[180:183], v[24:27]
    ds_read_b128 v[208:211], v7 offset:4096
    v_fma_f32 v156, v156, v236, v228
    v_mfma_f32_16x16x32_bf16 v[44:47], v[180:183], v[168:171], v[44:47]
    ds_read_b64_tr_b16 v[192:193], v14
    v_fma_f32 v157, v157, v237, v229
    v_mfma_f32_16x16x32_bf16 v[60:63], v[160:163], v[180:183], v[60:63]
    ds_read_b64_tr_b16 v[194:195], v14 offset:512
    v_fma_f32 v158, v158, v238, v230
    v_mfma_f32_16x16x32_bf16 v[28:31], v[164:167], v[184:187], v[28:31]
    ds_read_b128 v[212:215], v7 offset:8192
    ds_read_b32 v0, v108 offset:1024
    v_mfma_f32_16x16x32_bf16 v[48:51], v[184:187], v[168:171], v[48:51]
    ds_read_b128 v[216:219], v7 offset:12288
    ds_read_b32 v110, v108
    v_mfma_f32_16x16x32_bf16 v[64:67], v[160:163], v[184:187], v[64:67]
    ds_read_b128 v[220:223], v7 offset:16384
    ds_inc_u32 v109, v109
    v_mfma_f32_16x16x32_bf16 v[32:35], v[164:167], v[188:191], v[32:35]
    v_fma_f32 v159, v159, v239, v231
    v_cvt_pk_bf16_f32 v120, v120, v124
    v_mfma_f32_16x16x32_bf16 v[52:55], v[188:191], v[168:171], v[52:55]
    v_cvt_pk_bf16_f32 v121, v121, v125
    v_cvt_pk_bf16_f32 v122, v122, v126
    v_mfma_f32_16x16x32_bf16 v[68:71], v[160:163], v[188:191], v[68:71]
    v_cvt_pk_bf16_f32 v123, v123, v127
    v_cvt_pk_bf16_f32 v128, v128, v132
    s_waitcnt lgkmcnt(8)
    v_mfma_f32_16x16x32_bf16 v[16:19], v[196:199], v[204:207], v[16:19]
    s_waitcnt lgkmcnt(4)
    v_cmp_gt_u32 vcc, 6, v0
    s_cbranch_vccnz SLOW_adaLN_cond__sliding_local_dilated__glu_gated_reglu__prompt_kernel_12
BACK_adaLN_cond__sliding_local_dilated__glu_gated_reglu__prompt_kernel_13:
    s_waitcnt lgkmcnt(2)
    v_cmp_gt_u32 vcc, 4, v110
    s_cbranch_vccnz SLOW_adaLN_cond__sliding_local_dilated__glu_gated_reglu__prompt_kernel_14
BACK_adaLN_cond__sliding_local_dilated__glu_gated_reglu__prompt_kernel_15:
    ds_read_b64_tr_b16 v[164:165], v14 offset:13312
    v_cvt_pk_bf16_f32 v129, v129, v133
    v_mfma_f32_16x16x32_bf16 v[36:39], v[204:207], v[200:203], v[36:39]
    ds_read_b64_tr_b16 v[166:167], v14 offset:13824
    v_cvt_pk_bf16_f32 v130, v130, v134
    v_mfma_f32_16x16x32_bf16 v[20:23], v[196:199], v[208:211], v[20:23]
    ds_read_b128 v[172:175], v4 offset:20480
    v_cvt_pk_bf16_f32 v131, v131, v135
    v_mfma_f32_16x16x32_bf16 v[40:43], v[208:211], v[200:203], v[40:43]
    ds_read_b64_tr_b16 v[168:169], v14 offset:14336
    v_cvt_pk_bf16_f32 v136, v136, v140
    s_waitcnt lgkmcnt(5)
    v_mfma_f32_16x16x32_bf16 v[56:59], v[192:195], v[208:211], v[56:59]
    ds_read_b64_tr_b16 v[170:171], v14 offset:14848
    v_cvt_pk_bf16_f32 v137, v137, v141
    v_mfma_f32_16x16x32_bf16 v[24:27], v[196:199], v[212:215], v[24:27]
    ds_read_b128 v[176:179], v4 offset:24576
    v_cvt_pk_bf16_f32 v138, v138, v142
    v_mfma_f32_16x16x32_bf16 v[44:47], v[212:215], v[200:203], v[44:47]
    ds_read_b64_tr_b16 v[160:161], v14 offset:12288
    v_cvt_pk_bf16_f32 v139, v139, v143
    v_mfma_f32_16x16x32_bf16 v[60:63], v[192:195], v[212:215], v[60:63]
    ds_read_b64_tr_b16 v[162:163], v14 offset:12800
    v_cvt_pk_bf16_f32 v144, v144, v148
    v_mfma_f32_16x16x32_bf16 v[28:31], v[196:199], v[216:219], v[28:31]
    ds_read_b128 v[180:183], v4 offset:28672
    v_cvt_pk_bf16_f32 v145, v145, v149
    v_mfma_f32_16x16x32_bf16 v[48:51], v[216:219], v[200:203], v[48:51]
    ds_read_b128 v[184:187], v4 offset:32768
    ds_read_b32 v110, v108
    v_mfma_f32_16x16x32_bf16 v[64:67], v[192:195], v[216:219], v[64:67]
    ds_read_b128 v[188:191], v4 offset:36864
    ds_inc_u32 v109, v109
    v_mfma_f32_16x16x32_bf16 v[32:35], v[196:199], v[220:223], v[32:35]
    v_cvt_pk_bf16_f32 v146, v146, v150
    v_cvt_pk_bf16_f32 v147, v147, v151
    v_mfma_f32_16x16x32_bf16 v[52:55], v[220:223], v[200:203], v[52:55]
    v_cvt_pk_bf16_f32 v152, v152, v156
    v_cvt_pk_bf16_f32 v153, v153, v157
    v_mfma_f32_16x16x32_bf16 v[68:71], v[192:195], v[220:223], v[68:71]
    v_cvt_pk_bf16_f32 v154, v154, v158
    v_cvt_pk_bf16_f32 v155, v155, v159
    s_waitcnt lgkmcnt(7)
    v_mfma_f32_16x16x32_bf16 v[16:19], v[164:167], v[172:175], v[16:19]
    s_waitcnt lgkmcnt(2)
    v_cmp_gt_u32 vcc, 5, v110
    s_cbranch_vccnz SLOW_adaLN_cond__sliding_local_dilated__glu_gated_reglu__prompt_kernel_16
BACK_adaLN_cond__sliding_local_dilated__glu_gated_reglu__prompt_kernel_17:
    ds_read_b64_tr_b16 v[196:197], v14 offset:25600
    v_fma_f32 v72, v72, v248, v240
    v_mfma_f32_16x16x32_bf16 v[36:39], v[172:175], v[168:171], v[36:39]
    ds_read_b64_tr_b16 v[198:199], v14 offset:26112
    ds_write_b128 v104, v[120:123]
    v_mfma_f32_16x16x32_bf16 v[20:23], v[164:167], v[176:179], v[20:23]
    ds_read_b128 v[204:207], v5 offset:20480
    v_fma_f32 v73, v73, v249, v241
    v_mfma_f32_16x16x32_bf16 v[40:43], v[176:179], v[168:171], v[40:43]
    ds_read_b64_tr_b16 v[200:201], v14 offset:26624
    ds_write_b128 v105, v[128:131] offset:1024
    s_waitcnt lgkmcnt(7)
    v_mfma_f32_16x16x32_bf16 v[56:59], v[160:163], v[176:179], v[56:59]
    ds_read_b64_tr_b16 v[202:203], v14 offset:27136
    v_fma_f32 v74, v74, v250, v242
    v_mfma_f32_16x16x32_bf16 v[24:27], v[164:167], v[180:183], v[24:27]
    ds_read_b128 v[208:211], v5 offset:24576
    ds_write_b128 v106, v[136:139] offset:2048
    v_mfma_f32_16x16x32_bf16 v[44:47], v[180:183], v[168:171], v[44:47]
    ds_read_b64_tr_b16 v[192:193], v14 offset:24576
    v_fma_f32 v75, v75, v251, v243
    v_mfma_f32_16x16x32_bf16 v[60:63], v[160:163], v[180:183], v[60:63]
    ds_read_b64_tr_b16 v[194:195], v14 offset:25088
    ds_write_b128 v107, v[144:147] offset:3072
    v_mfma_f32_16x16x32_bf16 v[28:31], v[164:167], v[184:187], v[28:31]
    ds_read_b128 v[212:215], v5 offset:28672
    ds_read_b32 v0, v108 offset:1024
    v_mfma_f32_16x16x32_bf16 v[48:51], v[184:187], v[168:171], v[48:51]
    ds_read_b128 v[216:219], v5 offset:32768
    ds_write_b128 v104, v[152:155] offset:4096
    v_mfma_f32_16x16x32_bf16 v[64:67], v[160:163], v[184:187], v[64:67]
    ds_read_b128 v[220:223], v5 offset:36864
    ds_inc_u32 v109, v109
    v_mfma_f32_16x16x32_bf16 v[32:35], v[164:167], v[188:191], v[32:35]
    ds_inc_u32 v109, v109
    v_fma_f32 v76, v76, v252, v244
    v_mfma_f32_16x16x32_bf16 v[52:55], v[188:191], v[168:171], v[52:55]
    v_fma_f32 v77, v77, v253, v245
    v_fma_f32 v78, v78, v254, v246
    v_mfma_f32_16x16x32_bf16 v[68:71], v[160:163], v[188:191], v[68:71]
    v_fma_f32 v79, v79, v255, v247
    v_fma_f32 v80, v80, v248, v240
    s_waitcnt lgkmcnt(11)
    v_mfma_f32_16x16x32_bf16 v[16:19], v[196:199], v[204:207], v[16:19]
    s_waitcnt lgkmcnt(5)
    v_cmp_gt_u32 vcc, 9, v0
    s_cbranch_vccnz SLOW_adaLN_cond__sliding_local_dilated__glu_gated_reglu__prompt_kernel_18
BACK_adaLN_cond__sliding_local_dilated__glu_gated_reglu__prompt_kernel_19:
    ds_read_b64_tr_b16 v[164:165], v14 offset:37888
    v_fma_f32 v81, v81, v249, v241
    v_mfma_f32_16x16x32_bf16 v[36:39], v[204:207], v[200:203], v[36:39]
    ds_read_b64_tr_b16 v[166:167], v14 offset:38400
    v_fma_f32 v82, v82, v250, v242
    v_mfma_f32_16x16x32_bf16 v[20:23], v[196:199], v[208:211], v[20:23]
    ds_read_b128 v[172:175], v6 offset:20480
    v_fma_f32 v83, v83, v251, v243
    v_mfma_f32_16x16x32_bf16 v[40:43], v[208:211], v[200:203], v[40:43]
    ds_read_b64_tr_b16 v[168:169], v14 offset:38912
    v_fma_f32 v84, v84, v252, v244
    s_waitcnt lgkmcnt(6)
    v_mfma_f32_16x16x32_bf16 v[56:59], v[192:195], v[208:211], v[56:59]
    ds_read_b64_tr_b16 v[170:171], v14 offset:39424
    v_fma_f32 v85, v85, v253, v245
    v_mfma_f32_16x16x32_bf16 v[24:27], v[196:199], v[212:215], v[24:27]
    ds_read_b128 v[176:179], v6 offset:24576
    v_fma_f32 v86, v86, v254, v246
    v_mfma_f32_16x16x32_bf16 v[44:47], v[212:215], v[200:203], v[44:47]
    ds_read_b64_tr_b16 v[160:161], v14 offset:36864
    v_fma_f32 v87, v87, v255, v247
    v_mfma_f32_16x16x32_bf16 v[60:63], v[192:195], v[212:215], v[60:63]
    ds_read_b64_tr_b16 v[162:163], v14 offset:37376
    v_fma_f32 v88, v88, v248, v240
    v_mfma_f32_16x16x32_bf16 v[28:31], v[196:199], v[216:219], v[28:31]
    ds_read_b128 v[180:183], v6 offset:28672
    v_fma_f32 v89, v89, v249, v241
    v_mfma_f32_16x16x32_bf16 v[48:51], v[216:219], v[200:203], v[48:51]
    ds_read_b128 v[184:187], v6 offset:32768
    v_fma_f32 v90, v90, v250, v242
    v_mfma_f32_16x16x32_bf16 v[64:67], v[192:195], v[216:219], v[64:67]
    ds_read_b128 v[188:191], v6 offset:36864
    ds_inc_u32 v109, v109
    v_mfma_f32_16x16x32_bf16 v[32:35], v[196:199], v[220:223], v[32:35]
    v_fma_f32 v91, v91, v251, v243
    v_fma_f32 v92, v92, v252, v244
    v_mfma_f32_16x16x32_bf16 v[52:55], v[220:223], v[200:203], v[52:55]
    v_fma_f32 v93, v93, v253, v245
    v_fma_f32 v94, v94, v254, v246
    v_mfma_f32_16x16x32_bf16 v[68:71], v[192:195], v[220:223], v[68:71]
    v_fma_f32 v95, v95, v255, v247
    v_fma_f32 v96, v96, v248, v240
    s_waitcnt lgkmcnt(6)
    v_mfma_f32_16x16x32_bf16 v[16:19], v[164:167], v[172:175], v[16:19]
    ds_read_b64_tr_b16 v[196:197], v1 offset:1024
    v_fma_f32 v97, v97, v249, v241
    v_mfma_f32_16x16x32_bf16 v[36:39], v[172:175], v[168:171], v[36:39]
    ds_read_b64_tr_b16 v[198:199], v1 offset:1536
    v_fma_f32 v98, v98, v250, v242
    v_mfma_f32_16x16x32_bf16 v[20:23], v[164:167], v[176:179], v[20:23]
    ds_read_b128 v[204:207], v7 offset:20480
    v_fma_f32 v99, v99, v251, v243
    v_mfma_f32_16x16x32_bf16 v[40:43], v[176:179], v[168:171], v[40:43]
    ds_read_b64_tr_b16 v[200:201], v1 offset:2048
    v_fma_f32 v100, v100, v252, v244
    s_waitcnt lgkmcnt(5)
    v_mfma_f32_16x16x32_bf16 v[56:59], v[160:163], v[176:179], v[56:59]
    ds_read_b64_tr_b16 v[202:203], v1 offset:2560
    v_fma_f32 v101, v101, v253, v245
    v_mfma_f32_16x16x32_bf16 v[24:27], v[164:167], v[180:183], v[24:27]
    ds_read_b128 v[208:211], v7 offset:24576
    v_fma_f32 v102, v102, v254, v246
    v_mfma_f32_16x16x32_bf16 v[44:47], v[180:183], v[168:171], v[44:47]
    ds_read_b64_tr_b16 v[192:193], v1
    v_fma_f32 v103, v103, v255, v247
    v_mfma_f32_16x16x32_bf16 v[60:63], v[160:163], v[180:183], v[60:63]
    ds_read_b64_tr_b16 v[194:195], v1 offset:512
    v_fma_f32 v112, v112, v248, v240
    v_mfma_f32_16x16x32_bf16 v[28:31], v[164:167], v[184:187], v[28:31]
    ds_read_b128 v[212:215], v7 offset:28672
    v_fma_f32 v113, v113, v249, v241
    v_mfma_f32_16x16x32_bf16 v[48:51], v[184:187], v[168:171], v[48:51]
    ds_read_b128 v[216:219], v7 offset:32768
    ds_read_b32 v110, v108
    v_mfma_f32_16x16x32_bf16 v[64:67], v[160:163], v[184:187], v[64:67]
    ds_read_b128 v[220:223], v7 offset:36864
    ds_inc_u32 v109, v109
    v_mfma_f32_16x16x32_bf16 v[32:35], v[164:167], v[188:191], v[32:35]
    v_fma_f32 v114, v114, v250, v242
    v_fma_f32 v115, v115, v251, v243
    v_mfma_f32_16x16x32_bf16 v[52:55], v[188:191], v[168:171], v[52:55]
    v_fma_f32 v116, v116, v252, v244
    v_fma_f32 v117, v117, v253, v245
    v_mfma_f32_16x16x32_bf16 v[68:71], v[160:163], v[188:191], v[68:71]
    v_fma_f32 v118, v118, v254, v246
    v_fma_f32 v119, v119, v255, v247
    s_waitcnt lgkmcnt(7)
    v_mfma_f32_16x16x32_bf16 v[16:19], v[196:199], v[204:207], v[16:19]
    s_waitcnt lgkmcnt(2)
    v_cmp_gt_u32 vcc, 8, v110
    s_cbranch_vccnz SLOW_adaLN_cond__sliding_local_dilated__glu_gated_reglu__prompt_kernel_20
BACK_adaLN_cond__sliding_local_dilated__glu_gated_reglu__prompt_kernel_21:
    ds_read_b64_tr_b16 v[164:165], v1 offset:13312
    v_cvt_pk_bf16_f32 v72, v72, v76
    v_mfma_f32_16x16x32_bf16 v[36:39], v[204:207], v[200:203], v[36:39]
    ds_read_b64_tr_b16 v[166:167], v1 offset:13824
    v_cvt_pk_bf16_f32 v73, v73, v77
    v_mfma_f32_16x16x32_bf16 v[20:23], v[196:199], v[208:211], v[20:23]
    ds_read_b128 v[172:175], v4
    v_cvt_pk_bf16_f32 v74, v74, v78
    v_mfma_f32_16x16x32_bf16 v[40:43], v[208:211], v[200:203], v[40:43]
    ds_read_b64_tr_b16 v[168:169], v1 offset:14336
    v_cvt_pk_bf16_f32 v75, v75, v79
    s_waitcnt lgkmcnt(5)
    v_mfma_f32_16x16x32_bf16 v[56:59], v[192:195], v[208:211], v[56:59]
    ds_read_b64_tr_b16 v[170:171], v1 offset:14848
    v_cvt_pk_bf16_f32 v80, v80, v84
    v_mfma_f32_16x16x32_bf16 v[24:27], v[196:199], v[212:215], v[24:27]
    ds_read_b128 v[176:179], v4 offset:4096
    v_cvt_pk_bf16_f32 v81, v81, v85
    v_mfma_f32_16x16x32_bf16 v[44:47], v[212:215], v[200:203], v[44:47]
    ds_read_b64_tr_b16 v[160:161], v1 offset:12288
    v_cvt_pk_bf16_f32 v82, v82, v86
    v_mfma_f32_16x16x32_bf16 v[60:63], v[192:195], v[212:215], v[60:63]
    ds_read_b64_tr_b16 v[162:163], v1 offset:12800
    v_cvt_pk_bf16_f32 v83, v83, v87
    v_mfma_f32_16x16x32_bf16 v[28:31], v[196:199], v[216:219], v[28:31]
    ds_read_b128 v[180:183], v4 offset:8192
    ds_read_b32 v0, v108 offset:1024
    v_mfma_f32_16x16x32_bf16 v[48:51], v[216:219], v[200:203], v[48:51]
    ds_read_b128 v[184:187], v4 offset:12288
    ds_read_b32 v110, v108
    v_mfma_f32_16x16x32_bf16 v[64:67], v[192:195], v[216:219], v[64:67]
    ds_read_b128 v[188:191], v4 offset:16384
    ds_inc_u32 v109, v109
    v_mfma_f32_16x16x32_bf16 v[32:35], v[196:199], v[220:223], v[32:35]
    v_cvt_pk_bf16_f32 v88, v88, v92
    v_cvt_pk_bf16_f32 v89, v89, v93
    v_mfma_f32_16x16x32_bf16 v[52:55], v[220:223], v[200:203], v[52:55]
    v_cvt_pk_bf16_f32 v90, v90, v94
    v_cvt_pk_bf16_f32 v91, v91, v95
    v_mfma_f32_16x16x32_bf16 v[68:71], v[192:195], v[220:223], v[68:71]
    v_cvt_pk_bf16_f32 v96, v96, v100
    v_cvt_pk_bf16_f32 v97, v97, v101
    s_waitcnt lgkmcnt(8)
    v_mfma_f32_16x16x32_bf16 v[16:19], v[164:167], v[172:175], v[16:19]
    s_waitcnt lgkmcnt(4)
    v_cmp_gt_u32 vcc, 10, v0
    s_cbranch_vccnz SLOW_adaLN_cond__sliding_local_dilated__glu_gated_reglu__prompt_kernel_22
BACK_adaLN_cond__sliding_local_dilated__glu_gated_reglu__prompt_kernel_23:
    s_waitcnt lgkmcnt(2)
    v_cmp_gt_u32 vcc, 10, v110
    s_cbranch_vccnz SLOW_adaLN_cond__sliding_local_dilated__glu_gated_reglu__prompt_kernel_24
BACK_adaLN_cond__sliding_local_dilated__glu_gated_reglu__prompt_kernel_25:
    ds_read_b64_tr_b16 v[196:197], v1 offset:25600
    v_cvt_pk_bf16_f32 v98, v98, v102
    v_mfma_f32_16x16x32_bf16 v[36:39], v[172:175], v[168:171], v[36:39]
    ds_read_b64_tr_b16 v[198:199], v1 offset:26112
    v_cvt_pk_bf16_f32 v99, v99, v103
    v_mfma_f32_16x16x32_bf16 v[20:23], v[164:167], v[176:179], v[20:23]
    ds_read_b128 v[204:207], v5
    v_cvt_pk_bf16_f32 v112, v112, v116
    v_mfma_f32_16x16x32_bf16 v[40:43], v[176:179], v[168:171], v[40:43]
    ds_read_b64_tr_b16 v[200:201], v1 offset:26624
    v_cvt_pk_bf16_f32 v113, v113, v117
    s_waitcnt lgkmcnt(5)
    v_mfma_f32_16x16x32_bf16 v[56:59], v[160:163], v[176:179], v[56:59]
    ds_read_b64_tr_b16 v[202:203], v1 offset:27136
    v_cvt_pk_bf16_f32 v114, v114, v118
    v_mfma_f32_16x16x32_bf16 v[24:27], v[164:167], v[180:183], v[24:27]
    ds_read_b128 v[208:211], v5 offset:4096
    v_cvt_pk_bf16_f32 v115, v115, v119
    v_mfma_f32_16x16x32_bf16 v[44:47], v[180:183], v[168:171], v[44:47]
    ds_read_b64_tr_b16 v[192:193], v1 offset:24576
    v_mfma_f32_16x16x32_bf16 v[60:63], v[160:163], v[180:183], v[60:63]
    ds_read_b64_tr_b16 v[194:195], v1 offset:25088
    ds_write_b128 v104, v[72:75] offset:20480
    v_mfma_f32_16x16x32_bf16 v[28:31], v[164:167], v[184:187], v[28:31]
    ds_read_b128 v[212:215], v5 offset:8192
    ds_read_b32 v0, v108 offset:1024
    v_mfma_f32_16x16x32_bf16 v[48:51], v[184:187], v[168:171], v[48:51]
    ds_read_b128 v[216:219], v5 offset:12288
    ds_write_b128 v105, v[80:83] offset:21504
    v_mfma_f32_16x16x32_bf16 v[64:67], v[160:163], v[184:187], v[64:67]
    ds_read_b128 v[220:223], v5 offset:16384
    ds_inc_u32 v109, v109
    v_mfma_f32_16x16x32_bf16 v[32:35], v[164:167], v[188:191], v[32:35]
    ds_write_b128 v106, v[88:91] offset:22528
    v_mfma_f32_16x16x32_bf16 v[52:55], v[188:191], v[168:171], v[52:55]
    v_mfma_f32_16x16x32_bf16 v[68:71], v[160:163], v[188:191], v[68:71]
    ds_write_b128 v107, v[96:99] offset:23552
    s_waitcnt lgkmcnt(11)
    v_mfma_f32_16x16x32_bf16 v[16:19], v[196:199], v[204:207], v[16:19]
    s_waitcnt lgkmcnt(6)
    v_cmp_gt_u32 vcc, 11, v0
    s_cbranch_vccnz SLOW_adaLN_cond__sliding_local_dilated__glu_gated_reglu__prompt_kernel_26
BACK_adaLN_cond__sliding_local_dilated__glu_gated_reglu__prompt_kernel_27:
    ds_read_b64_tr_b16 v[164:165], v1 offset:37888
    v_mfma_f32_16x16x32_bf16 v[36:39], v[204:207], v[200:203], v[36:39]
    ds_read_b64_tr_b16 v[166:167], v1 offset:38400
    ds_write_b128 v104, v[112:115] offset:24576
    v_mfma_f32_16x16x32_bf16 v[20:23], v[196:199], v[208:211], v[20:23]
    ds_read_b128 v[172:175], v6
    v_mfma_f32_16x16x32_bf16 v[40:43], v[208:211], v[200:203], v[40:43]
    ds_read_b64_tr_b16 v[168:169], v1 offset:38912
    ds_inc_u32 v109, v109
    s_waitcnt lgkmcnt(9)
    v_mfma_f32_16x16x32_bf16 v[56:59], v[192:195], v[208:211], v[56:59]
    v_lshlrev_b32 v12, 2, v2
    v_sub_u32 v12, v3, v12
    ds_read_b64_tr_b16 v[170:171], v1 offset:39424
    v_mfma_f32_16x16x32_bf16 v[24:27], v[196:199], v[212:215], v[24:27]
    ds_read_b128 v[176:179], v6 offset:4096
    v_mfma_f32_16x16x32_bf16 v[44:47], v[212:215], v[200:203], v[44:47]
    ds_read_b64_tr_b16 v[160:161], v1 offset:36864
    v_mfma_f32_16x16x32_bf16 v[60:63], v[192:195], v[212:215], v[60:63]
    v_mov_b32 v8, 0xf149f2ca
    ds_read_b64_tr_b16 v[162:163], v1 offset:37376
    v_mfma_f32_16x16x32_bf16 v[28:31], v[196:199], v[216:219], v[28:31]
    ds_read_b128 v[180:183], v6 offset:8192
    ds_read_b32 v0, v108 offset:1024
    v_mfma_f32_16x16x32_bf16 v[48:51], v[216:219], v[200:203], v[48:51]
    ds_read_b128 v[184:187], v6 offset:12288
    v_mfma_f32_16x16x32_bf16 v[64:67], v[192:195], v[216:219], v[64:67]
    v_subrev_u32 v13, 0, v12
    v_and_b32 v13, 0x80000001, v13
    ds_read_b128 v[188:191], v6 offset:16384
    ds_inc_u32 v109, v109
    v_mfma_f32_16x16x32_bf16 v[32:35], v[196:199], v[220:223], v[32:35]
    v_mfma_f32_16x16x32_bf16 v[52:55], v[220:223], v[200:203], v[52:55]
    v_mfma_f32_16x16x32_bf16 v[68:71], v[192:195], v[220:223], v[68:71]
    v_cmp_eq_u32 vcc, 0, v13
    s_nop 1
    v_cndmask_b32 v76, v8, 0, vcc
    s_waitcnt lgkmcnt(7)
    v_mfma_f32_16x16x32_bf16 v[16:19], v[164:167], v[172:175], v[16:19]
    s_waitcnt lgkmcnt(3)
    v_cmp_gt_u32 vcc, 12, v0
    s_cbranch_vccnz SLOW_adaLN_cond__sliding_local_dilated__glu_gated_reglu__prompt_kernel_28
BACK_adaLN_cond__sliding_local_dilated__glu_gated_reglu__prompt_kernel_29:
    ds_read_b64_tr_b16 v[196:197], v1 offset:50176
    v_mfma_f32_16x16x32_bf16 v[36:39], v[172:175], v[168:171], v[36:39]
    ds_read_b64_tr_b16 v[198:199], v1 offset:50688
    v_mfma_f32_16x16x32_bf16 v[20:23], v[164:167], v[176:179], v[20:23]
    v_cmp_eq_u32 vcc, 0x80000000, v13
    s_nop 1
    v_cndmask_b32 v72, v8, 0, vcc
    ds_read_b128 v[204:207], v7
    v_mfma_f32_16x16x32_bf16 v[40:43], v[176:179], v[168:171], v[40:43]
    ds_read_b64_tr_b16 v[200:201], v1 offset:51200
    s_waitcnt lgkmcnt(5)
    v_mfma_f32_16x16x32_bf16 v[56:59], v[160:163], v[176:179], v[56:59]
    ds_read_b64_tr_b16 v[202:203], v1 offset:51712
    v_mfma_f32_16x16x32_bf16 v[24:27], v[164:167], v[180:183], v[24:27]
    v_subrev_u32 v13, 1, v12
    v_and_b32 v13, 0x80000001, v13
    ds_read_b128 v[208:211], v7 offset:4096
    v_mfma_f32_16x16x32_bf16 v[44:47], v[180:183], v[168:171], v[44:47]
    ds_read_b64_tr_b16 v[192:193], v1 offset:49152
    v_mfma_f32_16x16x32_bf16 v[60:63], v[160:163], v[180:183], v[60:63]
    ds_read_b64_tr_b16 v[194:195], v1 offset:49664
    v_mfma_f32_16x16x32_bf16 v[28:31], v[164:167], v[184:187], v[28:31]
    v_cmp_eq_u32 vcc, 0, v13
    s_nop 1
    v_cndmask_b32 v77, v8, 0, vcc
    ds_read_b128 v[212:215], v7 offset:8192
    ds_read_b32 v0, v108 offset:1024
    v_mfma_f32_16x16x32_bf16 v[48:51], v[184:187], v[168:171], v[48:51]
    ds_read_b128 v[216:219], v7 offset:12288
    ds_read_b32 v110, v108
    v_mfma_f32_16x16x32_bf16 v[64:67], v[160:163], v[184:187], v[64:67]
    ds_read_b128 v[220:223], v7 offset:16384
    ds_inc_u32 v109, v109
    v_mfma_f32_16x16x32_bf16 v[32:35], v[164:167], v[188:191], v[32:35]
    v_cmp_eq_u32 vcc, 0x80000000, v13
    s_nop 1
    v_cndmask_b32 v73, v8, 0, vcc
    v_mfma_f32_16x16x32_bf16 v[52:55], v[188:191], v[168:171], v[52:55]
    v_mfma_f32_16x16x32_bf16 v[68:71], v[160:163], v[188:191], v[68:71]
    s_waitcnt lgkmcnt(8)
    v_mfma_f32_16x16x32_bf16 v[16:19], v[196:199], v[204:207], v[16:19]
    v_subrev_u32 v13, 2, v12
    v_and_b32 v13, 0x80000001, v13
    s_waitcnt lgkmcnt(4)
    v_cmp_gt_u32 vcc, 13, v0
    s_cbranch_vccnz SLOW_adaLN_cond__sliding_local_dilated__glu_gated_reglu__prompt_kernel_30
BACK_adaLN_cond__sliding_local_dilated__glu_gated_reglu__prompt_kernel_31:
    s_waitcnt lgkmcnt(2)
    v_cmp_gt_u32 vcc, 13, v110
    s_cbranch_vccnz SLOW_adaLN_cond__sliding_local_dilated__glu_gated_reglu__prompt_kernel_32
BACK_adaLN_cond__sliding_local_dilated__glu_gated_reglu__prompt_kernel_33:
    ds_read_b64_tr_b16 v[164:165], v14 offset:1024
    v_mfma_f32_16x16x32_bf16 v[36:39], v[204:207], v[200:203], v[36:39]
    ds_read_b64_tr_b16 v[166:167], v14 offset:1536
    v_mfma_f32_16x16x32_bf16 v[20:23], v[196:199], v[208:211], v[20:23]
    ds_read_b128 v[172:175], v4 offset:20480
    v_mfma_f32_16x16x32_bf16 v[40:43], v[208:211], v[200:203], v[40:43]
    v_cmp_eq_u32 vcc, 0, v13
    s_nop 1
    v_cndmask_b32 v78, v8, 0, vcc
    ds_read_b64_tr_b16 v[168:169], v14 offset:2048
    s_waitcnt lgkmcnt(5)
    v_mfma_f32_16x16x32_bf16 v[56:59], v[192:195], v[208:211], v[56:59]
    ds_read_b64_tr_b16 v[170:171], v14 offset:2560
    v_mfma_f32_16x16x32_bf16 v[24:27], v[196:199], v[212:215], v[24:27]
    ds_read_b128 v[176:179], v4 offset:24576
    v_mfma_f32_16x16x32_bf16 v[44:47], v[212:215], v[200:203], v[44:47]
    v_cmp_eq_u32 vcc, 0x80000000, v13
    s_nop 1
    v_cndmask_b32 v74, v8, 0, vcc
    ds_read_b64_tr_b16 v[160:161], v14
    v_mfma_f32_16x16x32_bf16 v[60:63], v[192:195], v[212:215], v[60:63]
    ds_read_b64_tr_b16 v[162:163], v14 offset:512
    v_mfma_f32_16x16x32_bf16 v[28:31], v[196:199], v[216:219], v[28:31]
    ds_read_b128 v[180:183], v4 offset:28672
    ds_read_b32 v0, v108 offset:1024
    v_mfma_f32_16x16x32_bf16 v[48:51], v[216:219], v[200:203], v[48:51]
    v_subrev_u32 v13, 3, v12
    v_and_b32 v13, 0x80000001, v13
    ds_read_b128 v[184:187], v4 offset:32768
    v_mfma_f32_16x16x32_bf16 v[64:67], v[192:195], v[216:219], v[64:67]
    ds_read_b128 v[188:191], v4 offset:36864
    ds_inc_u32 v109, v109
    v_mfma_f32_16x16x32_bf16 v[32:35], v[196:199], v[220:223], v[32:35]
    v_mfma_f32_16x16x32_bf16 v[52:55], v[220:223], v[200:203], v[52:55]
    v_cmp_eq_u32 vcc, 0, v13
    s_nop 1
    v_cndmask_b32 v79, v8, 0, vcc
    v_mfma_f32_16x16x32_bf16 v[68:71], v[192:195], v[220:223], v[68:71]
    s_waitcnt lgkmcnt(7)
    v_mfma_f32_16x16x32_bf16 v[16:19], v[164:167], v[172:175], v[16:19]
    s_waitcnt lgkmcnt(3)
    v_cmp_gt_u32 vcc, 14, v0
    s_cbranch_vccnz SLOW_adaLN_cond__sliding_local_dilated__glu_gated_reglu__prompt_kernel_34
BACK_adaLN_cond__sliding_local_dilated__glu_gated_reglu__prompt_kernel_35:
    ds_read_b64_tr_b16 v[196:197], v14 offset:13312
    v_mfma_f32_16x16x32_bf16 v[36:39], v[172:175], v[168:171], v[36:39]
    v_cmp_eq_u32 vcc, 0x80000000, v13
    s_nop 1
    v_cndmask_b32 v75, v8, 0, vcc
    ds_read_b64_tr_b16 v[198:199], v14 offset:13824
    v_mfma_f32_16x16x32_bf16 v[20:23], v[164:167], v[176:179], v[20:23]
    ds_read_b128 v[204:207], v5 offset:20480
    v_mfma_f32_16x16x32_bf16 v[40:43], v[176:179], v[168:171], v[40:43]
    ds_read_b64_tr_b16 v[200:201], v14 offset:14336
    s_waitcnt lgkmcnt(5)
    v_mfma_f32_16x16x32_bf16 v[56:59], v[160:163], v[176:179], v[56:59]
    s_cmp_eq_u32 s76, 0
    s_cselect_b64 vcc, -1, 0
    v_cndmask_b32 v80, v72, v8, vcc
    v_cndmask_b32 v81, v73, v8, vcc
    v_cndmask_b32 v82, v74, v8, vcc
    v_cndmask_b32 v83, v75, v8, vcc
    ds_read_b64_tr_b16 v[202:203], v14 offset:14848
    v_mfma_f32_16x16x32_bf16 v[24:27], v[164:167], v[180:183], v[24:27]
    ds_read_b128 v[208:211], v5 offset:24576
    v_mfma_f32_16x16x32_bf16 v[44:47], v[180:183], v[168:171], v[44:47]
    ds_read_b64_tr_b16 v[192:193], v14 offset:12288
    v_mfma_f32_16x16x32_bf16 v[60:63], v[160:163], v[180:183], v[60:63]
    v_mov_b32 v84, 0x3f803f80
    v_mov_b32 v85, 0x3f803f80
    ds_read_b64_tr_b16 v[194:195], v14 offset:12800
    v_mfma_f32_16x16x32_bf16 v[28:31], v[164:167], v[184:187], v[28:31]
    ds_read_b128 v[212:215], v5 offset:28672
    ds_read_b32 v0, v108 offset:1024
    v_mfma_f32_16x16x32_bf16 v[48:51], v[184:187], v[168:171], v[48:51]
    ds_read_b128 v[216:219], v5 offset:32768
    v_mfma_f32_16x16x32_bf16 v[64:67], v[160:163], v[184:187], v[64:67]
    v_mov_b32 v86, 0x3f803f80
    v_mov_b32 v87, 0x3f803f80
    ds_read_b128 v[220:223], v5 offset:36864
    ds_inc_u32 v109, v109
    v_mfma_f32_16x16x32_bf16 v[32:35], v[164:167], v[188:191], v[32:35]
    v_mfma_f32_16x16x32_bf16 v[52:55], v[188:191], v[168:171], v[52:55]
    v_mfma_f32_16x16x32_bf16 v[68:71], v[160:163], v[188:191], v[68:71]
    s_waitcnt lgkmcnt(7)
    v_mfma_f32_16x16x32_bf16 v[16:19], v[196:199], v[204:207], v[16:19]
    s_waitcnt lgkmcnt(3)
    v_cmp_gt_u32 vcc, 15, v0
    s_cbranch_vccnz SLOW_adaLN_cond__sliding_local_dilated__glu_gated_reglu__prompt_kernel_36
BACK_adaLN_cond__sliding_local_dilated__glu_gated_reglu__prompt_kernel_37:
    ds_read_b64_tr_b16 v[164:165], v14 offset:25600
    v_mfma_f32_16x16x32_bf16 v[36:39], v[204:207], v[200:203], v[36:39]
    ds_read_b64_tr_b16 v[166:167], v14 offset:26112
    v_mfma_f32_16x16x32_bf16 v[20:23], v[196:199], v[208:211], v[20:23]
    ds_read_b128 v[172:175], v6 offset:20480
    v_mfma_f32_16x16x32_bf16 v[40:43], v[208:211], v[200:203], v[40:43]
    ds_read_b64_tr_b16 v[168:169], v14 offset:26624
    s_waitcnt lgkmcnt(5)
    v_mfma_f32_16x16x32_bf16 v[56:59], v[192:195], v[208:211], v[56:59]
    ds_read_b64_tr_b16 v[170:171], v14 offset:27136
    v_mfma_f32_16x16x32_bf16 v[24:27], v[196:199], v[212:215], v[24:27]
    ds_read_b128 v[176:179], v6 offset:24576
    v_mfma_f32_16x16x32_bf16 v[44:47], v[212:215], v[200:203], v[44:47]
    ds_read_b64_tr_b16 v[160:161], v14 offset:24576
    v_mfma_f32_16x16x32_bf16 v[60:63], v[192:195], v[212:215], v[60:63]
    ds_read_b64_tr_b16 v[162:163], v14 offset:25088
    v_mfma_f32_16x16x32_bf16 v[28:31], v[196:199], v[216:219], v[28:31]
    ds_read_b128 v[180:183], v6 offset:28672
    ds_read_b32 v0, v108 offset:1024
    v_mfma_f32_16x16x32_bf16 v[48:51], v[216:219], v[200:203], v[48:51]
    ds_read_b128 v[184:187], v6 offset:32768
    v_mfma_f32_16x16x32_bf16 v[64:67], v[192:195], v[216:219], v[64:67]
    ds_read_b128 v[188:191], v6 offset:36864
    ds_inc_u32 v109, v109
    v_mfma_f32_16x16x32_bf16 v[32:35], v[196:199], v[220:223], v[32:35]
    v_mfma_f32_16x16x32_bf16 v[52:55], v[220:223], v[200:203], v[52:55]
    v_mfma_f32_16x16x32_bf16 v[68:71], v[192:195], v[220:223], v[68:71]
    s_waitcnt lgkmcnt(7)
    v_mfma_f32_16x16x32_bf16 v[16:19], v[164:167], v[172:175], v[16:19]
    s_waitcnt lgkmcnt(3)
    v_cmp_gt_u32 vcc, 16, v0
    s_cbranch_vccnz SLOW_adaLN_cond__sliding_local_dilated__glu_gated_reglu__prompt_kernel_38
BACK_adaLN_cond__sliding_local_dilated__glu_gated_reglu__prompt_kernel_39:
    ds_read_b64_tr_b16 v[196:197], v14 offset:37888
    v_mfma_f32_16x16x32_bf16 v[36:39], v[172:175], v[168:171], v[36:39]
    ds_read_b64_tr_b16 v[198:199], v14 offset:38400
    v_mfma_f32_16x16x32_bf16 v[20:23], v[164:167], v[176:179], v[20:23]
    ds_read_b128 v[204:207], v7 offset:20480
    v_mfma_f32_16x16x32_bf16 v[40:43], v[176:179], v[168:171], v[40:43]
    ds_read_b64_tr_b16 v[200:201], v14 offset:38912
    s_waitcnt lgkmcnt(5)
    v_mfma_f32_16x16x32_bf16 v[56:59], v[160:163], v[176:179], v[56:59]
    ds_read_b64_tr_b16 v[202:203], v14 offset:39424
    v_mfma_f32_16x16x32_bf16 v[24:27], v[164:167], v[180:183], v[24:27]
    ds_read_b128 v[208:211], v7 offset:24576
    v_mfma_f32_16x16x32_bf16 v[44:47], v[180:183], v[168:171], v[44:47]
    ds_read_b64_tr_b16 v[192:193], v14 offset:36864
    v_mfma_f32_16x16x32_bf16 v[60:63], v[160:163], v[180:183], v[60:63]
    ds_read_b64_tr_b16 v[194:195], v14 offset:37376
    v_mfma_f32_16x16x32_bf16 v[28:31], v[164:167], v[184:187], v[28:31]
    ds_read_b128 v[212:215], v7 offset:28672
    v_mfma_f32_16x16x32_bf16 v[48:51], v[184:187], v[168:171], v[48:51]
    ds_read_b128 v[216:219], v7 offset:32768
    v_mfma_f32_16x16x32_bf16 v[64:67], v[160:163], v[184:187], v[64:67]
    ds_read_b128 v[220:223], v7 offset:36864
    ds_inc_u32 v109, v109
    v_mfma_f32_16x16x32_bf16 v[32:35], v[164:167], v[188:191], v[32:35]
    v_mfma_f32_16x16x32_bf16 v[52:55], v[188:191], v[168:171], v[52:55]
    v_mfma_f32_16x16x32_bf16 v[68:71], v[160:163], v[188:191], v[68:71]
    s_waitcnt lgkmcnt(6)
    v_mfma_f32_16x16x32_bf16 v[16:19], v[196:199], v[204:207], v[16:19]
    v_mfma_f32_16x16x32_bf16 v[36:39], v[204:207], v[200:203], v[36:39]
    v_mfma_f32_16x16x32_bf16 v[20:23], v[196:199], v[208:211], v[20:23]
    v_mfma_f32_16x16x32_bf16 v[40:43], v[208:211], v[200:203], v[40:43]
    s_waitcnt lgkmcnt(1)
    v_mfma_f32_16x16x32_bf16 v[56:59], v[192:195], v[208:211], v[56:59]
    v_mfma_f32_16x16x32_bf16 v[24:27], v[196:199], v[212:215], v[24:27]
    v_mfma_f32_16x16x32_bf16 v[44:47], v[212:215], v[200:203], v[44:47]
    v_mfma_f32_16x16x32_bf16 v[60:63], v[192:195], v[212:215], v[60:63]
    v_mfma_f32_16x16x32_bf16 v[28:31], v[196:199], v[216:219], v[28:31]
    v_mfma_f32_16x16x32_bf16 v[48:51], v[216:219], v[200:203], v[48:51]
    v_mfma_f32_16x16x32_bf16 v[64:67], v[192:195], v[216:219], v[64:67]
    v_mfma_f32_16x16x32_bf16 v[32:35], v[196:199], v[220:223], v[32:35]
    v_mfma_f32_16x16x32_bf16 v[52:55], v[220:223], v[200:203], v[52:55]
    v_mfma_f32_16x16x32_bf16 v[68:71], v[192:195], v[220:223], v[68:71]
    s_lshl_b32 s80, s88, 5
    s_add_u32 s80, s80, s76
    s_lshl_b32 s80, s80, 10
    s_lshl_b32 s81, s75, 7
    s_add_u32 s80, s80, s81
    s_lshl_b32 s81, s87, 6
    s_add_u32 s80, s80, s81
    v_and_b32 v10, 31, v15
    v_lshlrev_b32 v10, 10, v10
    v_lshrrev_b32 v11, 5, v15
    v_lshl_add_u32 v10, v11, 4, v10
    v_add_u32 v9, s80, v10
    buffer_load_dwordx4 v[144:147], v9, s[32:35], 0 offen
    buffer_load_dwordx4 v[148:151], v9, s[32:35], 0 offen offset:32
    v_cvt_pk_bf16_f32 v88, v16, v17
    v_cvt_pk_bf16_f32 v89, v18, v19
    v_cvt_pk_bf16_f32 v90, v20, v21
    v_cvt_pk_bf16_f32 v91, v22, v23
    v_cvt_pk_bf16_f32 v132, v56, v57
    v_cvt_pk_bf16_f32 v133, v58, v59
    v_cvt_pk_bf16_f32 v92, v24, v25
    v_cvt_pk_bf16_f32 v93, v26, v27
    v_cvt_pk_bf16_f32 v134, v60, v61
    v_cvt_pk_bf16_f32 v135, v62, v63
    v_cvt_pk_bf16_f32 v94, v28, v29
    v_cvt_pk_bf16_f32 v95, v30, v31
    v_cvt_pk_bf16_f32 v136, v64, v65
    v_cvt_pk_bf16_f32 v137, v66, v67
    v_cvt_pk_bf16_f32 v96, v32, v33
    v_cvt_pk_bf16_f32 v97, v34, v35
    v_cvt_pk_bf16_f32 v138, v68, v69
    v_cvt_pk_bf16_f32 v139, v70, v71
    v_cvt_pk_bf16_f32 v98, v36, v37
    v_cvt_pk_bf16_f32 v99, v38, v39
    v_cvt_pk_bf16_f32 v100, v40, v41
    v_cvt_pk_bf16_f32 v101, v42, v43
    v_cvt_pk_bf16_f32 v102, v44, v45
    v_cvt_pk_bf16_f32 v103, v46, v47
    v_cvt_pk_bf16_f32 v104, v48, v49
    v_cvt_pk_bf16_f32 v105, v50, v51
    v_cvt_pk_bf16_f32 v106, v52, v53
    v_cvt_pk_bf16_f32 v107, v54, v55
    v_mfma_f32_16x16x16_bf16 v[16:19], v[88:89], v[132:133], v[80:83]
    v_mfma_f32_16x16x16_bf16 v[20:23], v[90:91], v[132:133], v[76:79]
    v_mfma_f32_16x16x16_bf16 v[24:27], v[90:91], v[134:135], v[72:75]
    v_mfma_f32_16x16x16_bf16 v[28:31], v[92:93], v[134:135], v[76:79]
    v_mfma_f32_16x16x16_bf16 v[32:35], v[92:93], v[136:137], v[72:75]
    v_mfma_f32_16x16x16_bf16 v[36:39], v[94:95], v[136:137], v[76:79]
    v_mfma_f32_16x16x16_bf16 v[40:43], v[94:95], v[138:139], v[72:75]
    v_mfma_f32_16x16x16_bf16 v[44:47], v[96:97], v[138:139], v[76:79]
    v_and_b32 v11, 1, v2
    v_lshlrev_b32 v10, 9, v11
    v_lshrrev_b32 v11, 1, v2
    v_lshl_add_u32 v10, v11, 8, v10
    v_lshl_add_u32 v10, v3, 4, v10
    s_lshl_b32 s80, s76, 10
    s_lshl_b32 s81, s75, 2
    s_add_u32 s81, s81, s3
    s_lshl_b32 s81, s81, 10
    s_add_u32 s80, s80, s81
    s_add_u32 s80, s80, 0x100000
    s_add_u32 s83, s80, 32768
    s_mov_b32 s82, 0x3eb8aa3b
    v_max3_f32 v48, v16, v17, v18
    v_max3_f32 v49, v24, v25, v26
    v_max3_f32 v50, v32, v33, v34
    v_max3_f32 v51, v40, v41, v42
    v_max3_f32 v48, v48, v19, v20
    v_max3_f32 v49, v49, v27, v28
    v_max3_f32 v50, v50, v35, v36
    v_max3_f32 v51, v51, v43, v44
    v_max3_f32 v48, v48, v21, v22
    v_max3_f32 v49, v49, v29, v30
    v_max3_f32 v50, v50, v37, v38
    v_max3_f32 v51, v51, v45, v46
    v_max_f32 v48, v48, v23
    v_max_f32 v49, v49, v31
    v_max_f32 v50, v50, v39
    v_max_f32 v51, v51, v47
    v_mov_b32 v52, v48
    v_mov_b32 v53, v49
    v_mov_b32 v54, v50
    v_mov_b32 v55, v51
    v_permlane16_swap_b32 v48, v52
    v_permlane16_swap_b32 v49, v53
    v_permlane16_swap_b32 v50, v54
    v_permlane16_swap_b32 v51, v55
    v_max_f32 v48, v48, v52
    v_max_f32 v49, v49, v53
    v_max_f32 v50, v50, v54
    v_max_f32 v51, v51, v55
    v_mov_b32 v52, v48
    v_mov_b32 v53, v49
    v_mov_b32 v54, v50
    v_mov_b32 v55, v51
    v_permlane32_swap_b32 v48, v52
    v_permlane32_swap_b32 v49, v53
    v_permlane32_swap_b32 v50, v54
    v_permlane32_swap_b32 v51, v55
    v_max_f32 v48, v48, v52
    v_max_f32 v49, v49, v53
    v_max_f32 v50, v50, v54
    v_max_f32 v51, v51, v55
    v_mul_f32 v48, s82, v48
    v_mul_f32 v49, s82, v49
    v_mul_f32 v50, s82, v50
    v_mul_f32 v51, s82, v51
    v_fma_f32 v16, v16, s82, -v48
    v_fma_f32 v17, v17, s82, -v48
    v_fma_f32 v18, v18, s82, -v48
    v_fma_f32 v19, v19, s82, -v48
    v_fma_f32 v20, v20, s82, -v48
    v_fma_f32 v21, v21, s82, -v48
    v_fma_f32 v22, v22, s82, -v48
    v_fma_f32 v23, v23, s82, -v48
    v_fma_f32 v24, v24, s82, -v49
    v_fma_f32 v25, v25, s82, -v49
    v_fma_f32 v26, v26, s82, -v49
    v_fma_f32 v27, v27, s82, -v49
    v_fma_f32 v28, v28, s82, -v49
    v_fma_f32 v29, v29, s82, -v49
    v_fma_f32 v30, v30, s82, -v49
    v_fma_f32 v31, v31, s82, -v49
    v_fma_f32 v32, v32, s82, -v50
    v_fma_f32 v33, v33, s82, -v50
    v_fma_f32 v34, v34, s82, -v50
    v_fma_f32 v35, v35, s82, -v50
    v_fma_f32 v36, v36, s82, -v50
    v_fma_f32 v37, v37, s82, -v50
    v_fma_f32 v38, v38, s82, -v50
    v_fma_f32 v39, v39, s82, -v50
    v_fma_f32 v40, v40, s82, -v51
    v_fma_f32 v41, v41, s82, -v51
    v_fma_f32 v42, v42, s82, -v51
    v_fma_f32 v43, v43, s82, -v51
    v_fma_f32 v44, v44, s82, -v51
    v_fma_f32 v45, v45, s82, -v51
    v_fma_f32 v46, v46, s82, -v51
    v_fma_f32 v47, v47, s82, -v51
    v_exp_f32 v16, v16
    v_exp_f32 v17, v17
    v_exp_f32 v18, v18
    v_exp_f32 v19, v19
    v_exp_f32 v20, v20
    v_exp_f32 v21, v21
    v_exp_f32 v22, v22
    v_exp_f32 v23, v23
    v_exp_f32 v24, v24
    v_exp_f32 v25, v25
    v_exp_f32 v26, v26
    v_exp_f32 v27, v27
    v_exp_f32 v28, v28
    v_exp_f32 v29, v29
    v_exp_f32 v30, v30
    v_exp_f32 v31, v31
    v_cvt_pk_bf16_f32 v116, v16, v17
    v_cvt_pk_bf16_f32 v117, v18, v19
    v_cvt_pk_bf16_f32 v118, v20, v21
    v_cvt_pk_bf16_f32 v119, v22, v23
    v_exp_f32 v32, v32
    v_exp_f32 v33, v33
    v_exp_f32 v34, v34
    v_exp_f32 v35, v35
    v_exp_f32 v36, v36
    v_exp_f32 v37, v37
    v_exp_f32 v38, v38
    v_exp_f32 v39, v39
    v_cvt_pk_bf16_f32 v120, v24, v25
    v_cvt_pk_bf16_f32 v121, v26, v27
    v_cvt_pk_bf16_f32 v122, v28, v29
    v_cvt_pk_bf16_f32 v123, v30, v31
    v_exp_f32 v40, v40
    v_exp_f32 v41, v41
    v_exp_f32 v42, v42
    v_exp_f32 v43, v43
    v_exp_f32 v44, v44
    v_exp_f32 v45, v45
    v_exp_f32 v46, v46
    v_exp_f32 v47, v47
    v_cvt_pk_bf16_f32 v124, v32, v33
    v_cvt_pk_bf16_f32 v125, v34, v35
    v_cvt_pk_bf16_f32 v126, v36, v37
    v_cvt_pk_bf16_f32 v127, v38, v39
    v_cvt_pk_bf16_f32 v128, v40, v41
    v_cvt_pk_bf16_f32 v129, v42, v43
    v_cvt_pk_bf16_f32 v130, v44, v45
    v_cvt_pk_bf16_f32 v131, v46, v47
    v_mfma_f32_16x16x32_bf16 v[20:23], v[84:87], v[116:119], 0
    v_mfma_f32_16x16x32_bf16 v[16:19], v[98:101], v[116:119], 0
    v_mfma_f32_16x16x32_bf16 v[28:31], v[84:87], v[120:123], 0
    v_mfma_f32_16x16x32_bf16 v[24:27], v[100:103], v[120:123], 0
    v_mfma_f32_16x16x32_bf16 v[36:39], v[84:87], v[124:127], 0
    v_mfma_f32_16x16x32_bf16 v[32:35], v[102:105], v[124:127], 0
    v_mfma_f32_16x16x32_bf16 v[44:47], v[84:87], v[128:131], 0
    v_mfma_f32_16x16x32_bf16 v[40:43], v[104:107], v[128:131], 0
    s_nop 0
    v_rcp_f32 v48, v20
    s_nop 0
    v_rcp_f32 v49, v28
    s_nop 0
    v_rcp_f32 v50, v36
    s_nop 0
    v_rcp_f32 v51, v44
    v_mul_f32 v16, v16, v48
    v_mul_f32 v17, v17, v48
    v_mul_f32 v18, v18, v48
    v_mul_f32 v19, v19, v48
    v_cvt_pk_bf16_f32 v56, v16, v17
    v_cvt_pk_bf16_f32 v57, v18, v19
    v_mul_f32 v24, v24, v49
    v_mul_f32 v25, v25, v49
    v_mul_f32 v26, v26, v49
    v_mul_f32 v27, v27, v49
    v_cvt_pk_bf16_f32 v58, v24, v25
    v_cvt_pk_bf16_f32 v59, v26, v27
    s_nop 0
    v_permlane32_swap_b32 v56, v58
    v_permlane32_swap_b32 v57, v59
    buffer_store_dwordx4 v[56:59], v10, s[68:71], s80 offen sc1
    v_mul_f32 v32, v32, v50
    v_mul_f32 v33, v33, v50
    v_mul_f32 v34, v34, v50
    v_mul_f32 v35, v35, v50
    v_cvt_pk_bf16_f32 v60, v32, v33
    v_cvt_pk_bf16_f32 v61, v34, v35
    v_mul_f32 v40, v40, v51
    v_mul_f32 v41, v41, v51
    v_mul_f32 v42, v42, v51
    v_mul_f32 v43, v43, v51
    v_cvt_pk_bf16_f32 v62, v40, v41
    v_cvt_pk_bf16_f32 v63, v42, v43
    s_nop 0
    v_permlane32_swap_b32 v60, v62
    v_permlane32_swap_b32 v61, v63
    buffer_store_dwordx4 v[60:63], v10, s[68:71], s83 offen sc1
    v_bfe_u32 v6, v15, 2, 2
    v_bfe_u32 v7, v15, 1, 1
    v_bfe_u32 v8, v15, 4, 1
    v_lshl_add_u32 v7, v8, 1, v7
    v_bfe_u32 v8, v15, 3, 1
    v_lshl_add_u32 v7, v8, 2, v7
    v_lshrrev_b32 v8, 5, v15
    v_lshlrev_b32 v1, 9, v8
    v_lshl_add_u32 v1, v6, 7, v1
    v_lshl_add_u32 v1, v7, 4, v1
    v_and_b32 v8, 1, v15
    v_lshl_add_u32 v1, v8, 3, v1
    s_lshl_b32 s80, s87, 6
    v_xor_b32 v1, s80, v1
    s_mul_i32 s80, s87, 32768
    v_add_u32 v4, s80, v1
    v_xor_b32 v5, 64, v4
    v_lshlrev_b32 v13, 2, v15
    v_lshlrev_b32 v14, 4, v15
    s_lshr_b32 s83, s76, 5
    s_add_u32 s83, s83, s88
    s_lshl_b32 s84, s83, 15
    s_lshl_b32 s82, s87, 14
    s_add_u32 s84, s84, s82
    s_add_u32 s84, s84, 0x100000
    s_lshl4_add_u32 s40, s40, s84
    s_lshl4_add_u32 s41, s41, s84
    s_lshl4_add_u32 s42, s42, s84
    s_lshl4_add_u32 s43, s43, s84
    s_lshl_b32 s80, s75, 7
    s_lshl_b32 s81, s87, 6
    s_add_u32 s80, s80, s81
    s_add_u32 s80, s80, 155648
    v_lshrrev_b32 v6, 5, v15
    v_lshlrev_b32 v6, 3, v6
    v_add_u32 v8, s80, v6
    s_lshl_b32 s80, s89, 12
    s_add_u32 s80, s80, 131072
    v_add_u32 v6, s80, v14
    v_xor_b32 v7, 0x2000, v6
    v_xor_b32 v111, 0x200, v109
    s_lshl_b32 s100, s72, 14
    s_add_u32 s100, s100, 0x60000
    s_lshl_b32 s80, s73, 7
    s_add_u32 s95, s100, s80
    v_lshlrev_b32 v11, 7, v15
    s_lshl_b32 s80, s72, 11
    s_add_u32 s80, s80, 0xb0000
    s_lshl_b32 s81, s74, 8
    s_add_u32 s81, s81, s80
    s_lshl_b32 s82, s87, 7
    s_add_u32 s59, s81, s82
    s_lshr_b32 s82, s75, 2
    s_lshl_b32 s82, s82, 7
    s_add_u32 s56, s81, s82
    s_and_b32 s82, s75, 3
    s_lshl2_add_u32 s82, s82, s3
    s_lshl2_add_u32 s56, s82, s56
    s_lshl_b32 s82, s88, 7
    s_add_u32 s81, s81, s82
    s_lshl1_add_u32 s82, s75, s87
    s_lshl2_add_u32 s57, s82, s81
    s_add_u32 s57, s57, 512
    s_lshl_b32 s82, s3, 7
    s_add_u32 s60, s80, s82
    s_add_u32 s60, s60, 512
    s_sub_u32 s81, s81, s80
    s_lshl1_add_u32 s81, s81, s80
    s_lshl_b32 s82, s87, 7
    s_add_u32 s81, s81, s82
    s_add_u32 s61, s81, 1024
    s_cmp_eq_u32 s79, 7
    s_cselect_b32 s81, 14, s78
    s_and_b32 s82, s81, 1
    s_lshl1_add_u32 s82, s3, s82
    s_lshl_b32 s82, s82, 7
    s_add_u32 s82, s82, s80
    s_lshr_b32 s81, s81, 1
    s_lshl2_add_u32 s82, s81, s82
    s_add_u32 s58, s82, 1024
    s_movk_i32 s62, 80
    v_and_b32 v12, 31, v15
    v_lshlrev_b32 v12, 2, v12
    s_lshl_b32 s92, 0x5555, s74
    s_mov_b32 s93, 0
    s_waitcnt vmcnt(2)
    v_permlane32_swap_b32 v144, v146
    v_permlane32_swap_b32 v145, v147
    v_permlane32_swap_b32 v148, v150
    v_permlane32_swap_b32 v149, v151
    v_lshlrev_b32 v112, 16, v144
    v_and_b32 v113, 0xffff0000, v144
    v_lshlrev_b32 v114, 16, v145
    v_and_b32 v115, 0xffff0000, v145
    v_lshlrev_b32 v116, 16, v146
    v_and_b32 v117, 0xffff0000, v146
    v_lshlrev_b32 v118, 16, v147
    v_and_b32 v119, 0xffff0000, v147
    v_lshlrev_b32 v120, 16, v148
    v_and_b32 v121, 0xffff0000, v148
    v_lshlrev_b32 v122, 16, v149
    v_and_b32 v123, 0xffff0000, v149
    v_lshlrev_b32 v124, 16, v150
    v_and_b32 v125, 0xffff0000, v150
    v_lshlrev_b32 v126, 16, v151
    v_and_b32 v127, 0xffff0000, v151
    s_waitcnt vmcnt(0)
    v_mov_b32 v11, s77
    s_mov_b64 exec, 1
    buffer_store_dword v11, off, s[68:71], s56
    s_mov_b64 exec, -1
    ds_inc_u32 v109, v109
    buffer_load_dword v10, v12, s[68:71], s59 offen sc1
    s_waitcnt vmcnt(0)
    s_mov_b32 s86, s62
    s_branch WC_adaLN_cond__sliding_local_dilated__glu_gated_reglu__prompt_kernel_43
WL_adaLN_cond__sliding_local_dilated__glu_gated_reglu__prompt_kernel_42:
    s_sub_u32 s86, s86, 1
    s_cbranch_scc1 WS_adaLN_cond__sliding_local_dilated__glu_gated_reglu__prompt_kernel_40
    buffer_load_dword v10, v12, s[68:71], s59 offen sc1
    s_waitcnt vmcnt(0)
WC_adaLN_cond__sliding_local_dilated__glu_gated_reglu__prompt_kernel_43:
    v_cmp_ne_u32 vcc, s77, v10
    s_and_b32 s90, vcc_lo, 0xffff
    s_cbranch_scc1 WL_adaLN_cond__sliding_local_dilated__glu_gated_reglu__prompt_kernel_42
WB_adaLN_cond__sliding_local_dilated__glu_gated_reglu__prompt_kernel_41:
    ds_read_b32 v0, v108 offset:1024
    buffer_load_dwordx4 v[160:163], v14, s[68:71], s40 offen sc1
    buffer_load_dwordx4 v[164:167], v14, s[68:71], s40 offen offset:1024 sc1
    buffer_load_dwordx4 v[168:171], v14, s[68:71], s40 offen offset:2048 sc1
    buffer_load_dwordx4 v[172:175], v14, s[68:71], s40 offen offset:3072 sc1
    buffer_load_dwordx4 v[176:179], v14, s[68:71], s41 offen sc1
    buffer_load_dwordx4 v[180:183], v14, s[68:71], s41 offen offset:1024 sc1
    buffer_load_dwordx4 v[184:187], v14, s[68:71], s41 offen offset:2048 sc1
    buffer_load_dwordx4 v[188:191], v14, s[68:71], s41 offen offset:3072 sc1
    buffer_load_dwordx4 v[192:195], v14, s[68:71], s42 offen sc1
    buffer_load_dwordx4 v[196:199], v14, s[68:71], s42 offen offset:1024 sc1
    ds_inc_u32 v109, v109
    s_waitcnt lgkmcnt(1)
    v_cmp_gt_u32 vcc, 17, v0
    s_cbranch_vccnz SLOW_adaLN_cond__sliding_local_dilated__glu_gated_reglu__prompt_kernel_44
BACK_adaLN_cond__sliding_local_dilated__glu_gated_reglu__prompt_kernel_45:
    ds_read_b64_tr_b16 v[224:225], v5
    ds_read_b64_tr_b16 v[226:227], v5 offset:1024
    ds_read_b64_tr_b16 v[228:229], v4
    ds_read_b64_tr_b16 v[230:231], v4 offset:1024
    ds_read_b64_tr_b16 v[232:233], v5 offset:2048
    ds_read_b64_tr_b16 v[234:235], v5 offset:3072
    ds_read_b64_tr_b16 v[236:237], v4 offset:2048
    ds_read_b64_tr_b16 v[238:239], v4 offset:3072
    ds_read_b32 v0, v108 offset:1024
    s_waitcnt vmcnt(9)
    s_waitcnt lgkmcnt(7)
    v_mfma_f32_32x32x16_bf16 v[32:47], v[224:227], v[160:163], 0
    buffer_load_dwordx4 v[200:203], v14, s[68:71], s42 offen offset:2048 sc1
    ds_read_b64_tr_b16 v[240:241], v5 offset:4096
    ds_read_b64_tr_b16 v[242:243], v5 offset:5120
    s_waitcnt lgkmcnt(2)
    v_cmp_gt_u32 vcc, 18, v0
    s_cbranch_vccnz SLOW_adaLN_cond__sliding_local_dilated__glu_gated_reglu__prompt_kernel_46
BACK_adaLN_cond__sliding_local_dilated__glu_gated_reglu__prompt_kernel_47:
    ds_read_b64 v[80:81], v8
    v_mfma_f32_32x32x16_bf16 v[16:31], v[228:231], v[160:163], 0
    buffer_load_dwordx4 v[204:207], v14, s[68:71], s42 offen offset:3072 sc1
    ds_read_b64_tr_b16 v[244:245], v5 offset:6144
    ds_read_b64_tr_b16 v[246:247], v5 offset:7168
    ds_read_b64 v[88:89], v8 offset:2048
    ds_read_b64 v[82:83], v8 offset:16
    s_waitcnt vmcnt(10)
    v_mfma_f32_32x32x16_bf16 v[32:47], v[232:235], v[164:167], v[32:47]
    buffer_load_dwordx4 v[208:211], v14, s[68:71], s43 offen sc1
    ds_read_b64_tr_b16 v[224:225], v4 offset:4096
    ds_read_b64_tr_b16 v[226:227], v4 offset:5120
    ds_read_b64 v[90:91], v8 offset:2064
    ds_read_b64 v[84:85], v8 offset:32
    v_mfma_f32_32x32x16_bf16 v[16:31], v[236:239], v[164:167], v[16:31]
    buffer_load_dwordx4 v[212:215], v14, s[68:71], s43 offen offset:1024 sc1
    ds_read_b64_tr_b16 v[228:229], v5 offset:8192
    ds_read_b64_tr_b16 v[230:231], v5 offset:9216
    ds_read_b64 v[92:93], v8 offset:2080
    ds_read_b64 v[86:87], v8 offset:48
    s_waitcnt vmcnt(11)
    s_waitcnt lgkmcnt(13)
    v_mfma_f32_32x32x16_bf16 v[32:47], v[240:243], v[168:171], v[32:47]
    buffer_load_dwordx4 v[216:219], v14, s[68:71], s43 offen offset:2048 sc1
    ds_read_b64_tr_b16 v[232:233], v4 offset:6144
    ds_read_b64_tr_b16 v[234:235], v4 offset:7168
    ds_read_b64 v[94:95], v8 offset:2096
    s_waitcnt vmcnt(11)
    s_waitcnt lgkmcnt(13)
    v_mfma_f32_32x32x16_bf16 v[32:47], v[244:247], v[172:175], v[32:47]
    buffer_load_dwordx4 v[220:223], v14, s[68:71], s43 offen offset:3072 sc1
    ds_read_b64_tr_b16 v[236:237], v5 offset:10240
    ds_read_b64_tr_b16 v[238:239], v5 offset:11264
    s_waitcnt lgkmcnt(11)
    v_mfma_f32_32x32x16_bf16 v[16:31], v[224:227], v[168:171], v[16:31]
    ds_read_b64_tr_b16 v[240:241], v4 offset:8192
    ds_read_b64_tr_b16 v[242:243], v4 offset:9216
    s_waitcnt lgkmcnt(4)
    s_waitcnt vmcnt(11)
    v_mfma_f32_32x32x16_bf16 v[32:47], v[228:231], v[176:179], v[32:47]
    ds_read_b64_tr_b16 v[244:245], v5 offset:12288
    ds_read_b64_tr_b16 v[246:247], v5 offset:13312
    v_lshlrev_b32 v48, 16, v80
    v_and_b32 v49, 0xffff0000, v80
    v_lshlrev_b32 v64, 16, v88
    v_and_b32 v65, 0xffff0000, v88
    v_mfma_f32_32x32x16_bf16 v[16:31], v[232:235], v[172:175], v[16:31]
    ds_read_b64_tr_b16 v[224:225], v4 offset:10240
    ds_read_b64_tr_b16 v[226:227], v4 offset:11264
    v_lshlrev_b32 v50, 16, v81
    v_and_b32 v51, 0xffff0000, v81
    v_lshlrev_b32 v66, 16, v89
    v_and_b32 v67, 0xffff0000, v89
    s_waitcnt vmcnt(10)
    s_waitcnt lgkmcnt(6)
    v_mfma_f32_32x32x16_bf16 v[32:47], v[236:239], v[180:183], v[32:47]
    ds_read_b64_tr_b16 v[228:229], v5 offset:14336
    ds_read_b64_tr_b16 v[230:231], v5 offset:15360
    v_lshlrev_b32 v52, 16, v82
    v_and_b32 v53, 0xffff0000, v82
    v_lshlrev_b32 v68, 16, v90
    v_and_b32 v69, 0xffff0000, v90
    s_waitcnt lgkmcnt(6)
    v_mfma_f32_32x32x16_bf16 v[16:31], v[240:243], v[176:179], v[16:31]
    ds_read_b64_tr_b16 v[232:233], v5 offset:16384
    ds_read_b64_tr_b16 v[234:235], v5 offset:17408
    v_lshlrev_b32 v54, 16, v83
    v_and_b32 v55, 0xffff0000, v83
    v_lshlrev_b32 v70, 16, v91
    v_and_b32 v71, 0xffff0000, v91
    s_waitcnt vmcnt(9)
    s_waitcnt lgkmcnt(6)
    v_mfma_f32_32x32x16_bf16 v[32:47], v[244:247], v[184:187], v[32:47]
    ds_read_b64_tr_b16 v[236:237], v4 offset:12288
    ds_read_b64_tr_b16 v[238:239], v4 offset:13312
    v_lshlrev_b32 v56, 16, v84
    v_and_b32 v57, 0xffff0000, v84
    v_lshlrev_b32 v72, 16, v92
    v_and_b32 v73, 0xffff0000, v92
    s_waitcnt lgkmcnt(6)
    v_mfma_f32_32x32x16_bf16 v[16:31], v[224:227], v[180:183], v[16:31]
    ds_read_b64_tr_b16 v[240:241], v5 offset:18432
    ds_read_b64_tr_b16 v[242:243], v5 offset:19456
    v_lshlrev_b32 v58, 16, v85
    v_and_b32 v59, 0xffff0000, v85
    v_lshlrev_b32 v74, 16, v93
    v_and_b32 v75, 0xffff0000, v93
    s_waitcnt vmcnt(8)
    s_waitcnt lgkmcnt(6)
    v_mfma_f32_32x32x16_bf16 v[32:47], v[228:231], v[188:191], v[32:47]
    ds_read_b64_tr_b16 v[244:245], v4 offset:14336
    ds_read_b64_tr_b16 v[246:247], v4 offset:15360
    v_lshlrev_b32 v60, 16, v86
    v_and_b32 v61, 0xffff0000, v86
    v_lshlrev_b32 v76, 16, v94
    v_and_b32 v77, 0xffff0000, v94
    s_waitcnt vmcnt(7)
    s_waitcnt lgkmcnt(6)
    v_mfma_f32_32x32x16_bf16 v[32:47], v[232:235], v[192:195], v[32:47]
    ds_read_b64_tr_b16 v[224:225], v5 offset:20480
    ds_read_b64_tr_b16 v[226:227], v5 offset:21504
    v_lshlrev_b32 v62, 16, v87
    v_and_b32 v63, 0xffff0000, v87
    v_lshlrev_b32 v78, 16, v95
    v_and_b32 v79, 0xffff0000, v95
    s_waitcnt lgkmcnt(6)
    v_mfma_f32_32x32x16_bf16 v[16:31], v[236:239], v[184:187], v[16:31]
    ds_read_b64_tr_b16 v[228:229], v4 offset:16384
    ds_read_b64_tr_b16 v[230:231], v4 offset:17408
    s_waitcnt vmcnt(6)
    s_waitcnt lgkmcnt(6)
    v_mfma_f32_32x32x16_bf16 v[32:47], v[240:243], v[196:199], v[32:47]
    ds_read_b64_tr_b16 v[232:233], v5 offset:22528
    ds_read_b64_tr_b16 v[234:235], v5 offset:23552
    s_waitcnt lgkmcnt(6)
    v_mfma_f32_32x32x16_bf16 v[16:31], v[244:247], v[188:191], v[16:31]
    ds_read_b64_tr_b16 v[236:237], v4 offset:18432
    ds_read_b64_tr_b16 v[238:239], v4 offset:19456
    s_waitcnt vmcnt(5)
    s_waitcnt lgkmcnt(6)
    v_mfma_f32_32x32x16_bf16 v[32:47], v[224:227], v[200:203], v[32:47]
    ds_read_b64_tr_b16 v[240:241], v5 offset:24576
    ds_read_b64_tr_b16 v[242:243], v5 offset:25600
    s_waitcnt lgkmcnt(6)
    v_mfma_f32_32x32x16_bf16 v[16:31], v[228:231], v[192:195], v[16:31]
    ds_read_b64_tr_b16 v[244:245], v5 offset:26624
    ds_read_b64_tr_b16 v[246:247], v5 offset:27648
    s_waitcnt vmcnt(4)
    s_waitcnt lgkmcnt(6)
    v_mfma_f32_32x32x16_bf16 v[32:47], v[232:235], v[204:207], v[32:47]
    ds_read_b64_tr_b16 v[224:225], v4 offset:20480
    ds_read_b64_tr_b16 v[226:227], v4 offset:21504
    s_waitcnt lgkmcnt(6)
    v_mfma_f32_32x32x16_bf16 v[16:31], v[236:239], v[196:199], v[16:31]
    ds_read_b64_tr_b16 v[228:229], v5 offset:28672
    ds_read_b64_tr_b16 v[230:231], v5 offset:29696
    s_waitcnt vmcnt(3)
    s_waitcnt lgkmcnt(6)
    v_mfma_f32_32x32x16_bf16 v[32:47], v[240:243], v[208:211], v[32:47]
    ds_read_b64_tr_b16 v[232:233], v4 offset:22528
    ds_read_b64_tr_b16 v[234:235], v4 offset:23552
    s_waitcnt vmcnt(2)
    s_waitcnt lgkmcnt(6)
    v_mfma_f32_32x32x16_bf16 v[32:47], v[244:247], v[212:215], v[32:47]
    ds_read_b64_tr_b16 v[236:237], v5 offset:30720
    ds_read_b64_tr_b16 v[238:239], v5 offset:31744
    s_waitcnt lgkmcnt(6)
    v_mfma_f32_32x32x16_bf16 v[16:31], v[224:227], v[200:203], v[16:31]
    ds_read_b64_tr_b16 v[240:241], v4 offset:24576
    ds_read_b64_tr_b16 v[242:243], v4 offset:25600
    s_waitcnt vmcnt(1)
    s_waitcnt lgkmcnt(6)
    v_mfma_f32_32x32x16_bf16 v[32:47], v[228:231], v[216:219], v[32:47]
    ds_read_b64_tr_b16 v[244:245], v4 offset:26624
    ds_read_b64_tr_b16 v[246:247], v4 offset:27648
    s_waitcnt lgkmcnt(6)
    v_mfma_f32_32x32x16_bf16 v[16:31], v[232:235], v[204:207], v[16:31]
    ds_read_b64_tr_b16 v[224:225], v4 offset:28672
    ds_read_b64_tr_b16 v[226:227], v4 offset:29696
    s_waitcnt vmcnt(0)
    s_waitcnt lgkmcnt(6)
    v_mfma_f32_32x32x16_bf16 v[32:47], v[236:239], v[220:223], v[32:47]
    ds_read_b64_tr_b16 v[228:229], v4 offset:30720
    ds_read_b64_tr_b16 v[230:231], v4 offset:31744
    ds_inc_u32 v109, v109
    s_waitcnt lgkmcnt(7)
    v_mfma_f32_32x32x16_bf16 v[16:31], v[240:243], v[208:211], v[16:31]
    s_waitcnt lgkmcnt(5)
    v_mfma_f32_32x32x16_bf16 v[16:31], v[244:247], v[212:215], v[16:31]
    s_nop 4
    ds_write_b128 v6, v[32:35]
    ds_write_b128 v6, v[36:39] offset:1024
    s_waitcnt lgkmcnt(5)
    v_mfma_f32_32x32x16_bf16 v[16:31], v[224:227], v[216:219], v[16:31]
    ds_write_b128 v6, v[40:43] offset:2048
    ds_write_b128 v6, v[44:47] offset:3072
    s_waitcnt lgkmcnt(5)
    v_mfma_f32_32x32x16_bf16 v[16:31], v[228:231], v[220:223], v[16:31]
    ds_inc_u32 v109, v109
    s_lshl_b32 s81, s75, 1
    s_add_u32 s81, s81, s87
    s_lshl_b32 s84, s83, 15
    s_lshl_b32 s82, s81, 11
    s_add_u32 s84, s84, s82
    s_add_u32 s84, s84, 0x300000
    s_lshl_b32 s82, s83, 12
    s_lshl_b32 s81, s81, 8
    s_add_u32 s82, s82, s81
    s_add_u32 s82, s82, 0x20000
    ds_read_b32 v0, v111
    s_waitcnt lgkmcnt(0)
    v_cmp_gt_u32 vcc, 23, v0
    s_cbranch_vccnz SLOW_adaLN_cond__sliding_local_dilated__glu_gated_reglu__prompt_kernel_48
BACK_adaLN_cond__sliding_local_dilated__glu_gated_reglu__prompt_kernel_49:
    ds_read_b128 v[32:35], v7
    ds_read_b128 v[36:39], v7 offset:1024
    ds_read_b128 v[40:43], v7 offset:2048
    ds_read_b128 v[44:47], v7 offset:3072
    s_waitcnt lgkmcnt(3)
    v_pk_add_f32 v[16:17], v[16:17], v[32:33]
    v_pk_add_f32 v[18:19], v[18:19], v[34:35]
    s_waitcnt lgkmcnt(2)
    v_pk_add_f32 v[20:21], v[20:21], v[36:37]
    v_pk_add_f32 v[22:23], v[22:23], v[38:39]
    s_waitcnt lgkmcnt(1)
    v_pk_add_f32 v[24:25], v[24:25], v[40:41]
    v_pk_add_f32 v[26:27], v[26:27], v[42:43]
    s_waitcnt lgkmcnt(0)
    v_pk_add_f32 v[28:29], v[28:29], v[44:45]
    v_pk_add_f32 v[30:31], v[30:31], v[46:47]
    v_pk_fma_f32 v[16:17], v[16:17], v[48:49], v[112:113]
    v_pk_fma_f32 v[18:19], v[18:19], v[50:51], v[114:115]
    v_pk_fma_f32 v[20:21], v[20:21], v[52:53], v[116:117]
    v_pk_fma_f32 v[22:23], v[22:23], v[54:55], v[118:119]
    v_cvt_pk_bf16_f32 v144, v16, v17
    v_cvt_pk_bf16_f32 v145, v18, v19
    v_cvt_pk_bf16_f32 v146, v20, v21
    v_cvt_pk_bf16_f32 v147, v22, v23
    v_lshlrev_b32 v112, 16, v144
    v_and_b32 v113, 0xffff0000, v144
    v_lshlrev_b32 v114, 16, v145
    v_and_b32 v115, 0xffff0000, v145
    v_lshlrev_b32 v116, 16, v146
    v_and_b32 v117, 0xffff0000, v146
    v_lshlrev_b32 v118, 16, v147
    v_and_b32 v119, 0xffff0000, v147
    v_pk_mul_f32 v[16:17], v[112:113], v[64:65]
    v_pk_mul_f32 v[18:19], v[114:115], v[66:67]
    v_pk_mul_f32 v[20:21], v[116:117], v[68:69]
    v_pk_mul_f32 v[22:23], v[118:119], v[70:71]
    v_cvt_pk_bf16_f32 v32, v16, v17
    v_cvt_pk_bf16_f32 v33, v18, v19
    v_cvt_pk_bf16_f32 v34, v20, v21
    v_cvt_pk_bf16_f32 v35, v22, v23
    buffer_store_dwordx4 v[32:35], v14, s[68:71], s84 offen sc1
    v_pk_fma_f32 v[24:25], v[24:25], v[56:57], v[120:121]
    v_pk_fma_f32 v[26:27], v[26:27], v[58:59], v[122:123]
    v_pk_fma_f32 v[28:29], v[28:29], v[60:61], v[124:125]
    v_pk_fma_f32 v[30:31], v[30:31], v[62:63], v[126:127]
    v_cvt_pk_bf16_f32 v148, v24, v25
    v_cvt_pk_bf16_f32 v149, v26, v27
    v_cvt_pk_bf16_f32 v150, v28, v29
    v_cvt_pk_bf16_f32 v151, v30, v31
    v_lshlrev_b32 v120, 16, v148
    v_and_b32 v121, 0xffff0000, v148
    v_lshlrev_b32 v122, 16, v149
    v_and_b32 v123, 0xffff0000, v149
    v_lshlrev_b32 v124, 16, v150
    v_and_b32 v125, 0xffff0000, v150
    v_lshlrev_b32 v126, 16, v151
    v_and_b32 v127, 0xffff0000, v151
    v_pk_mul_f32 v[24:25], v[120:121], v[72:73]
    v_pk_mul_f32 v[26:27], v[122:123], v[74:75]
    v_pk_mul_f32 v[28:29], v[124:125], v[76:77]
    v_pk_mul_f32 v[30:31], v[126:127], v[78:79]
    v_cvt_pk_bf16_f32 v36, v24, v25
    v_cvt_pk_bf16_f32 v37, v26, v27
    v_cvt_pk_bf16_f32 v38, v28, v29
    v_cvt_pk_bf16_f32 v39, v30, v31
    buffer_store_dwordx4 v[36:39], v14, s[68:71], s84 offen offset:1024 sc1
    v_mov_b32 v10, 0x3f803f80
    v_dot2_f32_bf16 v56, v144, v10, 0
    v_dot2_f32_bf16 v57, v144, v144, 0
    v_dot2_f32_bf16 v58, v145, v10, 0
    v_dot2_f32_bf16 v59, v145, v145, 0
    v_dot2_f32_bf16 v56, v146, v10, v56
    v_dot2_f32_bf16 v57, v146, v146, v57
    v_dot2_f32_bf16 v58, v147, v10, v58
    v_dot2_f32_bf16 v59, v147, v147, v59
    v_dot2_f32_bf16 v56, v148, v10, v56
    v_dot2_f32_bf16 v57, v148, v148, v57
    v_dot2_f32_bf16 v58, v149, v10, v58
    v_dot2_f32_bf16 v59, v149, v149, v59
    v_dot2_f32_bf16 v56, v150, v10, v56
    v_dot2_f32_bf16 v57, v150, v150, v57
    v_dot2_f32_bf16 v58, v151, v10, v58
    v_dot2_f32_bf16 v59, v151, v151, v59
    v_lshlrev_b32 v10, 3, v15
    s_nop 0
    v_add_f32 v56, v56, v58
    v_add_f32 v57, v57, v59
    v_mov_b32 v58, v56
    v_mov_b32 v59, v57
    s_nop 0
    v_permlane32_swap_b32 v56, v58
    v_permlane32_swap_b32 v57, v59
    v_add_f32 v56, v56, v58
    v_add_f32 v57, v57, v59
    s_mov_b32 exec_hi, 0
    buffer_store_dwordx2 v[56:57], v10, s[68:71], s82 offen sc1
    s_mov_b32 exec_hi, -1
    ds_inc_u32 v109, v109
    v_lshrrev_b32 v2, 5, v15
    v_bfe_u32 v8, v15, 4, 1
    v_bfe_u32 v6, v15, 2, 2
    v_bfe_u32 v7, v15, 1, 1
    v_and_b32 v3, 2, v6
    v_xor_b32 v7, v7, v3
    v_lshlrev_b32 v3, 2, v8
    v_xor_b32 v7, v7, v3
    v_lshlrev_b32 v3, 10, v8
    v_lshl_add_u32 v3, v6, 7, v3
    v_lshl_add_u32 v3, v2, 9, v3
    v_lshl_add_u32 v3, v7, 4, v3
    v_and_b32 v6, 1, v15
    v_lshl_add_u32 v3, v6, 3, v3
    v_xor_b32 v152, 0, v3
    v_add_u32 v156, 0x10000, v152
    v_xor_b32 v153, 32, v3
    v_add_u32 v157, 0x10000, v153
    v_xor_b32 v154, 64, v3
    v_add_u32 v158, 0x10000, v154
    v_xor_b32 v155, 96, v3
    v_add_u32 v159, 0x10000, v155
    v_and_b32 v6, 31, v15
    v_lshlrev_b32 v6, 4, v6
    v_add_u32 v4, 147456, v6
    s_lshl_b32 s80, s89, 9
    s_add_u32 s80, s80, 153600
    v_add_u32 v5, s80, v6
    v_mov_b32 v6, 151552
    v_cmp_eq_u32 vcc, 0, v2
    s_nop 1
    v_cndmask_b32 v5, v6, v5, vcc
    s_lshl_b32 s82, s72, 2
    s_add_u32 s82, s82, s89
    s_lshl_b32 s84, s82, 15
    s_add_u32 s84, s84, 0x300000
    s_add_u32 s80, s7, 0
    s_and_b32 s80, s80, 7
    s_lshl_b32 s80, s80, 12
    s_add_u32 s40, s80, s84
    s_add_u32 s80, s7, 1
    s_and_b32 s80, s80, 7
    s_lshl_b32 s80, s80, 12
    s_add_u32 s41, s80, s84
    s_add_u32 s80, s7, 2
    s_and_b32 s80, s80, 7
    s_lshl_b32 s80, s80, 12
    s_add_u32 s42, s80, s84
    s_add_u32 s80, s7, 3
    s_and_b32 s80, s80, 7
    s_lshl_b32 s80, s80, 12
    s_add_u32 s43, s80, s84
    s_add_u32 s80, s7, 4
    s_and_b32 s80, s80, 7
    s_lshl_b32 s80, s80, 12
    s_add_u32 s44, s80, s84
    s_add_u32 s80, s7, 5
    s_and_b32 s80, s80, 7
    s_lshl_b32 s80, s80, 12
    s_add_u32 s45, s80, s84
    s_add_u32 s80, s7, 6
    s_and_b32 s80, s80, 7
    s_lshl_b32 s80, s80, 12
    s_add_u32 s46, s80, s84
    s_add_u32 s80, s7, 7
    s_and_b32 s80, s80, 7
    s_lshl_b32 s80, s80, 12
    s_add_u32 s47, s80, s84
    s_mul_i32 s94, s82, 114688
    s_lshl_b32 s80, s78, 13
    s_add_u32 s94, s94, s80
    s_add_u32 s94, s94, 0x500000
    s_add_u32 s101, s94, 4096
    s_mul_i32 s83, s83, 114688
    s_lshl_b32 s80, s87, 13
    s_add_u32 s83, s83, s80
    s_add_u32 s83, s83, 0x500000
    s_sub_u32 s80, s7, 7
    s_cselect_b32 s80, s7, s80
    s_lshl_b32 s48, s80, 14
    s_add_u32 s48, s48, s83
    s_add_u32 s80, s80, 1
    s_cmp_eq_u32 s80, 7
    s_cselect_b32 s80, 0, s80
    s_lshl_b32 s49, s80, 14
    s_add_u32 s49, s49, s83
    s_add_u32 s80, s80, 1
    s_cmp_eq_u32 s80, 7
    s_cselect_b32 s80, 0, s80
    s_lshl_b32 s50, s80, 14
    s_add_u32 s50, s50, s83
    s_add_u32 s80, s80, 1
    s_cmp_eq_u32 s80, 7
    s_cselect_b32 s80, 0, s80
    s_lshl_b32 s51, s80, 14
    s_add_u32 s51, s51, s83
    s_add_u32 s80, s80, 1
    s_cmp_eq_u32 s80, 7
    s_cselect_b32 s80, 0, s80
    s_lshl_b32 s52, s80, 14
    s_add_u32 s52, s52, s83
    s_add_u32 s80, s80, 1
    s_cmp_eq_u32 s80, 7
    s_cselect_b32 s80, 0, s80
    s_lshl_b32 s53, s80, 14
    s_add_u32 s53, s53, s83
    s_add_u32 s80, s80, 1
    s_cmp_eq_u32 s80, 7
    s_cselect_b32 s80, 0, s80
    s_lshl_b32 s54, s80, 14
    s_add_u32 s54, s54, s83
    v_add_u32 v13, 0x1000, v14
    s_waitcnt vmcnt(0)
    v_mov_b32 v11, s77
    s_mov_b64 exec, 1
    buffer_store_dword v11, off, s[68:71], s57
    s_mov_b64 exec, -1
    ds_inc_u32 v109, v109
    s_xor_b32 s80, s73, 7
    s_or_b32 s80, s80, s72
    s_or_b32 s80, s80, s3
    s_cmp_lg_u32 s80, 0
    s_cbranch_scc1 NOEP
    s_mov_b64 exec, 1
    buffer_store_dword v11, off, s[68:71], 0 sc1
    s_mov_b64 exec, -1
NOEP:
    s_cmp_eq_u32 s79, 7
    s_cbranch_scc1 P3_IDLE
    buffer_load_dword v10, v12, s[68:71], s60 offen sc1
    s_waitcnt vmcnt(0)
    s_mov_b32 s86, s62
    s_branch WC_adaLN_cond__sliding_local_dilated__glu_gated_reglu__prompt_kernel_53
WL_adaLN_cond__sliding_local_dilated__glu_gated_reglu__prompt_kernel_52:
    s_sub_u32 s86, s86, 1
    s_cbranch_scc1 WS_adaLN_cond__sliding_local_dilated__glu_gated_reglu__prompt_kernel_50
    buffer_load_dword v10, v12, s[68:71], s60 offen sc1
    s_waitcnt vmcnt(0)
WC_adaLN_cond__sliding_local_dilated__glu_gated_reglu__prompt_kernel_53:
    v_cmp_ne_u32 vcc, s77, v10
    s_and_b32 s90, vcc_lo, 0xffff
    s_cbranch_scc1 WL_adaLN_cond__sliding_local_dilated__glu_gated_reglu__prompt_kernel_52
WB_adaLN_cond__sliding_local_dilated__glu_gated_reglu__prompt_kernel_51:
    ds_read_b32 v0, v108 offset:1024
    buffer_load_dwordx4 v[160:163], v14, s[68:71], s40 offen sc1
    buffer_load_dwordx4 v[164:167], v14, s[68:71], s40 offen offset:1024 sc1
    buffer_load_dwordx4 v[168:171], v14, s[68:71], s40 offen offset:2048 sc1
    buffer_load_dwordx4 v[172:175], v14, s[68:71], s40 offen offset:3072 sc1
    buffer_load_dwordx4 v[176:179], v14, s[68:71], s41 offen sc1
    buffer_load_dwordx4 v[180:183], v14, s[68:71], s41 offen offset:1024 sc1
    buffer_load_dwordx4 v[184:187], v14, s[68:71], s41 offen offset:2048 sc1
    buffer_load_dwordx4 v[188:191], v14, s[68:71], s41 offen offset:3072 sc1
    buffer_load_dwordx4 v[192:195], v14, s[68:71], s42 offen sc1
    buffer_load_dwordx4 v[196:199], v14, s[68:71], s42 offen offset:1024 sc1
    ds_inc_u32 v109, v109
    s_waitcnt lgkmcnt(1)
    v_cmp_gt_u32 vcc, 19, v0
    s_cbranch_vccnz SLOW_adaLN_cond__sliding_local_dilated__glu_gated_reglu__prompt_kernel_54
BACK_adaLN_cond__sliding_local_dilated__glu_gated_reglu__prompt_kernel_55:
    ds_read_b64_tr_b16 v[80:81], v156
    ds_read_b64_tr_b16 v[82:83], v156 offset:2048
    ds_read_b64_tr_b16 v[84:85], v157
    ds_read_b64_tr_b16 v[86:87], v157 offset:2048
    ds_read_b64_tr_b16 v[88:89], v158
    ds_read_b64_tr_b16 v[90:91], v158 offset:2048
    ds_read_b64_tr_b16 v[92:93], v159
    ds_read_b64_tr_b16 v[94:95], v159 offset:2048
    s_waitcnt vmcnt(9)
    s_waitcnt lgkmcnt(6)
    v_mfma_f32_32x32x16_bf16 v[16:31], v[80:83], v[160:163], 0
    ds_read_b64_tr_b16 v[96:97], v156 offset:4096
    ds_read_b64_tr_b16 v[98:99], v156 offset:6144
    buffer_load_dwordx4 v[200:203], v14, s[68:71], s42 offen offset:2048 sc1
    s_waitcnt lgkmcnt(6)
    v_mfma_f32_32x32x16_bf16 v[32:47], v[84:87], v[160:163], 0
    ds_read_b64_tr_b16 v[100:101], v157 offset:4096
    ds_read_b64_tr_b16 v[102:103], v157 offset:6144
    s_waitcnt lgkmcnt(6)
    v_mfma_f32_32x32x16_bf16 v[48:63], v[88:91], v[160:163], 0
    ds_read_b64_tr_b16 v[80:81], v158 offset:4096
    ds_read_b64_tr_b16 v[82:83], v158 offset:6144
    buffer_load_dwordx4 v[204:207], v14, s[68:71], s42 offen offset:3072 sc1
    s_waitcnt lgkmcnt(6)
    v_mfma_f32_32x32x16_bf16 v[64:79], v[92:95], v[160:163], 0
    ds_read_b64_tr_b16 v[84:85], v159 offset:4096
    ds_read_b64_tr_b16 v[86:87], v159 offset:6144
    s_waitcnt vmcnt(10)
    s_waitcnt lgkmcnt(6)
    v_mfma_f32_32x32x16_bf16 v[16:31], v[96:99], v[164:167], v[16:31]
    ds_read_b64_tr_b16 v[88:89], v156 offset:8192
    ds_read_b64_tr_b16 v[90:91], v156 offset:10240
    buffer_load_dwordx4 v[208:211], v14, s[68:71], s43 offen sc1
    s_waitcnt lgkmcnt(6)
    v_mfma_f32_32x32x16_bf16 v[32:47], v[100:103], v[164:167], v[32:47]
    ds_read_b64_tr_b16 v[92:93], v157 offset:8192
    ds_read_b64_tr_b16 v[94:95], v157 offset:10240
    s_waitcnt lgkmcnt(6)
    v_mfma_f32_32x32x16_bf16 v[48:63], v[80:83], v[164:167], v[48:63]
    ds_read_b64_tr_b16 v[96:97], v158 offset:8192
    ds_read_b64_tr_b16 v[98:99], v158 offset:10240
    buffer_load_dwordx4 v[212:215], v14, s[68:71], s43 offen offset:1024 sc1
    s_waitcnt lgkmcnt(6)
    v_mfma_f32_32x32x16_bf16 v[64:79], v[84:87], v[164:167], v[64:79]
    ds_read_b64_tr_b16 v[100:101], v159 offset:8192
    ds_read_b64_tr_b16 v[102:103], v159 offset:10240
    s_waitcnt vmcnt(11)
    s_waitcnt lgkmcnt(6)
    v_mfma_f32_32x32x16_bf16 v[16:31], v[88:91], v[168:171], v[16:31]
    ds_read_b64_tr_b16 v[80:81], v156 offset:12288
    ds_read_b64_tr_b16 v[82:83], v156 offset:14336
    buffer_load_dwordx4 v[216:219], v14, s[68:71], s43 offen offset:2048 sc1
    s_waitcnt lgkmcnt(6)
    v_mfma_f32_32x32x16_bf16 v[32:47], v[92:95], v[168:171], v[32:47]
    ds_read_b64_tr_b16 v[84:85], v157 offset:12288
    ds_read_b64_tr_b16 v[86:87], v157 offset:14336
    s_waitcnt lgkmcnt(6)
    v_mfma_f32_32x32x16_bf16 v[48:63], v[96:99], v[168:171], v[48:63]
    ds_read_b64_tr_b16 v[88:89], v158 offset:12288
    ds_read_b64_tr_b16 v[90:91], v158 offset:14336
    buffer_load_dwordx4 v[220:223], v14, s[68:71], s43 offen offset:3072 sc1
    s_waitcnt lgkmcnt(6)
    v_mfma_f32_32x32x16_bf16 v[64:79], v[100:103], v[168:171], v[64:79]
    ds_read_b64_tr_b16 v[92:93], v159 offset:12288
    ds_read_b64_tr_b16 v[94:95], v159 offset:14336
    ds_inc_u32 v109, v109
    s_waitcnt vmcnt(12)
    s_waitcnt lgkmcnt(7)
    v_mfma_f32_32x32x16_bf16 v[16:31], v[80:83], v[172:175], v[16:31]
    ds_read_b64_tr_b16 v[96:97], v156 offset:16384
    ds_read_b64_tr_b16 v[98:99], v156 offset:18432
    buffer_load_dwordx4 v[224:227], v14, s[68:71], s44 offen sc1
    s_waitcnt lgkmcnt(7)
    v_mfma_f32_32x32x16_bf16 v[32:47], v[84:87], v[172:175], v[32:47]
    ds_read_b64_tr_b16 v[100:101], v157 offset:16384
    ds_read_b64_tr_b16 v[102:103], v157 offset:18432
    s_waitcnt lgkmcnt(7)
    v_mfma_f32_32x32x16_bf16 v[48:63], v[88:91], v[172:175], v[48:63]
    ds_read_b64_tr_b16 v[80:81], v158 offset:16384
    ds_read_b64_tr_b16 v[82:83], v158 offset:18432
    buffer_load_dwordx4 v[228:231], v14, s[68:71], s44 offen offset:1024 sc1
    s_waitcnt lgkmcnt(7)
    v_mfma_f32_32x32x16_bf16 v[64:79], v[92:95], v[172:175], v[64:79]
    ds_read_b64_tr_b16 v[84:85], v159 offset:16384
    ds_read_b64_tr_b16 v[86:87], v159 offset:18432
    s_waitcnt vmcnt(13)
    s_waitcnt lgkmcnt(6)
    v_mfma_f32_32x32x16_bf16 v[16:31], v[96:99], v[176:179], v[16:31]
    ds_read_b64_tr_b16 v[88:89], v156 offset:20480
    ds_read_b64_tr_b16 v[90:91], v156 offset:22528
    buffer_load_dwordx4 v[232:235], v14, s[68:71], s44 offen offset:2048 sc1
    s_waitcnt lgkmcnt(6)
    v_mfma_f32_32x32x16_bf16 v[32:47], v[100:103], v[176:179], v[32:47]
    ds_read_b64_tr_b16 v[92:93], v157 offset:20480
    ds_read_b64_tr_b16 v[94:95], v157 offset:22528
    s_waitcnt lgkmcnt(6)
    v_mfma_f32_32x32x16_bf16 v[48:63], v[80:83], v[176:179], v[48:63]
    ds_read_b64_tr_b16 v[96:97], v158 offset:20480
    ds_read_b64_tr_b16 v[98:99], v158 offset:22528
    buffer_load_dwordx4 v[236:239], v14, s[68:71], s44 offen offset:3072 sc1
    s_waitcnt lgkmcnt(6)
    v_mfma_f32_32x32x16_bf16 v[64:79], v[84:87], v[176:179], v[64:79]
    ds_read_b64_tr_b16 v[100:101], v159 offset:20480
    ds_read_b64_tr_b16 v[102:103], v159 offset:22528
    s_waitcnt vmcnt(14)
    s_waitcnt lgkmcnt(6)
    v_mfma_f32_32x32x16_bf16 v[16:31], v[88:91], v[180:183], v[16:31]
    ds_read_b64_tr_b16 v[80:81], v156 offset:24576
    ds_read_b64_tr_b16 v[82:83], v156 offset:26624
    buffer_load_dwordx4 v[240:243], v14, s[68:71], s45 offen sc1
    s_waitcnt lgkmcnt(6)
    v_mfma_f32_32x32x16_bf16 v[32:47], v[92:95], v[180:183], v[32:47]
    ds_read_b64_tr_b16 v[84:85], v157 offset:24576
    ds_read_b64_tr_b16 v[86:87], v157 offset:26624
    s_waitcnt lgkmcnt(6)
    v_mfma_f32_32x32x16_bf16 v[48:63], v[96:99], v[180:183], v[48:63]
    ds_read_b64_tr_b16 v[88:89], v158 offset:24576
    ds_read_b64_tr_b16 v[90:91], v158 offset:26624
    buffer_load_dwordx4 v[244:247], v14, s[68:71], s45 offen offset:1024 sc1
    s_waitcnt lgkmcnt(6)
    v_mfma_f32_32x32x16_bf16 v[64:79], v[100:103], v[180:183], v[64:79]
    ds_read_b64_tr_b16 v[92:93], v159 offset:24576
    ds_read_b64_tr_b16 v[94:95], v159 offset:26624
    s_waitcnt vmcnt(15)
    s_waitcnt lgkmcnt(6)
    v_mfma_f32_32x32x16_bf16 v[16:31], v[80:83], v[184:187], v[16:31]
    ds_read_b64_tr_b16 v[96:97], v156 offset:28672
    ds_read_b64_tr_b16 v[98:99], v156 offset:30720
    buffer_load_dwordx4 v[248:251], v14, s[68:71], s45 offen offset:2048 sc1
    s_waitcnt lgkmcnt(6)
    v_mfma_f32_32x32x16_bf16 v[32:47], v[84:87], v[184:187], v[32:47]
    ds_read_b64_tr_b16 v[100:101], v157 offset:28672
    ds_read_b64_tr_b16 v[102:103], v157 offset:30720
    s_waitcnt lgkmcnt(6)
    v_mfma_f32_32x32x16_bf16 v[48:63], v[88:91], v[184:187], v[48:63]
    ds_read_b64_tr_b16 v[80:81], v158 offset:28672
    ds_read_b64_tr_b16 v[82:83], v158 offset:30720
    buffer_load_dwordx4 v[252:255], v14, s[68:71], s45 offen offset:3072 sc1
    s_waitcnt lgkmcnt(6)
    v_mfma_f32_32x32x16_bf16 v[64:79], v[92:95], v[184:187], v[64:79]
    ds_read_b64_tr_b16 v[84:85], v159 offset:28672
    ds_read_b64_tr_b16 v[86:87], v159 offset:30720
    ds_inc_u32 v109, v109
    s_waitcnt vmcnt(16)
    s_waitcnt lgkmcnt(7)
    v_mfma_f32_32x32x16_bf16 v[16:31], v[96:99], v[188:191], v[16:31]
    ds_read_b64_tr_b16 v[88:89], v156 offset:32768
    ds_read_b64_tr_b16 v[90:91], v156 offset:34816
    buffer_load_dwordx4 v[112:115], v14, s[68:71], s46 offen sc1
    s_waitcnt lgkmcnt(7)
    v_mfma_f32_32x32x16_bf16 v[32:47], v[100:103], v[188:191], v[32:47]
    ds_read_b64_tr_b16 v[92:93], v157 offset:32768
    ds_read_b64_tr_b16 v[94:95], v157 offset:34816
    s_waitcnt lgkmcnt(7)
    v_mfma_f32_32x32x16_bf16 v[48:63], v[80:83], v[188:191], v[48:63]
    ds_read_b64_tr_b16 v[96:97], v158 offset:32768
    ds_read_b64_tr_b16 v[98:99], v158 offset:34816
    buffer_load_dwordx4 v[116:119], v14, s[68:71], s46 offen offset:1024 sc1
    s_waitcnt lgkmcnt(7)
    v_mfma_f32_32x32x16_bf16 v[64:79], v[84:87], v[188:191], v[64:79]
    ds_read_b64_tr_b16 v[100:101], v159 offset:32768
    ds_read_b64_tr_b16 v[102:103], v159 offset:34816
    s_waitcnt vmcnt(17)
    s_waitcnt lgkmcnt(6)
    v_mfma_f32_32x32x16_bf16 v[16:31], v[88:91], v[192:195], v[16:31]
    ds_read_b64_tr_b16 v[80:81], v156 offset:36864
    ds_read_b64_tr_b16 v[82:83], v156 offset:38912
    buffer_load_dwordx4 v[120:123], v14, s[68:71], s46 offen offset:2048 sc1
    s_waitcnt lgkmcnt(6)
    v_mfma_f32_32x32x16_bf16 v[32:47], v[92:95], v[192:195], v[32:47]
    ds_read_b64_tr_b16 v[84:85], v157 offset:36864
    ds_read_b64_tr_b16 v[86:87], v157 offset:38912
    s_waitcnt lgkmcnt(6)
    v_mfma_f32_32x32x16_bf16 v[48:63], v[96:99], v[192:195], v[48:63]
    ds_read_b64_tr_b16 v[88:89], v158 offset:36864
    ds_read_b64_tr_b16 v[90:91], v158 offset:38912
    buffer_load_dwordx4 v[124:127], v14, s[68:71], s46 offen offset:3072 sc1
    s_waitcnt lgkmcnt(6)
    v_mfma_f32_32x32x16_bf16 v[64:79], v[100:103], v[192:195], v[64:79]
    ds_read_b64_tr_b16 v[92:93], v159 offset:36864
    ds_read_b64_tr_b16 v[94:95], v159 offset:38912
    s_waitcnt vmcnt(18)
    s_waitcnt lgkmcnt(6)
    v_mfma_f32_32x32x16_bf16 v[16:31], v[80:83], v[196:199], v[16:31]
    ds_read_b64_tr_b16 v[96:97], v156 offset:40960
    ds_read_b64_tr_b16 v[98:99], v156 offset:43008
    buffer_load_dwordx4 v[128:131], v14, s[68:71], s47 offen sc1
    s_waitcnt lgkmcnt(6)
    v_mfma_f32_32x32x16_bf16 v[32:47], v[84:87], v[196:199], v[32:47]
    ds_read_b64_tr_b16 v[100:101], v157 offset:40960
    ds_read_b64_tr_b16 v[102:103], v157 offset:43008
    s_waitcnt lgkmcnt(6)
    v_mfma_f32_32x32x16_bf16 v[48:63], v[88:91], v[196:199], v[48:63]
    ds_read_b64_tr_b16 v[80:81], v158 offset:40960
    ds_read_b64_tr_b16 v[82:83], v158 offset:43008
    buffer_load_dwordx4 v[132:135], v14, s[68:71], s47 offen offset:1024 sc1
    s_waitcnt lgkmcnt(6)
    v_mfma_f32_32x32x16_bf16 v[64:79], v[92:95], v[196:199], v[64:79]
    ds_read_b64_tr_b16 v[84:85], v159 offset:40960
    ds_read_b64_tr_b16 v[86:87], v159 offset:43008
    s_waitcnt vmcnt(19)
    s_waitcnt lgkmcnt(6)
    v_mfma_f32_32x32x16_bf16 v[16:31], v[96:99], v[200:203], v[16:31]
    ds_read_b64_tr_b16 v[88:89], v156 offset:45056
    ds_read_b64_tr_b16 v[90:91], v156 offset:47104
    buffer_load_dwordx4 v[136:139], v14, s[68:71], s47 offen offset:2048 sc1
    s_waitcnt lgkmcnt(6)
    v_mfma_f32_32x32x16_bf16 v[32:47], v[100:103], v[200:203], v[32:47]
    ds_read_b64_tr_b16 v[92:93], v157 offset:45056
    ds_read_b64_tr_b16 v[94:95], v157 offset:47104
    s_waitcnt lgkmcnt(6)
    v_mfma_f32_32x32x16_bf16 v[48:63], v[80:83], v[200:203], v[48:63]
    ds_read_b64_tr_b16 v[96:97], v158 offset:45056
    ds_read_b64_tr_b16 v[98:99], v158 offset:47104
    buffer_load_dwordx4 v[140:143], v14, s[68:71], s47 offen offset:3072 sc1
    s_waitcnt lgkmcnt(6)
    v_mfma_f32_32x32x16_bf16 v[64:79], v[84:87], v[200:203], v[64:79]
    ds_read_b64_tr_b16 v[100:101], v159 offset:45056
    ds_read_b64_tr_b16 v[102:103], v159 offset:47104
    ds_inc_u32 v109, v109
    s_waitcnt vmcnt(20)
    s_waitcnt lgkmcnt(7)
    v_mfma_f32_32x32x16_bf16 v[16:31], v[88:91], v[204:207], v[16:31]
    ds_read_b64_tr_b16 v[80:81], v156 offset:49152
    ds_read_b64_tr_b16 v[82:83], v156 offset:51200
    s_waitcnt lgkmcnt(7)
    v_mfma_f32_32x32x16_bf16 v[32:47], v[92:95], v[204:207], v[32:47]
    ds_read_b64_tr_b16 v[84:85], v157 offset:49152
    ds_read_b64_tr_b16 v[86:87], v157 offset:51200
    s_waitcnt lgkmcnt(7)
    v_mfma_f32_32x32x16_bf16 v[48:63], v[96:99], v[204:207], v[48:63]
    ds_read_b64_tr_b16 v[88:89], v158 offset:49152
    ds_read_b64_tr_b16 v[90:91], v158 offset:51200
    s_waitcnt lgkmcnt(7)
    v_mfma_f32_32x32x16_bf16 v[64:79], v[100:103], v[204:207], v[64:79]
    ds_read_b64_tr_b16 v[92:93], v159 offset:49152
    ds_read_b64_tr_b16 v[94:95], v159 offset:51200
    s_waitcnt vmcnt(19)
    s_waitcnt lgkmcnt(6)
    v_mfma_f32_32x32x16_bf16 v[16:31], v[80:83], v[208:211], v[16:31]
    ds_read_b64_tr_b16 v[96:97], v156 offset:53248
    ds_read_b64_tr_b16 v[98:99], v156 offset:55296
    s_waitcnt lgkmcnt(6)
    v_mfma_f32_32x32x16_bf16 v[32:47], v[84:87], v[208:211], v[32:47]
    ds_read_b64_tr_b16 v[100:101], v157 offset:53248
    ds_read_b64_tr_b16 v[102:103], v157 offset:55296
    s_waitcnt lgkmcnt(6)
    v_mfma_f32_32x32x16_bf16 v[48:63], v[88:91], v[208:211], v[48:63]
    ds_read_b64_tr_b16 v[80:81], v158 offset:53248
    ds_read_b64_tr_b16 v[82:83], v158 offset:55296
    s_waitcnt lgkmcnt(6)
    v_mfma_f32_32x32x16_bf16 v[64:79], v[92:95], v[208:211], v[64:79]
    ds_read_b64_tr_b16 v[84:85], v159 offset:53248
    ds_read_b64_tr_b16 v[86:87], v159 offset:55296
    s_waitcnt vmcnt(18)
    s_waitcnt lgkmcnt(6)
    v_mfma_f32_32x32x16_bf16 v[16:31], v[96:99], v[212:215], v[16:31]
    ds_read_b64_tr_b16 v[88:89], v156 offset:57344
    ds_read_b64_tr_b16 v[90:91], v156 offset:59392
    s_waitcnt lgkmcnt(6)
    v_mfma_f32_32x32x16_bf16 v[32:47], v[100:103], v[212:215], v[32:47]
    ds_read_b64_tr_b16 v[92:93], v157 offset:57344
    ds_read_b64_tr_b16 v[94:95], v157 offset:59392
    s_waitcnt lgkmcnt(6)
    v_mfma_f32_32x32x16_bf16 v[48:63], v[80:83], v[212:215], v[48:63]
    ds_read_b32 v0, v108 offset:1024
    ds_read_b64_tr_b16 v[96:97], v158 offset:57344
    ds_read_b64_tr_b16 v[98:99], v158 offset:59392
    s_waitcnt lgkmcnt(7)
    v_mfma_f32_32x32x16_bf16 v[64:79], v[84:87], v[212:215], v[64:79]
    ds_read_b64_tr_b16 v[100:101], v159 offset:57344
    ds_read_b64_tr_b16 v[102:103], v159 offset:59392
    s_waitcnt vmcnt(17)
    s_waitcnt lgkmcnt(7)
    v_mfma_f32_32x32x16_bf16 v[16:31], v[88:91], v[216:219], v[16:31]
    ds_read_b64_tr_b16 v[80:81], v156 offset:61440
    ds_read_b64_tr_b16 v[82:83], v156 offset:63488
    s_waitcnt lgkmcnt(7)
    v_mfma_f32_32x32x16_bf16 v[32:47], v[92:95], v[216:219], v[32:47]
    ds_read_b64_tr_b16 v[84:85], v157 offset:61440
    ds_read_b64_tr_b16 v[86:87], v157 offset:63488
    s_waitcnt lgkmcnt(6)
    v_mfma_f32_32x32x16_bf16 v[48:63], v[96:99], v[216:219], v[48:63]
    ds_read_b64_tr_b16 v[88:89], v158 offset:61440
    ds_read_b64_tr_b16 v[90:91], v158 offset:63488
    s_waitcnt lgkmcnt(6)
    v_mfma_f32_32x32x16_bf16 v[64:79], v[100:103], v[216:219], v[64:79]
    v_cmp_gt_u32 vcc, 20, v0
    s_cbranch_vccnz SLOW_adaLN_cond__sliding_local_dilated__glu_gated_reglu__prompt_kernel_56
BACK_adaLN_cond__sliding_local_dilated__glu_gated_reglu__prompt_kernel_57:
    ds_read_b64_tr_b16 v[92:93], v152
    ds_read_b64_tr_b16 v[94:95], v152 offset:2048
    s_waitcnt vmcnt(16)
    s_waitcnt lgkmcnt(6)
    v_mfma_f32_32x32x16_bf16 v[16:31], v[80:83], v[220:223], v[16:31]
    ds_read_b64_tr_b16 v[96:97], v159 offset:61440
    ds_read_b64_tr_b16 v[98:99], v159 offset:63488
    ds_inc_u32 v109, v109
    s_waitcnt lgkmcnt(7)
    v_mfma_f32_32x32x16_bf16 v[32:47], v[84:87], v[220:223], v[32:47]
    ds_read_b64_tr_b16 v[100:101], v153
    ds_read_b64_tr_b16 v[102:103], v153 offset:2048
    s_waitcnt lgkmcnt(7)
    v_mfma_f32_32x32x16_bf16 v[48:63], v[88:91], v[220:223], v[48:63]
    ds_read_b64_tr_b16 v[80:81], v152 offset:4096
    ds_read_b64_tr_b16 v[82:83], v152 offset:6144
    s_waitcnt vmcnt(15)
    s_waitcnt lgkmcnt(7)
    v_mfma_f32_32x32x16_bf16 v[16:31], v[92:95], v[224:227], v[16:31]
    ds_read_b64_tr_b16 v[84:85], v154
    ds_read_b64_tr_b16 v[86:87], v154 offset:2048
    s_waitcnt lgkmcnt(7)
    v_mfma_f32_32x32x16_bf16 v[64:79], v[96:99], v[220:223], v[64:79]
    ds_read_b64_tr_b16 v[88:89], v153 offset:4096
    ds_read_b64_tr_b16 v[90:91], v153 offset:6144
    s_waitcnt lgkmcnt(6)
    v_mfma_f32_32x32x16_bf16 v[32:47], v[100:103], v[224:227], v[32:47]
    ds_read_b64_tr_b16 v[92:93], v155
    ds_read_b64_tr_b16 v[94:95], v155 offset:2048
    s_waitcnt vmcnt(14)
    s_waitcnt lgkmcnt(6)
    v_mfma_f32_32x32x16_bf16 v[16:31], v[80:83], v[228:231], v[16:31]
    ds_read_b64_tr_b16 v[96:97], v152 offset:8192
    ds_read_b64_tr_b16 v[98:99], v152 offset:10240
    s_waitcnt lgkmcnt(6)
    v_mfma_f32_32x32x16_bf16 v[48:63], v[84:87], v[224:227], v[48:63]
    ds_read_b32 v0, v108 offset:1024
    ds_read_b64_tr_b16 v[100:101], v154 offset:4096
    ds_read_b64_tr_b16 v[102:103], v154 offset:6144
    s_waitcnt lgkmcnt(7)
    v_mfma_f32_32x32x16_bf16 v[32:47], v[88:91], v[228:231], v[32:47]
    ds_read_b64_tr_b16 v[80:81], v153 offset:8192
    ds_read_b64_tr_b16 v[82:83], v153 offset:10240
    s_waitcnt lgkmcnt(7)
    v_mfma_f32_32x32x16_bf16 v[64:79], v[92:95], v[224:227], v[64:79]
    ds_read_b64_tr_b16 v[84:85], v152 offset:12288
    ds_read_b64_tr_b16 v[86:87], v152 offset:14336
    s_waitcnt vmcnt(13)
    s_waitcnt lgkmcnt(7)
    v_mfma_f32_32x32x16_bf16 v[16:31], v[96:99], v[232:235], v[16:31]
    ds_read_b64_tr_b16 v[88:89], v155 offset:4096
    ds_read_b64_tr_b16 v[90:91], v155 offset:6144
    s_waitcnt lgkmcnt(6)
    v_mfma_f32_32x32x16_bf16 v[48:63], v[100:103], v[228:231], v[48:63]
    ds_read_b64_tr_b16 v[92:93], v154 offset:8192
    ds_read_b64_tr_b16 v[94:95], v154 offset:10240
    s_waitcnt lgkmcnt(6)
    v_mfma_f32_32x32x16_bf16 v[32:47], v[80:83], v[232:235], v[32:47]
    v_cmp_gt_u32 vcc, 21, v0
    s_cbranch_vccnz SLOW_adaLN_cond__sliding_local_dilated__glu_gated_reglu__prompt_kernel_58
BACK_adaLN_cond__sliding_local_dilated__glu_gated_reglu__prompt_kernel_59:
    ds_read_b64_tr_b16 v[96:97], v152 offset:16384
    ds_read_b64_tr_b16 v[98:99], v152 offset:18432
    s_waitcnt vmcnt(12)
    s_waitcnt lgkmcnt(6)
    v_mfma_f32_32x32x16_bf16 v[16:31], v[84:87], v[236:239], v[16:31]
    ds_read_b64_tr_b16 v[100:101], v153 offset:12288
    ds_read_b64_tr_b16 v[102:103], v153 offset:14336
    s_waitcnt lgkmcnt(6)
    v_mfma_f32_32x32x16_bf16 v[64:79], v[88:91], v[228:231], v[64:79]
    ds_read_b64_tr_b16 v[80:81], v155 offset:8192
    ds_read_b64_tr_b16 v[82:83], v155 offset:10240
    s_waitcnt lgkmcnt(6)
    v_mfma_f32_32x32x16_bf16 v[48:63], v[92:95], v[232:235], v[48:63]
    ds_read_b64_tr_b16 v[84:85], v152 offset:20480
    ds_read_b64_tr_b16 v[86:87], v152 offset:22528
    s_waitcnt vmcnt(11)
    s_waitcnt lgkmcnt(6)
    v_mfma_f32_32x32x16_bf16 v[16:31], v[96:99], v[240:243], v[16:31]
    ds_read_b64_tr_b16 v[88:89], v154 offset:12288
    ds_read_b64_tr_b16 v[90:91], v154 offset:14336
    s_waitcnt lgkmcnt(6)
    v_mfma_f32_32x32x16_bf16 v[32:47], v[100:103], v[236:239], v[32:47]
    ds_read_b64_tr_b16 v[92:93], v153 offset:16384
    ds_read_b64_tr_b16 v[94:95], v153 offset:18432
    s_waitcnt lgkmcnt(6)
    v_mfma_f32_32x32x16_bf16 v[64:79], v[80:83], v[232:235], v[64:79]
    ds_read_b64_tr_b16 v[96:97], v152 offset:24576
    ds_read_b64_tr_b16 v[98:99], v152 offset:26624
    s_waitcnt vmcnt(10)
    s_waitcnt lgkmcnt(6)
    v_mfma_f32_32x32x16_bf16 v[16:31], v[84:87], v[244:247], v[16:31]
    ds_read_b64_tr_b16 v[100:101], v155 offset:12288
    ds_read_b64_tr_b16 v[102:103], v155 offset:14336
    ds_inc_u32 v109, v109
    s_waitcnt lgkmcnt(7)
    v_mfma_f32_32x32x16_bf16 v[48:63], v[88:91], v[236:239], v[48:63]
    ds_read_b64_tr_b16 v[80:81], v153 offset:20480
    ds_read_b64_tr_b16 v[82:83], v153 offset:22528
    s_waitcnt lgkmcnt(7)
    v_mfma_f32_32x32x16_bf16 v[32:47], v[92:95], v[240:243], v[32:47]
    ds_read_b32 v0, v108 offset:1024
    ds_read_b64_tr_b16 v[84:85], v154 offset:16384
    ds_read_b64_tr_b16 v[86:87], v154 offset:18432
    s_waitcnt vmcnt(9)
    s_waitcnt lgkmcnt(8)
    v_mfma_f32_32x32x16_bf16 v[16:31], v[96:99], v[248:251], v[16:31]
    ds_read_b64_tr_b16 v[88:89], v152 offset:28672
    ds_read_b64_tr_b16 v[90:91], v152 offset:30720
    s_waitcnt lgkmcnt(8)
    v_mfma_f32_32x32x16_bf16 v[64:79], v[100:103], v[236:239], v[64:79]
    ds_read_b64_tr_b16 v[92:93], v153 offset:24576
    ds_read_b64_tr_b16 v[94:95], v153 offset:26624
    s_waitcnt lgkmcnt(7)
    v_mfma_f32_32x32x16_bf16 v[32:47], v[80:83], v[244:247], v[32:47]
    ds_read_b64_tr_b16 v[96:97], v155 offset:16384
    ds_read_b64_tr_b16 v[98:99], v155 offset:18432
    s_waitcnt lgkmcnt(6)
    v_mfma_f32_32x32x16_bf16 v[48:63], v[84:87], v[240:243], v[48:63]
    ds_read_b64_tr_b16 v[100:101], v154 offset:20480
    ds_read_b64_tr_b16 v[102:103], v154 offset:22528
    s_waitcnt vmcnt(8)
    s_waitcnt lgkmcnt(6)
    v_mfma_f32_32x32x16_bf16 v[16:31], v[88:91], v[252:255], v[16:31]
    v_cmp_gt_u32 vcc, 22, v0
    s_cbranch_vccnz SLOW_adaLN_cond__sliding_local_dilated__glu_gated_reglu__prompt_kernel_60
BACK_adaLN_cond__sliding_local_dilated__glu_gated_reglu__prompt_kernel_61:
    ds_read_b64_tr_b16 v[80:81], v152 offset:32768
    ds_read_b64_tr_b16 v[82:83], v152 offset:34816
    s_waitcnt lgkmcnt(6)
    v_mfma_f32_32x32x16_bf16 v[32:47], v[92:95], v[248:251], v[32:47]
    ds_read_b64_tr_b16 v[84:85], v153 offset:28672
    ds_read_b64_tr_b16 v[86:87], v153 offset:30720
    s_waitcnt lgkmcnt(6)
    v_mfma_f32_32x32x16_bf16 v[64:79], v[96:99], v[240:243], v[64:79]
    ds_read_b64_tr_b16 v[88:89], v152 offset:36864
    ds_read_b64_tr_b16 v[90:91], v152 offset:38912
    s_waitcnt lgkmcnt(6)
    v_mfma_f32_32x32x16_bf16 v[48:63], v[100:103], v[244:247], v[48:63]
    ds_read_b64_tr_b16 v[92:93], v154 offset:24576
    ds_read_b64_tr_b16 v[94:95], v154 offset:26624
    s_waitcnt vmcnt(7)
    s_waitcnt lgkmcnt(6)
    v_mfma_f32_32x32x16_bf16 v[16:31], v[80:83], v[112:115], v[16:31]
    ds_read_b64_tr_b16 v[96:97], v155 offset:20480
    ds_read_b64_tr_b16 v[98:99], v155 offset:22528
    s_waitcnt lgkmcnt(6)
    v_mfma_f32_32x32x16_bf16 v[32:47], v[84:87], v[252:255], v[32:47]
    ds_read_b64_tr_b16 v[100:101], v153 offset:32768
    ds_read_b64_tr_b16 v[102:103], v153 offset:34816
    s_waitcnt vmcnt(6)
    s_waitcnt lgkmcnt(6)
    v_mfma_f32_32x32x16_bf16 v[16:31], v[88:91], v[116:119], v[16:31]
    ds_read_b64_tr_b16 v[80:81], v152 offset:40960
    ds_read_b64_tr_b16 v[82:83], v152 offset:43008
    s_waitcnt lgkmcnt(6)
    v_mfma_f32_32x32x16_bf16 v[48:63], v[92:95], v[248:251], v[48:63]
    ds_read_b32 v0, v108 offset:1024
    ds_read_b64_tr_b16 v[84:85], v154 offset:28672
    ds_read_b64_tr_b16 v[86:87], v154 offset:30720
    s_waitcnt lgkmcnt(7)
    v_mfma_f32_32x32x16_bf16 v[64:79], v[96:99], v[244:247], v[64:79]
    ds_read_b64_tr_b16 v[88:89], v155 offset:24576
    ds_read_b64_tr_b16 v[90:91], v155 offset:26624
    s_waitcnt lgkmcnt(7)
    v_mfma_f32_32x32x16_bf16 v[32:47], v[100:103], v[112:115], v[32:47]
    ds_read_b64_tr_b16 v[92:93], v152 offset:45056
    ds_read_b64_tr_b16 v[94:95], v152 offset:47104
    s_waitcnt vmcnt(5)
    s_waitcnt lgkmcnt(7)
    v_mfma_f32_32x32x16_bf16 v[16:31], v[80:83], v[120:123], v[16:31]
    ds_read_b64_tr_b16 v[96:97], v153 offset:36864
    ds_read_b64_tr_b16 v[98:99], v153 offset:38912
    s_waitcnt lgkmcnt(6)
    v_mfma_f32_32x32x16_bf16 v[48:63], v[84:87], v[252:255], v[48:63]
    ds_read_b64_tr_b16 v[100:101], v154 offset:32768
    ds_read_b64_tr_b16 v[102:103], v154 offset:34816
    s_waitcnt lgkmcnt(6)
    v_mfma_f32_32x32x16_bf16 v[64:79], v[88:91], v[248:251], v[64:79]
    v_cmp_gt_u32 vcc, 23, v0
    s_cbranch_vccnz SLOW_adaLN_cond__sliding_local_dilated__glu_gated_reglu__prompt_kernel_62
BACK_adaLN_cond__sliding_local_dilated__glu_gated_reglu__prompt_kernel_63:
    ds_read_b64_tr_b16 v[80:81], v152 offset:49152
    ds_read_b64_tr_b16 v[82:83], v152 offset:51200
    s_waitcnt vmcnt(4)
    s_waitcnt lgkmcnt(6)
    v_mfma_f32_32x32x16_bf16 v[16:31], v[92:95], v[124:127], v[16:31]
    ds_read_b64_tr_b16 v[84:85], v155 offset:28672
    ds_read_b64_tr_b16 v[86:87], v155 offset:30720
    ds_inc_u32 v109, v109
    s_waitcnt lgkmcnt(7)
    v_mfma_f32_32x32x16_bf16 v[32:47], v[96:99], v[116:119], v[32:47]
    ds_read_b64_tr_b16 v[88:89], v153 offset:40960
    ds_read_b64_tr_b16 v[90:91], v153 offset:43008
    s_waitcnt lgkmcnt(7)
    v_mfma_f32_32x32x16_bf16 v[48:63], v[100:103], v[112:115], v[48:63]
    ds_read_b64_tr_b16 v[92:93], v152 offset:53248
    ds_read_b64_tr_b16 v[94:95], v152 offset:55296
    s_waitcnt vmcnt(3)
    s_waitcnt lgkmcnt(7)
    v_mfma_f32_32x32x16_bf16 v[16:31], v[80:83], v[128:131], v[16:31]
    ds_read_b64_tr_b16 v[96:97], v154 offset:36864
    ds_read_b64_tr_b16 v[98:99], v154 offset:38912
    s_waitcnt lgkmcnt(7)
    v_mfma_f32_32x32x16_bf16 v[64:79], v[84:87], v[252:255], v[64:79]
    ds_read_b64_tr_b16 v[100:101], v153 offset:45056
    ds_read_b64_tr_b16 v[102:103], v153 offset:47104
    s_waitcnt lgkmcnt(6)
    v_mfma_f32_32x32x16_bf16 v[32:47], v[88:91], v[120:123], v[32:47]
    ds_read_b64_tr_b16 v[80:81], v155 offset:32768
    ds_read_b64_tr_b16 v[82:83], v155 offset:34816
    s_waitcnt vmcnt(2)
    s_waitcnt lgkmcnt(6)
    v_mfma_f32_32x32x16_bf16 v[16:31], v[92:95], v[132:135], v[16:31]
    ds_read_b64_tr_b16 v[84:85], v152 offset:57344
    ds_read_b64_tr_b16 v[86:87], v152 offset:59392
    s_waitcnt lgkmcnt(6)
    v_mfma_f32_32x32x16_bf16 v[48:63], v[96:99], v[116:119], v[48:63]
    ds_read_b64_tr_b16 v[88:89], v154 offset:40960
    ds_read_b64_tr_b16 v[90:91], v154 offset:43008
    s_waitcnt lgkmcnt(6)
    v_mfma_f32_32x32x16_bf16 v[32:47], v[100:103], v[124:127], v[32:47]
    ds_read_b32 v0, v108 offset:1024
    ds_read_b64_tr_b16 v[92:93], v153 offset:49152
    ds_read_b64_tr_b16 v[94:95], v153 offset:51200
    s_waitcnt lgkmcnt(7)
    v_mfma_f32_32x32x16_bf16 v[64:79], v[80:83], v[112:115], v[64:79]
    ds_read_b64_tr_b16 v[96:97], v152 offset:61440
    ds_read_b64_tr_b16 v[98:99], v152 offset:63488
    s_waitcnt vmcnt(1)
    s_waitcnt lgkmcnt(7)
    v_mfma_f32_32x32x16_bf16 v[16:31], v[84:87], v[136:139], v[16:31]
    ds_read_b64_tr_b16 v[100:101], v155 offset:36864
    ds_read_b64_tr_b16 v[102:103], v155 offset:38912
    s_waitcnt lgkmcnt(7)
    v_mfma_f32_32x32x16_bf16 v[48:63], v[88:91], v[120:123], v[48:63]
    ds_read_b64_tr_b16 v[80:81], v153 offset:53248
    ds_read_b64_tr_b16 v[82:83], v153 offset:55296
    s_waitcnt lgkmcnt(6)
    v_mfma_f32_32x32x16_bf16 v[32:47], v[92:95], v[128:131], v[32:47]
    ds_read_b64_tr_b16 v[84:85], v154 offset:45056
    ds_read_b64_tr_b16 v[86:87], v154 offset:47104
    s_waitcnt vmcnt(0)
    s_waitcnt lgkmcnt(6)
    v_mfma_f32_32x32x16_bf16 v[16:31], v[96:99], v[140:143], v[16:31]
    v_cmp_gt_u32 vcc, 27, v0
    s_cbranch_vccnz SLOW_adaLN_cond__sliding_local_dilated__glu_gated_reglu__prompt_kernel_64
BACK_adaLN_cond__sliding_local_dilated__glu_gated_reglu__prompt_kernel_65:
    ds_read_b128 v[104:107], v5
    ds_read_b128 v[88:91], v4
    s_waitcnt lgkmcnt(6)
    v_mfma_f32_32x32x16_bf16 v[64:79], v[100:103], v[116:119], v[64:79]
    ds_read_b64_tr_b16 v[92:93], v155 offset:40960
    ds_read_b64_tr_b16 v[94:95], v155 offset:43008
    s_waitcnt lgkmcnt(6)
    v_mfma_f32_32x32x16_bf16 v[32:47], v[80:83], v[132:135], v[32:47]
    ds_read_b64_tr_b16 v[96:97], v153 offset:57344
    ds_read_b64_tr_b16 v[98:99], v153 offset:59392
    s_waitcnt lgkmcnt(6)
    v_mfma_f32_32x32x16_bf16 v[48:63], v[84:87], v[124:127], v[48:63]
    ds_read_b64_tr_b16 v[100:101], v154 offset:49152
    ds_read_b64_tr_b16 v[102:103], v154 offset:51200
    s_waitcnt lgkmcnt(6)
    v_mfma_f32_32x32x16_bf16 v[16:31], v[88:91], v[104:107], v[16:31]
    ds_read_b64_tr_b16 v[80:81], v153 offset:61440
    ds_read_b64_tr_b16 v[82:83], v153 offset:63488
    s_waitcnt lgkmcnt(6)
    v_mfma_f32_32x32x16_bf16 v[64:79], v[92:95], v[120:123], v[64:79]
    ds_read_b32 v0, v108 offset:1024
    ds_read_b64_tr_b16 v[84:85], v155 offset:45056
    ds_read_b64_tr_b16 v[86:87], v155 offset:47104
    ds_inc_u32 v109, v109
    s_waitcnt lgkmcnt(8)
    v_mfma_f32_32x32x16_bf16 v[32:47], v[96:99], v[136:139], v[32:47]
    ds_read_b64_tr_b16 v[88:89], v154 offset:53248
    ds_read_b64_tr_b16 v[90:91], v154 offset:55296
    s_waitcnt lgkmcnt(8)
    v_mfma_f32_32x32x16_bf16 v[48:63], v[100:103], v[128:131], v[48:63]
    ds_read_b128 v[92:95], v4 offset:512
    v_max_f32 v16, 0, v16
    v_max_f32 v17, 0, v17
    v_max_f32 v18, 0, v18
    s_waitcnt lgkmcnt(7)
    v_mfma_f32_32x32x16_bf16 v[32:47], v[80:83], v[140:143], v[32:47]
    ds_read_b64_tr_b16 v[96:97], v155 offset:49152
    ds_read_b64_tr_b16 v[98:99], v155 offset:51200
    v_max_f32 v19, 0, v19
    v_max_f32 v20, 0, v20
    v_max_f32 v21, 0, v21
    s_waitcnt lgkmcnt(6)
    v_mfma_f32_32x32x16_bf16 v[64:79], v[84:87], v[124:127], v[64:79]
    ds_read_b64_tr_b16 v[100:101], v154 offset:57344
    ds_read_b64_tr_b16 v[102:103], v154 offset:59392
    v_max_f32 v22, 0, v22
    v_max_f32 v23, 0, v23
    v_mul_f32 v16, v16, v24
    s_waitcnt lgkmcnt(5)
    v_mfma_f32_32x32x16_bf16 v[48:63], v[88:91], v[132:135], v[48:63]
    v_cmp_gt_u32 vcc, 25, v0
    s_cbranch_vccnz SLOW_adaLN_cond__sliding_local_dilated__glu_gated_reglu__prompt_kernel_66
BACK_adaLN_cond__sliding_local_dilated__glu_gated_reglu__prompt_kernel_67:
    ds_read_b64_tr_b16 v[80:81], v156
    ds_read_b64_tr_b16 v[82:83], v156 offset:2048
    v_mul_f32 v17, v17, v25
    v_mul_f32 v18, v18, v26
    v_mul_f32 v19, v19, v27
    s_waitcnt lgkmcnt(6)
    v_mfma_f32_32x32x16_bf16 v[32:47], v[92:95], v[104:107], v[32:47]
    ds_read_b32 v0, v108 offset:1024
    ds_read_b64_tr_b16 v[84:85], v156 offset:4096
    ds_read_b64_tr_b16 v[86:87], v156 offset:6144
    v_mul_f32 v20, v20, v28
    v_mul_f32 v21, v21, v29
    v_mul_f32 v22, v22, v30
    s_waitcnt lgkmcnt(7)
    v_mfma_f32_32x32x16_bf16 v[64:79], v[96:99], v[128:131], v[64:79]
    ds_read_b64_tr_b16 v[88:89], v156 offset:8192
    ds_read_b64_tr_b16 v[90:91], v156 offset:10240
    v_mul_f32 v23, v23, v31
    v_cvt_pk_bf16_f32 v24, v16, v17
    v_cvt_pk_bf16_f32 v25, v18, v19
    s_waitcnt lgkmcnt(7)
    v_mfma_f32_32x32x16_bf16 v[48:63], v[100:103], v[136:139], v[48:63]
    ds_read_b64_tr_b16 v[92:93], v156 offset:12288
    ds_read_b64_tr_b16 v[94:95], v156 offset:14336
    v_cvt_pk_bf16_f32 v26, v20, v21
    v_cvt_pk_bf16_f32 v27, v22, v23
    buffer_store_dwordx4 v[24:27], v14, s[68:71], s94 offen sc1
    s_waitcnt lgkmcnt(7)
    s_nop 0
    v_mfma_f32_32x32x16_bf16 v[16:31], v[80:83], v[160:163], 0
    ds_read_b64_tr_b16 v[96:97], v154 offset:61440
    ds_read_b64_tr_b16 v[98:99], v154 offset:63488
    v_max_f32 v32, 0, v32
    v_max_f32 v33, 0, v33
    v_max_f32 v34, 0, v34
    s_waitcnt lgkmcnt(6)
    v_mfma_f32_32x32x16_bf16 v[16:31], v[84:87], v[164:167], v[16:31]
    ds_read_b64_tr_b16 v[100:101], v155 offset:53248
    ds_read_b64_tr_b16 v[102:103], v155 offset:55296
    v_max_f32 v35, 0, v35
    v_max_f32 v36, 0, v36
    v_max_f32 v37, 0, v37
    s_waitcnt lgkmcnt(6)
    v_mfma_f32_32x32x16_bf16 v[16:31], v[88:91], v[168:171], v[16:31]
    v_cmp_gt_u32 vcc, 26, v0
    s_cbranch_vccnz SLOW_adaLN_cond__sliding_local_dilated__glu_gated_reglu__prompt_kernel_68
BACK_adaLN_cond__sliding_local_dilated__glu_gated_reglu__prompt_kernel_69:
    ds_read_b64_tr_b16 v[80:81], v156 offset:16384
    ds_read_b64_tr_b16 v[82:83], v156 offset:18432
    v_max_f32 v38, 0, v38
    v_max_f32 v39, 0, v39
    v_mul_f32 v32, v32, v40
    s_waitcnt lgkmcnt(6)
    v_mfma_f32_32x32x16_bf16 v[16:31], v[92:95], v[172:175], v[16:31]
    ds_read_b32 v0, v108 offset:1024
    ds_read_b64_tr_b16 v[84:85], v156 offset:20480
    ds_read_b64_tr_b16 v[86:87], v156 offset:22528
    v_mul_f32 v33, v33, v41
    v_mul_f32 v34, v34, v42
    v_mul_f32 v35, v35, v43
    s_waitcnt lgkmcnt(7)
    v_mfma_f32_32x32x16_bf16 v[48:63], v[96:99], v[140:143], v[48:63]
    ds_read_b64_tr_b16 v[88:89], v156 offset:24576
    ds_read_b64_tr_b16 v[90:91], v156 offset:26624
    v_mul_f32 v36, v36, v44
    v_mul_f32 v37, v37, v45
    v_mul_f32 v38, v38, v46
    s_waitcnt lgkmcnt(7)
    v_mfma_f32_32x32x16_bf16 v[64:79], v[100:103], v[132:135], v[64:79]
    ds_read_b64_tr_b16 v[92:93], v156 offset:28672
    ds_read_b64_tr_b16 v[94:95], v156 offset:30720
    v_mul_f32 v39, v39, v47
    v_cvt_pk_bf16_f32 v40, v32, v33
    v_cvt_pk_bf16_f32 v41, v34, v35
    s_waitcnt lgkmcnt(7)
    v_mfma_f32_32x32x16_bf16 v[16:31], v[80:83], v[176:179], v[16:31]
    ds_read_b128 v[96:99], v4 offset:1024
    v_cvt_pk_bf16_f32 v42, v36, v37
    v_cvt_pk_bf16_f32 v43, v38, v39
    buffer_store_dwordx4 v[40:43], v14, s[68:71], s94 offen offset:1024 sc1
    s_waitcnt lgkmcnt(5)
    v_mfma_f32_32x32x16_bf16 v[16:31], v[84:87], v[180:183], v[16:31]
    ds_read_b64_tr_b16 v[100:101], v155 offset:57344
    ds_read_b64_tr_b16 v[102:103], v155 offset:59392
    s_waitcnt lgkmcnt(5)
    v_mfma_f32_32x32x16_bf16 v[16:31], v[88:91], v[184:187], v[16:31]
    v_cmp_gt_u32 vcc, 28, v0
    s_cbranch_vccnz SLOW_adaLN_cond__sliding_local_dilated__glu_gated_reglu__prompt_kernel_70
BACK_adaLN_cond__sliding_local_dilated__glu_gated_reglu__prompt_kernel_71:
    ds_read_b64_tr_b16 v[80:81], v156 offset:32768
    ds_read_b64_tr_b16 v[82:83], v156 offset:34816
    s_waitcnt lgkmcnt(5)
    v_mfma_f32_32x32x16_bf16 v[16:31], v[92:95], v[188:191], v[16:31]
    ds_read_b64_tr_b16 v[84:85], v156 offset:36864
    ds_read_b64_tr_b16 v[86:87], v156 offset:38912
    s_waitcnt lgkmcnt(6)
    v_mfma_f32_32x32x16_bf16 v[48:63], v[96:99], v[104:107], v[48:63]
    ds_read_b32 v0, v108 offset:1024
    ds_read_b64_tr_b16 v[88:89], v157
    ds_read_b64_tr_b16 v[90:91], v157 offset:2048
    s_waitcnt lgkmcnt(7)
    v_mfma_f32_32x32x16_bf16 v[64:79], v[100:103], v[136:139], v[64:79]
    ds_read_b64_tr_b16 v[92:93], v156 offset:40960
    ds_read_b64_tr_b16 v[94:95], v156 offset:43008
    s_waitcnt lgkmcnt(7)
    v_mfma_f32_32x32x16_bf16 v[16:31], v[80:83], v[192:195], v[16:31]
    ds_read_b64_tr_b16 v[96:97], v157 offset:4096
    ds_read_b64_tr_b16 v[98:99], v157 offset:6144
    s_waitcnt lgkmcnt(7)
    v_mfma_f32_32x32x16_bf16 v[16:31], v[84:87], v[196:199], v[16:31]
    ds_read_b64_tr_b16 v[100:101], v156 offset:45056
    ds_read_b64_tr_b16 v[102:103], v156 offset:47104
    v_max_f32 v48, 0, v48
    v_max_f32 v49, 0, v49
    v_max_f32 v50, 0, v50
    s_waitcnt lgkmcnt(6)
    v_mfma_f32_32x32x16_bf16 v[32:47], v[88:91], v[160:163], 0
    ds_read_b64_tr_b16 v[80:81], v157 offset:8192
    ds_read_b64_tr_b16 v[82:83], v157 offset:10240
    v_max_f32 v51, 0, v51
    v_max_f32 v52, 0, v52
    v_max_f32 v53, 0, v53
    s_waitcnt lgkmcnt(6)
    v_mfma_f32_32x32x16_bf16 v[16:31], v[92:95], v[200:203], v[16:31]
    v_cmp_gt_u32 vcc, 29, v0
    s_cbranch_vccnz SLOW_adaLN_cond__sliding_local_dilated__glu_gated_reglu__prompt_kernel_72
BACK_adaLN_cond__sliding_local_dilated__glu_gated_reglu__prompt_kernel_73:
    ds_read_b64_tr_b16 v[84:85], v156 offset:49152
    ds_read_b64_tr_b16 v[86:87], v156 offset:51200
    v_max_f32 v54, 0, v54
    v_max_f32 v55, 0, v55
    v_mul_f32 v48, v48, v56
    s_waitcnt lgkmcnt(6)
    v_mfma_f32_32x32x16_bf16 v[32:47], v[96:99], v[164:167], v[32:47]
    ds_read_b64_tr_b16 v[88:89], v157 offset:12288
    ds_read_b64_tr_b16 v[90:91], v157 offset:14336
    v_mul_f32 v49, v49, v57
    v_mul_f32 v50, v50, v58
    v_mul_f32 v51, v51, v59
    s_waitcnt lgkmcnt(6)
    v_mfma_f32_32x32x16_bf16 v[16:31], v[100:103], v[204:207], v[16:31]
    ds_read_b64_tr_b16 v[92:93], v155 offset:61440
    ds_read_b64_tr_b16 v[94:95], v155 offset:63488
    ds_inc_u32 v109, v109
    v_mul_f32 v52, v52, v60
    v_mul_f32 v53, v53, v61
    v_mul_f32 v54, v54, v62
    s_waitcnt lgkmcnt(7)
    v_mfma_f32_32x32x16_bf16 v[32:47], v[80:83], v[168:171], v[32:47]
    ds_read_b64_tr_b16 v[96:97], v157 offset:16384
    ds_read_b64_tr_b16 v[98:99], v157 offset:18432
    v_mul_f32 v55, v55, v63
    v_cvt_pk_bf16_f32 v56, v48, v49
    v_cvt_pk_bf16_f32 v57, v50, v51
    s_waitcnt lgkmcnt(7)
    v_mfma_f32_32x32x16_bf16 v[16:31], v[84:87], v[208:211], v[16:31]
    ds_read_b64_tr_b16 v[100:101], v156 offset:53248
    ds_read_b64_tr_b16 v[102:103], v156 offset:55296
    v_cvt_pk_bf16_f32 v58, v52, v53
    v_cvt_pk_bf16_f32 v59, v54, v55
    buffer_store_dwordx4 v[56:59], v14, s[68:71], s94 offen offset:2048 sc1
    s_waitcnt lgkmcnt(7)
    v_mfma_f32_32x32x16_bf16 v[32:47], v[88:91], v[172:175], v[32:47]
    ds_read_b32 v0, v108 offset:1024
    ds_read_b64_tr_b16 v[80:81], v157 offset:20480
    ds_read_b64_tr_b16 v[82:83], v157 offset:22528
    s_waitcnt lgkmcnt(8)
    v_mfma_f32_32x32x16_bf16 v[64:79], v[92:95], v[140:143], v[64:79]
    ds_read_b64_tr_b16 v[84:85], v156 offset:57344
    ds_read_b64_tr_b16 v[86:87], v156 offset:59392
    s_waitcnt lgkmcnt(7)
    v_mfma_f32_32x32x16_bf16 v[32:47], v[96:99], v[176:179], v[32:47]
    ds_read_b64_tr_b16 v[88:89], v157 offset:24576
    ds_read_b64_tr_b16 v[90:91], v157 offset:26624
    s_waitcnt lgkmcnt(7)
    v_mfma_f32_32x32x16_bf16 v[16:31], v[100:103], v[212:215], v[16:31]
    ds_read_b64_tr_b16 v[92:93], v156 offset:61440
    ds_read_b64_tr_b16 v[94:95], v156 offset:63488
    s_waitcnt lgkmcnt(6)
    v_mfma_f32_32x32x16_bf16 v[32:47], v[80:83], v[180:183], v[32:47]
    ds_read_b64_tr_b16 v[96:97], v157 offset:28672
    ds_read_b64_tr_b16 v[98:99], v157 offset:30720
    s_waitcnt lgkmcnt(6)
    v_mfma_f32_32x32x16_bf16 v[16:31], v[84:87], v[216:219], v[16:31]
    v_cmp_gt_u32 vcc, 30, v0
    s_cbranch_vccnz SLOW_adaLN_cond__sliding_local_dilated__glu_gated_reglu__prompt_kernel_74
BACK_adaLN_cond__sliding_local_dilated__glu_gated_reglu__prompt_kernel_75:
    ds_read_b64_tr_b16 v[100:101], v152
    ds_read_b64_tr_b16 v[102:103], v152 offset:2048
    s_waitcnt lgkmcnt(6)
    v_mfma_f32_32x32x16_bf16 v[32:47], v[88:91], v[184:187], v[32:47]
    ds_read_b128 v[80:83], v4 offset:1536
    s_waitcnt lgkmcnt(5)
    v_mfma_f32_32x32x16_bf16 v[16:31], v[92:95], v[220:223], v[16:31]
    ds_read_b64_tr_b16 v[84:85], v157 offset:32768
    ds_read_b64_tr_b16 v[86:87], v157 offset:34816
    s_waitcnt lgkmcnt(5)
    v_mfma_f32_32x32x16_bf16 v[32:47], v[96:99], v[188:191], v[32:47]
    ds_read_b64_tr_b16 v[88:89], v152 offset:4096
    ds_read_b64_tr_b16 v[90:91], v152 offset:6144
    s_waitcnt lgkmcnt(5)
    v_mfma_f32_32x32x16_bf16 v[16:31], v[100:103], v[224:227], v[16:31]
    ds_read_b64_tr_b16 v[92:93], v157 offset:36864
    ds_read_b64_tr_b16 v[94:95], v157 offset:38912
    s_waitcnt lgkmcnt(6)
    v_mfma_f32_32x32x16_bf16 v[64:79], v[80:83], v[104:107], v[64:79]
    ds_read_b32 v0, v108 offset:1024
    ds_read_b64_tr_b16 v[96:97], v152 offset:8192
    ds_read_b64_tr_b16 v[98:99], v152 offset:10240
    s_waitcnt lgkmcnt(7)
    v_mfma_f32_32x32x16_bf16 v[32:47], v[84:87], v[192:195], v[32:47]
    ds_read_b64_tr_b16 v[100:101], v158
    ds_read_b64_tr_b16 v[102:103], v158 offset:2048
    s_waitcnt lgkmcnt(7)
    v_mfma_f32_32x32x16_bf16 v[16:31], v[88:91], v[228:231], v[16:31]
    ds_read_b64_tr_b16 v[80:81], v157 offset:40960
    ds_read_b64_tr_b16 v[82:83], v157 offset:43008
    s_waitcnt lgkmcnt(7)
    v_mfma_f32_32x32x16_bf16 v[32:47], v[92:95], v[196:199], v[32:47]
    ds_read_b64_tr_b16 v[84:85], v152 offset:12288
    ds_read_b64_tr_b16 v[86:87], v152 offset:14336
    v_max_f32 v64, 0, v64
    v_max_f32 v65, 0, v65
    v_max_f32 v66, 0, v66
    s_waitcnt lgkmcnt(6)
    v_mfma_f32_32x32x16_bf16 v[16:31], v[96:99], v[232:235], v[16:31]
    ds_read_b64_tr_b16 v[88:89], v157 offset:45056
    ds_read_b64_tr_b16 v[90:91], v157 offset:47104
    v_max_f32 v67, 0, v67
    v_max_f32 v68, 0, v68
    v_max_f32 v69, 0, v69
    s_waitcnt lgkmcnt(6)
    v_mfma_f32_32x32x16_bf16 v[48:63], v[100:103], v[160:163], 0
    v_cmp_gt_u32 vcc, 31, v0
    s_cbranch_vccnz SLOW_adaLN_cond__sliding_local_dilated__glu_gated_reglu__prompt_kernel_76
BACK_adaLN_cond__sliding_local_dilated__glu_gated_reglu__prompt_kernel_77:
    ds_read_b64_tr_b16 v[92:93], v152 offset:16384
    ds_read_b64_tr_b16 v[94:95], v152 offset:18432
    v_max_f32 v70, 0, v70
    v_max_f32 v71, 0, v71
    v_mul_f32 v64, v64, v72
    s_waitcnt lgkmcnt(6)
    v_mfma_f32_32x32x16_bf16 v[32:47], v[80:83], v[200:203], v[32:47]
    ds_read_b64_tr_b16 v[96:97], v157 offset:49152
    ds_read_b64_tr_b16 v[98:99], v157 offset:51200
    v_mul_f32 v65, v65, v73
    v_mul_f32 v66, v66, v74
    v_mul_f32 v67, v67, v75
    s_waitcnt lgkmcnt(6)
    v_mfma_f32_32x32x16_bf16 v[16:31], v[84:87], v[236:239], v[16:31]
    ds_read_b64_tr_b16 v[100:101], v152 offset:20480
    ds_read_b64_tr_b16 v[102:103], v152 offset:22528
    v_mul_f32 v68, v68, v76
    v_mul_f32 v69, v69, v77
    v_mul_f32 v70, v70, v78
    s_waitcnt lgkmcnt(6)
    v_mfma_f32_32x32x16_bf16 v[32:47], v[88:91], v[204:207], v[32:47]
    ds_read_b32 v0, v108 offset:1024
    ds_read_b64_tr_b16 v[80:81], v157 offset:53248
    ds_read_b64_tr_b16 v[82:83], v157 offset:55296
    v_mul_f32 v71, v71, v79
    v_cvt_pk_bf16_f32 v72, v64, v65
    v_cvt_pk_bf16_f32 v73, v66, v67
    s_waitcnt lgkmcnt(7)
    v_mfma_f32_32x32x16_bf16 v[16:31], v[92:95], v[240:243], v[16:31]
    ds_read_b64_tr_b16 v[84:85], v152 offset:24576
    ds_read_b64_tr_b16 v[86:87], v152 offset:26624
    v_cvt_pk_bf16_f32 v74, v68, v69
    v_cvt_pk_bf16_f32 v75, v70, v71
    buffer_store_dwordx4 v[72:75], v14, s[68:71], s94 offen offset:3072 sc1
    s_waitcnt lgkmcnt(7)
    v_mfma_f32_32x32x16_bf16 v[32:47], v[96:99], v[208:211], v[32:47]
    ds_read_b64_tr_b16 v[88:89], v157 offset:57344
    ds_read_b64_tr_b16 v[90:91], v157 offset:59392
    s_waitcnt lgkmcnt(7)
    v_mfma_f32_32x32x16_bf16 v[16:31], v[100:103], v[244:247], v[16:31]
    ds_read_b64_tr_b16 v[92:93], v152 offset:28672
    ds_read_b64_tr_b16 v[94:95], v152 offset:30720
    s_waitcnt lgkmcnt(6)
    v_mfma_f32_32x32x16_bf16 v[32:47], v[80:83], v[212:215], v[32:47]
    ds_read_b64_tr_b16 v[96:97], v157 offset:61440
    ds_read_b64_tr_b16 v[98:99], v157 offset:63488
    s_waitcnt lgkmcnt(6)
    v_mfma_f32_32x32x16_bf16 v[16:31], v[84:87], v[248:251], v[16:31]
    v_cmp_gt_u32 vcc, 32, v0
    s_cbranch_vccnz SLOW_adaLN_cond__sliding_local_dilated__glu_gated_reglu__prompt_kernel_78
BACK_adaLN_cond__sliding_local_dilated__glu_gated_reglu__prompt_kernel_79:
    ds_read_b64_tr_b16 v[100:101], v152 offset:32768
    ds_read_b64_tr_b16 v[102:103], v152 offset:34816
    s_waitcnt lgkmcnt(6)
    v_mfma_f32_32x32x16_bf16 v[32:47], v[88:91], v[216:219], v[32:47]
    ds_read_b64_tr_b16 v[80:81], v153
    ds_read_b64_tr_b16 v[82:83], v153 offset:2048
    s_waitcnt lgkmcnt(6)
    v_mfma_f32_32x32x16_bf16 v[16:31], v[92:95], v[252:255], v[16:31]
    ds_read_b64_tr_b16 v[84:85], v158 offset:4096
    ds_read_b64_tr_b16 v[86:87], v158 offset:6144
    s_waitcnt lgkmcnt(6)
    v_mfma_f32_32x32x16_bf16 v[32:47], v[96:99], v[220:223], v[32:47]
    ds_read_b64_tr_b16 v[88:89], v152 offset:36864
    ds_read_b64_tr_b16 v[90:91], v152 offset:38912
    s_waitcnt lgkmcnt(6)
    v_mfma_f32_32x32x16_bf16 v[16:31], v[100:103], v[112:115], v[16:31]
    ds_read_b64_tr_b16 v[92:93], v153 offset:4096
    ds_read_b64_tr_b16 v[94:95], v153 offset:6144
    s_waitcnt lgkmcnt(6)
    v_mfma_f32_32x32x16_bf16 v[32:47], v[80:83], v[224:227], v[32:47]
    ds_read_b32 v0, v108 offset:1024
    ds_read_b64_tr_b16 v[96:97], v152 offset:40960
    ds_read_b64_tr_b16 v[98:99], v152 offset:43008
    s_waitcnt lgkmcnt(7)
    v_mfma_f32_32x32x16_bf16 v[48:63], v[84:87], v[164:167], v[48:63]
    ds_read_b64_tr_b16 v[100:101], v153 offset:8192
    ds_read_b64_tr_b16 v[102:103], v153 offset:10240
    s_waitcnt lgkmcnt(7)
    v_mfma_f32_32x32x16_bf16 v[16:31], v[88:91], v[116:119], v[16:31]
    ds_read_b64_tr_b16 v[80:81], v152 offset:45056
    ds_read_b64_tr_b16 v[82:83], v152 offset:47104
    s_waitcnt lgkmcnt(7)
    v_mfma_f32_32x32x16_bf16 v[32:47], v[92:95], v[228:231], v[32:47]
    ds_read_b64_tr_b16 v[84:85], v153 offset:12288
    ds_read_b64_tr_b16 v[86:87], v153 offset:14336
    s_waitcnt lgkmcnt(6)
    v_mfma_f32_32x32x16_bf16 v[16:31], v[96:99], v[120:123], v[16:31]
    ds_read_b64_tr_b16 v[88:89], v159
    ds_read_b64_tr_b16 v[90:91], v159 offset:2048
    s_waitcnt lgkmcnt(6)
    v_mfma_f32_32x32x16_bf16 v[32:47], v[100:103], v[232:235], v[32:47]
    v_cmp_gt_u32 vcc, 33, v0
    s_cbranch_vccnz SLOW_adaLN_cond__sliding_local_dilated__glu_gated_reglu__prompt_kernel_80
BACK_adaLN_cond__sliding_local_dilated__glu_gated_reglu__prompt_kernel_81:
    ds_read_b64_tr_b16 v[92:93], v152 offset:49152
    ds_read_b64_tr_b16 v[94:95], v152 offset:51200
    s_waitcnt lgkmcnt(6)
    v_mfma_f32_32x32x16_bf16 v[16:31], v[80:83], v[124:127], v[16:31]
    ds_read_b64_tr_b16 v[96:97], v153 offset:16384
    ds_read_b64_tr_b16 v[98:99], v153 offset:18432
    s_waitcnt lgkmcnt(6)
    v_mfma_f32_32x32x16_bf16 v[32:47], v[84:87], v[236:239], v[32:47]
    ds_read_b64_tr_b16 v[100:101], v153 offset:20480
    ds_read_b64_tr_b16 v[102:103], v153 offset:22528
    s_waitcnt lgkmcnt(6)
    v_mfma_f32_32x32x16_bf16 v[64:79], v[88:91], v[160:163], 0
    ds_read_b64_tr_b16 v[80:81], v152 offset:53248
    ds_read_b64_tr_b16 v[82:83], v152 offset:55296
    s_waitcnt lgkmcnt(6)
    v_mfma_f32_32x32x16_bf16 v[16:31], v[92:95], v[128:131], v[16:31]
    ds_read_b64_tr_b16 v[84:85], v153 offset:24576
    ds_read_b64_tr_b16 v[86:87], v153 offset:26624
    s_waitcnt lgkmcnt(6)
    v_mfma_f32_32x32x16_bf16 v[32:47], v[96:99], v[240:243], v[32:47]
    ds_read_b64_tr_b16 v[88:89], v152 offset:57344
    ds_read_b64_tr_b16 v[90:91], v152 offset:59392
    s_waitcnt lgkmcnt(6)
    v_mfma_f32_32x32x16_bf16 v[32:47], v[100:103], v[244:247], v[32:47]
    ds_read_b64_tr_b16 v[92:93], v153 offset:28672
    ds_read_b64_tr_b16 v[94:95], v153 offset:30720
    s_waitcnt lgkmcnt(6)
    v_mfma_f32_32x32x16_bf16 v[16:31], v[80:83], v[132:135], v[16:31]
    ds_read_b64_tr_b16 v[96:97], v152 offset:61440
    ds_read_b64_tr_b16 v[98:99], v152 offset:63488
    s_waitcnt vmcnt(0)
    v_mov_b32 v11, s77
    s_mov_b64 exec, 1
    buffer_store_dword v11, off, s[68:71], s58
    s_mov_b64 exec, -1
    ds_inc_u32 v109, v109
    s_waitcnt lgkmcnt(7)
    v_mfma_f32_32x32x16_bf16 v[32:47], v[84:87], v[248:251], v[32:47]
    ds_read_b64_tr_b16 v[100:101], v158 offset:8192
    ds_read_b64_tr_b16 v[102:103], v158 offset:10240
    s_waitcnt lgkmcnt(7)
    v_mfma_f32_32x32x16_bf16 v[16:31], v[88:91], v[136:139], v[16:31]
    ds_read_b64_tr_b16 v[80:81], v153 offset:32768
    ds_read_b64_tr_b16 v[82:83], v153 offset:34816
    s_waitcnt lgkmcnt(7)
    v_mfma_f32_32x32x16_bf16 v[32:47], v[92:95], v[252:255], v[32:47]
    ds_read_b128 v[84:87], v4 offset:2048
    s_waitcnt lgkmcnt(6)
    v_mfma_f32_32x32x16_bf16 v[16:31], v[96:99], v[140:143], v[16:31]
    ds_read_b64_tr_b16 v[88:89], v153 offset:36864
    ds_read_b64_tr_b16 v[90:91], v153 offset:38912
    s_waitcnt lgkmcnt(5)
    v_mfma_f32_32x32x16_bf16 v[48:63], v[100:103], v[168:171], v[48:63]
    ds_read_b64_tr_b16 v[92:93], v153 offset:40960
    ds_read_b64_tr_b16 v[94:95], v153 offset:43008
    s_waitcnt lgkmcnt(5)
    v_mfma_f32_32x32x16_bf16 v[32:47], v[80:83], v[112:115], v[32:47]
    ds_read_b64_tr_b16 v[96:97], v159 offset:4096
    ds_read_b64_tr_b16 v[98:99], v159 offset:6144
    buffer_load_dword v10, v12, s[68:71], s61 offen sc1
    s_waitcnt lgkmcnt(6)
    v_mfma_f32_32x32x16_bf16 v[16:31], v[84:87], v[104:107], v[16:31]
    ds_read_b64_tr_b16 v[100:101], v153 offset:45056
    ds_read_b64_tr_b16 v[102:103], v153 offset:47104
    s_waitcnt lgkmcnt(6)
    v_mfma_f32_32x32x16_bf16 v[32:47], v[88:91], v[116:119], v[32:47]
    ds_read_b64_tr_b16 v[80:81], v153 offset:49152
    ds_read_b64_tr_b16 v[82:83], v153 offset:51200
    s_waitcnt lgkmcnt(6)
    v_mfma_f32_32x32x16_bf16 v[32:47], v[92:95], v[120:123], v[32:47]
    ds_read_b64_tr_b16 v[84:85], v153 offset:53248
    ds_read_b64_tr_b16 v[86:87], v153 offset:55296
    s_waitcnt lgkmcnt(6)
    v_mfma_f32_32x32x16_bf16 v[64:79], v[96:99], v[164:167], v[64:79]
    ds_read_b64_tr_b16 v[88:89], v153 offset:57344
    ds_read_b64_tr_b16 v[90:91], v153 offset:59392
    v_max_f32 v16, 0, v16
    v_max_f32 v17, 0, v17
    v_max_f32 v18, 0, v18
    s_waitcnt lgkmcnt(6)
    v_mfma_f32_32x32x16_bf16 v[32:47], v[100:103], v[124:127], v[32:47]
    ds_read_b64_tr_b16 v[92:93], v158 offset:12288
    ds_read_b64_tr_b16 v[94:95], v158 offset:14336
    v_max_f32 v19, 0, v19
    v_max_f32 v20, 0, v20
    v_max_f32 v21, 0, v21
    s_waitcnt lgkmcnt(6)
    v_mfma_f32_32x32x16_bf16 v[32:47], v[80:83], v[128:131], v[32:47]
    ds_read_b64_tr_b16 v[96:97], v153 offset:61440
    ds_read_b64_tr_b16 v[98:99], v153 offset:63488
    v_max_f32 v22, 0, v22
    v_max_f32 v23, 0, v23
    v_mul_f32 v16, v16, v24
    s_waitcnt lgkmcnt(6)
    v_mfma_f32_32x32x16_bf16 v[32:47], v[84:87], v[132:135], v[32:47]
    ds_read_b128 v[100:103], v4 offset:2560
    v_mul_f32 v17, v17, v25
    v_mul_f32 v18, v18, v26
    v_mul_f32 v19, v19, v27
    s_waitcnt lgkmcnt(5)
    v_mfma_f32_32x32x16_bf16 v[32:47], v[88:91], v[136:139], v[32:47]
    ds_read_b64_tr_b16 v[80:81], v159 offset:8192
    ds_read_b64_tr_b16 v[82:83], v159 offset:10240
    v_mul_f32 v20, v20, v28
    v_mul_f32 v21, v21, v29
    v_mul_f32 v22, v22, v30
    s_waitcnt lgkmcnt(5)
    v_mfma_f32_32x32x16_bf16 v[48:63], v[92:95], v[172:175], v[48:63]
    ds_read_b64_tr_b16 v[84:85], v158 offset:16384
    ds_read_b64_tr_b16 v[86:87], v158 offset:18432
    v_mul_f32 v23, v23, v31
    v_cvt_pk_bf16_f32 v24, v16, v17
    v_cvt_pk_bf16_f32 v25, v18, v19
    s_waitcnt lgkmcnt(5)
    v_mfma_f32_32x32x16_bf16 v[32:47], v[96:99], v[140:143], v[32:47]
    ds_read_b64_tr_b16 v[88:89], v159 offset:12288
    ds_read_b64_tr_b16 v[90:91], v159 offset:14336
    ds_inc_u32 v109, v109
    v_cvt_pk_bf16_f32 v26, v20, v21
    v_cvt_pk_bf16_f32 v27, v22, v23
    buffer_store_dwordx4 v[24:27], v14, s[68:71], s101 offen sc1
    s_waitcnt lgkmcnt(7)
    v_mfma_f32_32x32x16_bf16 v[32:47], v[100:103], v[104:107], v[32:47]
    ds_read_b64_tr_b16 v[92:93], v158 offset:20480
    ds_read_b64_tr_b16 v[94:95], v158 offset:22528
    s_waitcnt lgkmcnt(7)
    v_mfma_f32_32x32x16_bf16 v[64:79], v[80:83], v[168:171], v[64:79]
    ds_read_b64_tr_b16 v[96:97], v159 offset:16384
    ds_read_b64_tr_b16 v[98:99], v159 offset:18432
    s_waitcnt lgkmcnt(7)
    v_mfma_f32_32x32x16_bf16 v[48:63], v[84:87], v[176:179], v[48:63]
    ds_read_b64_tr_b16 v[100:101], v158 offset:24576
    ds_read_b64_tr_b16 v[102:103], v158 offset:26624
    s_waitcnt lgkmcnt(7)
    v_mfma_f32_32x32x16_bf16 v[64:79], v[88:91], v[172:175], v[64:79]
    ds_read_b64_tr_b16 v[80:81], v159 offset:20480
    ds_read_b64_tr_b16 v[82:83], v159 offset:22528
    v_max_f32 v32, 0, v32
    v_max_f32 v33, 0, v33
    v_max_f32 v34, 0, v34
    s_waitcnt lgkmcnt(6)
    v_mfma_f32_32x32x16_bf16 v[48:63], v[92:95], v[180:183], v[48:63]
    ds_read_b64_tr_b16 v[84:85], v158 offset:28672
    ds_read_b64_tr_b16 v[86:87], v158 offset:30720
    v_max_f32 v35, 0, v35
    v_max_f32 v36, 0, v36
    v_max_f32 v37, 0, v37
    s_waitcnt lgkmcnt(6)
    v_mfma_f32_32x32x16_bf16 v[64:79], v[96:99], v[176:179], v[64:79]
    ds_read_b64_tr_b16 v[88:89], v159 offset:24576
    ds_read_b64_tr_b16 v[90:91], v159 offset:26624
    v_max_f32 v38, 0, v38
    v_max_f32 v39, 0, v39
    v_mul_f32 v32, v32, v40
    s_waitcnt lgkmcnt(6)
    v_mfma_f32_32x32x16_bf16 v[48:63], v[100:103], v[184:187], v[48:63]
    ds_read_b64_tr_b16 v[92:93], v158 offset:32768
    ds_read_b64_tr_b16 v[94:95], v158 offset:34816
    v_mul_f32 v33, v33, v41
    v_mul_f32 v34, v34, v42
    v_mul_f32 v35, v35, v43
    s_waitcnt lgkmcnt(6)
    v_mfma_f32_32x32x16_bf16 v[64:79], v[80:83], v[180:183], v[64:79]
    ds_read_b64_tr_b16 v[96:97], v159 offset:28672
    ds_read_b64_tr_b16 v[98:99], v159 offset:30720
    ds_inc_u32 v109, v109
    v_mul_f32 v36, v36, v44
    v_mul_f32 v37, v37, v45
    v_mul_f32 v38, v38, v46
    s_waitcnt lgkmcnt(7)
    v_mfma_f32_32x32x16_bf16 v[48:63], v[84:87], v[188:191], v[48:63]
    ds_read_b64_tr_b16 v[100:101], v158 offset:36864
    ds_read_b64_tr_b16 v[102:103], v158 offset:38912
    v_mul_f32 v39, v39, v47
    v_cvt_pk_bf16_f32 v40, v32, v33
    v_cvt_pk_bf16_f32 v41, v34, v35
    s_waitcnt lgkmcnt(7)
    v_mfma_f32_32x32x16_bf16 v[64:79], v[88:91], v[184:187], v[64:79]
    ds_read_b64_tr_b16 v[80:81], v159 offset:32768
    ds_read_b64_tr_b16 v[82:83], v159 offset:34816
    s_waitcnt vmcnt(1)
    v_cmp_ne_u32 vcc, s77, v10
    s_and_b32 s90, vcc_lo, 0x7f
    s_cbranch_scc1 WS_adaLN_cond__sliding_local_dilated__glu_gated_reglu__prompt_kernel_82
WB_adaLN_cond__sliding_local_dilated__glu_gated_reglu__prompt_kernel_83:
    v_cvt_pk_bf16_f32 v42, v36, v37
    v_cvt_pk_bf16_f32 v43, v38, v39
    buffer_store_dwordx4 v[40:43], v14, s[68:71], s101 offen offset:1024 sc1
    s_waitcnt lgkmcnt(7)
    v_mfma_f32_32x32x16_bf16 v[48:63], v[92:95], v[192:195], v[48:63]
    ds_read_b64_tr_b16 v[84:85], v158 offset:40960
    ds_read_b64_tr_b16 v[86:87], v158 offset:43008
    buffer_load_dwordx4 v[160:163], v14, s[68:71], s48 offen sc1
    s_waitcnt lgkmcnt(7)
    v_mfma_f32_32x32x16_bf16 v[64:79], v[96:99], v[188:191], v[64:79]
    ds_read_b64_tr_b16 v[88:89], v159 offset:36864
    ds_read_b64_tr_b16 v[90:91], v159 offset:38912
    s_waitcnt lgkmcnt(6)
    v_mfma_f32_32x32x16_bf16 v[48:63], v[100:103], v[196:199], v[48:63]
    ds_read_b64_tr_b16 v[92:93], v158 offset:45056
    ds_read_b64_tr_b16 v[94:95], v158 offset:47104
    s_waitcnt lgkmcnt(6)
    v_mfma_f32_32x32x16_bf16 v[64:79], v[80:83], v[192:195], v[64:79]
    ds_read_b64_tr_b16 v[96:97], v159 offset:40960
    ds_read_b64_tr_b16 v[98:99], v159 offset:43008
    buffer_load_dwordx4 v[164:167], v14, s[68:71], s48 offen offset:1024 sc1
    s_waitcnt lgkmcnt(6)
    v_mfma_f32_32x32x16_bf16 v[48:63], v[84:87], v[200:203], v[48:63]
    ds_read_b64_tr_b16 v[100:101], v158 offset:49152
    ds_read_b64_tr_b16 v[102:103], v158 offset:51200
    s_waitcnt lgkmcnt(6)
    v_mfma_f32_32x32x16_bf16 v[64:79], v[88:91], v[196:199], v[64:79]
    ds_read_b64_tr_b16 v[80:81], v159 offset:45056
    ds_read_b64_tr_b16 v[82:83], v159 offset:47104
    ds_inc_u32 v109, v109
    s_waitcnt lgkmcnt(7)
    v_mfma_f32_32x32x16_bf16 v[48:63], v[92:95], v[204:207], v[48:63]
    ds_read_b64_tr_b16 v[84:85], v158 offset:53248
    ds_read_b64_tr_b16 v[86:87], v158 offset:55296
    buffer_load_dwordx4 v[168:171], v14, s[68:71], s48 offen offset:2048 sc1
    s_waitcnt lgkmcnt(7)
    v_mfma_f32_32x32x16_bf16 v[64:79], v[96:99], v[200:203], v[64:79]
    ds_read_b64_tr_b16 v[88:89], v159 offset:49152
    ds_read_b64_tr_b16 v[90:91], v159 offset:51200
    s_waitcnt lgkmcnt(7)
    v_mfma_f32_32x32x16_bf16 v[48:63], v[100:103], v[208:211], v[48:63]
    ds_read_b64_tr_b16 v[92:93], v158 offset:57344
    ds_read_b64_tr_b16 v[94:95], v158 offset:59392
    s_waitcnt lgkmcnt(7)
    v_mfma_f32_32x32x16_bf16 v[64:79], v[80:83], v[204:207], v[64:79]
    ds_read_b64_tr_b16 v[96:97], v159 offset:53248
    ds_read_b64_tr_b16 v[98:99], v159 offset:55296
    buffer_load_dwordx4 v[172:175], v14, s[68:71], s48 offen offset:3072 sc1
    s_waitcnt lgkmcnt(6)
    v_mfma_f32_32x32x16_bf16 v[48:63], v[84:87], v[212:215], v[48:63]
    ds_read_b64_tr_b16 v[100:101], v158 offset:61440
    ds_read_b64_tr_b16 v[102:103], v158 offset:63488
    s_waitcnt lgkmcnt(6)
    v_mfma_f32_32x32x16_bf16 v[64:79], v[88:91], v[208:211], v[64:79]
    ds_read_b64_tr_b16 v[80:81], v159 offset:57344
    ds_read_b64_tr_b16 v[82:83], v159 offset:59392
    s_waitcnt lgkmcnt(6)
    v_mfma_f32_32x32x16_bf16 v[48:63], v[92:95], v[216:219], v[48:63]
    ds_read_b64_tr_b16 v[84:85], v154
    ds_read_b64_tr_b16 v[86:87], v154 offset:2048
    buffer_load_dwordx4 v[176:179], v14, s[68:71], s49 offen sc1
    s_waitcnt lgkmcnt(6)
    v_mfma_f32_32x32x16_bf16 v[64:79], v[96:99], v[212:215], v[64:79]
    ds_read_b64_tr_b16 v[88:89], v159 offset:61440
    ds_read_b64_tr_b16 v[90:91], v159 offset:63488
    ds_inc_u32 v109, v109
    s_waitcnt lgkmcnt(7)
    v_mfma_f32_32x32x16_bf16 v[48:63], v[100:103], v[220:223], v[48:63]
    ds_read_b64_tr_b16 v[92:93], v154 offset:4096
    ds_read_b64_tr_b16 v[94:95], v154 offset:6144
    s_waitcnt lgkmcnt(7)
    v_mfma_f32_32x32x16_bf16 v[64:79], v[80:83], v[216:219], v[64:79]
    ds_read_b64_tr_b16 v[96:97], v155
    ds_read_b64_tr_b16 v[98:99], v155 offset:2048
    buffer_load_dwordx4 v[180:183], v14, s[68:71], s49 offen offset:1024 sc1
    s_waitcnt lgkmcnt(7)
    v_mfma_f32_32x32x16_bf16 v[48:63], v[84:87], v[224:227], v[48:63]
    ds_read_b64_tr_b16 v[100:101], v154 offset:8192
    ds_read_b64_tr_b16 v[102:103], v154 offset:10240
    s_waitcnt lgkmcnt(7)
    v_mfma_f32_32x32x16_bf16 v[64:79], v[88:91], v[220:223], v[64:79]
    ds_read_b64_tr_b16 v[80:81], v155 offset:4096
    ds_read_b64_tr_b16 v[82:83], v155 offset:6144
    s_waitcnt lgkmcnt(6)
    v_mfma_f32_32x32x16_bf16 v[48:63], v[92:95], v[228:231], v[48:63]
    ds_read_b64_tr_b16 v[84:85], v154 offset:12288
    ds_read_b64_tr_b16 v[86:87], v154 offset:14336
    buffer_load_dwordx4 v[184:187], v14, s[68:71], s49 offen offset:2048 sc1
    s_waitcnt lgkmcnt(6)
    v_mfma_f32_32x32x16_bf16 v[64:79], v[96:99], v[224:227], v[64:79]
    ds_read_b64_tr_b16 v[88:89], v155 offset:8192
    ds_read_b64_tr_b16 v[90:91], v155 offset:10240
    s_waitcnt lgkmcnt(6)
    v_mfma_f32_32x32x16_bf16 v[48:63], v[100:103], v[232:235], v[48:63]
    ds_read_b64_tr_b16 v[92:93], v154 offset:16384
    ds_read_b64_tr_b16 v[94:95], v154 offset:18432
    s_waitcnt lgkmcnt(6)
    v_mfma_f32_32x32x16_bf16 v[64:79], v[80:83], v[228:231], v[64:79]
    ds_read_b64_tr_b16 v[96:97], v155 offset:12288
    ds_read_b64_tr_b16 v[98:99], v155 offset:14336
    ds_inc_u32 v109, v109
    buffer_load_dwordx4 v[188:191], v14, s[68:71], s49 offen offset:3072 sc1
    s_waitcnt lgkmcnt(7)
    v_mfma_f32_32x32x16_bf16 v[48:63], v[84:87], v[236:239], v[48:63]
    ds_read_b64_tr_b16 v[100:101], v154 offset:20480
    ds_read_b64_tr_b16 v[102:103], v154 offset:22528
    s_waitcnt lgkmcnt(7)
    v_mfma_f32_32x32x16_bf16 v[64:79], v[88:91], v[232:235], v[64:79]
    ds_read_b64_tr_b16 v[80:81], v155 offset:16384
    ds_read_b64_tr_b16 v[82:83], v155 offset:18432
    s_waitcnt lgkmcnt(7)
    v_mfma_f32_32x32x16_bf16 v[48:63], v[92:95], v[240:243], v[48:63]
    ds_read_b64_tr_b16 v[84:85], v154 offset:24576
    ds_read_b64_tr_b16 v[86:87], v154 offset:26624
    buffer_load_dwordx4 v[192:195], v14, s[68:71], s50 offen sc1
    s_waitcnt lgkmcnt(7)
    v_mfma_f32_32x32x16_bf16 v[64:79], v[96:99], v[236:239], v[64:79]
    ds_read_b64_tr_b16 v[88:89], v155 offset:20480
    ds_read_b64_tr_b16 v[90:91], v155 offset:22528
    s_waitcnt lgkmcnt(6)
    v_mfma_f32_32x32x16_bf16 v[48:63], v[100:103], v[244:247], v[48:63]
    ds_read_b64_tr_b16 v[92:93], v154 offset:28672
    ds_read_b64_tr_b16 v[94:95], v154 offset:30720
    s_waitcnt vmcnt(9)
    v_mov_b32 v11, s77
    s_mov_b64 exec, 1
    buffer_store_dword v11, off, s[68:71], s58 offset:32
    s_mov_b64 exec, -1
    ds_inc_u32 v109, v109
    s_waitcnt lgkmcnt(7)
    v_mfma_f32_32x32x16_bf16 v[64:79], v[80:83], v[240:243], v[64:79]
    ds_read_b64_tr_b16 v[96:97], v155 offset:24576
    ds_read_b64_tr_b16 v[98:99], v155 offset:26624
    buffer_load_dwordx4 v[196:199], v14, s[68:71], s50 offen offset:1024 sc1
    s_waitcnt lgkmcnt(7)
    v_mfma_f32_32x32x16_bf16 v[48:63], v[84:87], v[248:251], v[48:63]
    ds_read_b64_tr_b16 v[100:101], v154 offset:32768
    ds_read_b64_tr_b16 v[102:103], v154 offset:34816
    s_waitcnt lgkmcnt(7)
    v_mfma_f32_32x32x16_bf16 v[64:79], v[88:91], v[244:247], v[64:79]
    ds_read_b64_tr_b16 v[80:81], v155 offset:28672
    ds_read_b64_tr_b16 v[82:83], v155 offset:30720
    ds_inc_u32 v109, v109
    s_waitcnt lgkmcnt(8)
    v_mfma_f32_32x32x16_bf16 v[48:63], v[92:95], v[252:255], v[48:63]
    ds_read_b64_tr_b16 v[84:85], v154 offset:36864
    ds_read_b64_tr_b16 v[86:87], v154 offset:38912
    buffer_load_dwordx4 v[200:203], v14, s[68:71], s50 offen offset:2048 sc1
    s_waitcnt lgkmcnt(7)
    v_mfma_f32_32x32x16_bf16 v[64:79], v[96:99], v[248:251], v[64:79]
    ds_read_b64_tr_b16 v[88:89], v155 offset:32768
    ds_read_b64_tr_b16 v[90:91], v155 offset:34816
    s_waitcnt lgkmcnt(7)
    v_mfma_f32_32x32x16_bf16 v[48:63], v[100:103], v[112:115], v[48:63]
    ds_read_b64_tr_b16 v[92:93], v154 offset:40960
    ds_read_b64_tr_b16 v[94:95], v154 offset:43008
    s_waitcnt lgkmcnt(7)
    v_mfma_f32_32x32x16_bf16 v[64:79], v[80:83], v[252:255], v[64:79]
    ds_read_b64_tr_b16 v[96:97], v155 offset:36864
    ds_read_b64_tr_b16 v[98:99], v155 offset:38912
    buffer_load_dwordx4 v[204:207], v14, s[68:71], s50 offen offset:3072 sc1
    s_waitcnt lgkmcnt(6)
    v_mfma_f32_32x32x16_bf16 v[48:63], v[84:87], v[116:119], v[48:63]
    ds_read_b64_tr_b16 v[100:101], v154 offset:45056
    ds_read_b64_tr_b16 v[102:103], v154 offset:47104
    s_waitcnt lgkmcnt(6)
    v_mfma_f32_32x32x16_bf16 v[64:79], v[88:91], v[112:115], v[64:79]
    ds_read_b64_tr_b16 v[80:81], v155 offset:40960
    ds_read_b64_tr_b16 v[82:83], v155 offset:43008
    s_waitcnt lgkmcnt(6)
    v_mfma_f32_32x32x16_bf16 v[48:63], v[92:95], v[120:123], v[48:63]
    ds_read_b64_tr_b16 v[84:85], v154 offset:49152
    ds_read_b64_tr_b16 v[86:87], v154 offset:51200
    buffer_load_dwordx4 v[208:211], v14, s[68:71], s51 offen sc1
    s_waitcnt lgkmcnt(6)
    v_mfma_f32_32x32x16_bf16 v[64:79], v[96:99], v[116:119], v[64:79]
    ds_read_b64_tr_b16 v[88:89], v155 offset:45056
    ds_read_b64_tr_b16 v[90:91], v155 offset:47104
    ds_inc_u32 v109, v109
    s_waitcnt lgkmcnt(7)
    v_mfma_f32_32x32x16_bf16 v[48:63], v[100:103], v[124:127], v[48:63]
    ds_read_b64_tr_b16 v[92:93], v154 offset:53248
    ds_read_b64_tr_b16 v[94:95], v154 offset:55296
    s_waitcnt lgkmcnt(7)
    v_mfma_f32_32x32x16_bf16 v[64:79], v[80:83], v[120:123], v[64:79]
    ds_read_b64_tr_b16 v[96:97], v155 offset:49152
    ds_read_b64_tr_b16 v[98:99], v155 offset:51200
    buffer_load_dwordx4 v[212:215], v14, s[68:71], s51 offen offset:1024 sc1
    s_waitcnt lgkmcnt(7)
    v_mfma_f32_32x32x16_bf16 v[48:63], v[84:87], v[128:131], v[48:63]
    ds_read_b64_tr_b16 v[100:101], v154 offset:57344
    ds_read_b64_tr_b16 v[102:103], v154 offset:59392
    s_waitcnt lgkmcnt(7)
    v_mfma_f32_32x32x16_bf16 v[64:79], v[88:91], v[124:127], v[64:79]
    ds_read_b64_tr_b16 v[80:81], v155 offset:53248
    ds_read_b64_tr_b16 v[82:83], v155 offset:55296
    s_waitcnt lgkmcnt(6)
    v_mfma_f32_32x32x16_bf16 v[48:63], v[92:95], v[132:135], v[48:63]
    ds_read_b64_tr_b16 v[84:85], v154 offset:61440
    ds_read_b64_tr_b16 v[86:87], v154 offset:63488
    buffer_load_dwordx4 v[216:219], v14, s[68:71], s51 offen offset:2048 sc1
    s_waitcnt lgkmcnt(6)
    v_mfma_f32_32x32x16_bf16 v[64:79], v[96:99], v[128:131], v[64:79]
    ds_read_b64_tr_b16 v[88:89], v155 offset:57344
    ds_read_b64_tr_b16 v[90:91], v155 offset:59392
    s_waitcnt lgkmcnt(6)
    v_mfma_f32_32x32x16_bf16 v[48:63], v[100:103], v[136:139], v[48:63]
    ds_read_b128 v[92:95], v4 offset:3072
    s_waitcnt lgkmcnt(5)
    v_mfma_f32_32x32x16_bf16 v[64:79], v[80:83], v[132:135], v[64:79]
    ds_read_b64_tr_b16 v[96:97], v155 offset:61440
    ds_read_b64_tr_b16 v[98:99], v155 offset:63488
    ds_inc_u32 v109, v109
    buffer_load_dword v10, v12, s[68:71], s61 offen sc1
    buffer_load_dwordx4 v[220:223], v14, s[68:71], s51 offen offset:3072 sc1
    s_waitcnt lgkmcnt(6)
    v_mfma_f32_32x32x16_bf16 v[48:63], v[84:87], v[140:143], v[48:63]
    ds_read_b128 v[100:103], v4 offset:3584
    s_waitcnt lgkmcnt(5)
    v_mfma_f32_32x32x16_bf16 v[64:79], v[88:91], v[136:139], v[64:79]
    s_waitcnt lgkmcnt(4)
    v_mfma_f32_32x32x16_bf16 v[48:63], v[92:95], v[104:107], v[48:63]
    buffer_load_dwordx4 v[224:227], v14, s[68:71], s52 offen sc1
    s_waitcnt lgkmcnt(2)
    v_mfma_f32_32x32x16_bf16 v[64:79], v[96:99], v[140:143], v[64:79]
    s_waitcnt lgkmcnt(0)
    v_mfma_f32_32x32x16_bf16 v[64:79], v[100:103], v[104:107], v[64:79]
    ds_read_b32 v0, v108 offset:1024
    s_nop 5
    v_max_f32 v48, 0, v48
    v_max_f32 v49, 0, v49
    v_max_f32 v50, 0, v50
    v_max_f32 v51, 0, v51
    v_max_f32 v52, 0, v52
    v_max_f32 v53, 0, v53
    v_max_f32 v54, 0, v54
    v_max_f32 v55, 0, v55
    v_mul_f32 v48, v48, v56
    v_mul_f32 v49, v49, v57
    v_mul_f32 v50, v50, v58
    v_mul_f32 v51, v51, v59
    v_mul_f32 v52, v52, v60
    v_mul_f32 v53, v53, v61
    v_mul_f32 v54, v54, v62
    v_mul_f32 v55, v55, v63
    v_cvt_pk_bf16_f32 v56, v48, v49
    v_cvt_pk_bf16_f32 v57, v50, v51
    v_cvt_pk_bf16_f32 v58, v52, v53
    v_cvt_pk_bf16_f32 v59, v54, v55
    buffer_store_dwordx4 v[56:59], v14, s[68:71], s101 offen offset:2048 sc1
    v_max_f32 v64, 0, v64
    v_max_f32 v65, 0, v65
    v_max_f32 v66, 0, v66
    v_max_f32 v67, 0, v67
    v_max_f32 v68, 0, v68
    v_max_f32 v69, 0, v69
    v_max_f32 v70, 0, v70
    v_max_f32 v71, 0, v71
    v_mul_f32 v64, v64, v72
    v_mul_f32 v65, v65, v73
    v_mul_f32 v66, v66, v74
    v_mul_f32 v67, v67, v75
    v_mul_f32 v68, v68, v76
    v_mul_f32 v69, v69, v77
    v_mul_f32 v70, v70, v78
    v_mul_f32 v71, v71, v79
    v_cvt_pk_bf16_f32 v72, v64, v65
    v_cvt_pk_bf16_f32 v73, v66, v67
    v_cvt_pk_bf16_f32 v74, v68, v69
    v_cvt_pk_bf16_f32 v75, v70, v71
    buffer_store_dwordx4 v[72:75], v14, s[68:71], s101 offen offset:3072 sc1
    buffer_load_dwordx4 v[228:231], v14, s[68:71], s52 offen offset:1024 sc1
    buffer_load_dwordx4 v[232:235], v14, s[68:71], s52 offen offset:2048 sc1
    buffer_load_dwordx4 v[236:239], v14, s[68:71], s52 offen offset:3072 sc1
    buffer_load_dwordx4 v[240:243], v14, s[68:71], s53 offen sc1
    buffer_load_dwordx4 v[244:247], v14, s[68:71], s53 offen offset:1024 sc1
    buffer_load_dwordx4 v[248:251], v14, s[68:71], s53 offen offset:2048 sc1
    buffer_load_dwordx4 v[252:255], v14, s[68:71], s53 offen offset:3072 sc1
    buffer_load_dwordx4 v[112:115], v14, s[68:71], s54 offen sc1
    buffer_load_dwordx4 v[116:119], v14, s[68:71], s54 offen offset:1024 sc1
    buffer_load_dwordx4 v[120:123], v14, s[68:71], s54 offen offset:2048 sc1
    buffer_load_dwordx4 v[124:127], v14, s[68:71], s54 offen offset:3072 sc1
    s_lshl_b32 s80, s87, 13
    v_add_u32 v4, s80, v1
    v_xor_b32 v5, 64, v4
    v_add_u32 v2, 0x10000, v4
    v_add_u32 v3, 0x10000, v5
    s_lshl_b32 s80, s89, 12
    s_add_u32 s80, s80, 131072
    v_add_u32 v6, s80, v14
    v_xor_b32 v7, 0x2000, v6
    v_xor_b32 v111, 0x200, v109
    s_lshl_b32 s80, s74, 1
    s_add_u32 s80, s80, s88
    s_lshl_b32 s80, s80, 7
    s_add_u32 s80, s80, 152064
    v_and_b32 v8, 31, v15
    v_lshlrev_b32 v8, 2, v8
    v_add_u32 v8, s80, v8
    s_lshl_b32 s80, s75, 7
    s_lshl_b32 s81, s87, 6
    s_add_u32 s80, s80, s81
    s_add_u32 s80, s80, 155648
    v_lshrrev_b32 v11, 5, v15
    v_lshlrev_b32 v11, 3, v11
    v_add_u32 v110, s80, v11
    ds_inc_u32 v109, v109
    s_branch P3_DONE
P3_IDLE:
    s_nop 7
    s_nop 7
    buffer_load_dword v10, v12, s[68:71], s60 offen sc1
    s_waitcnt vmcnt(0)
    s_mov_b32 s86, s62
    s_branch WC_adaLN_cond__sliding_local_dilated__glu_gated_reglu__prompt_kernel_87
WL_adaLN_cond__sliding_local_dilated__glu_gated_reglu__prompt_kernel_86:
    s_sub_u32 s86, s86, 1
    s_cbranch_scc1 WS_adaLN_cond__sliding_local_dilated__glu_gated_reglu__prompt_kernel_84
    s_sleep 2
    buffer_load_dword v10, v12, s[68:71], s60 offen sc1
    s_waitcnt vmcnt(0)
WC_adaLN_cond__sliding_local_dilated__glu_gated_reglu__prompt_kernel_87:
    v_cmp_ne_u32 vcc, s77, v10
    s_and_b32 s90, vcc_lo, 0xffff
    s_cbranch_scc1 WL_adaLN_cond__sliding_local_dilated__glu_gated_reglu__prompt_kernel_86
WB_adaLN_cond__sliding_local_dilated__glu_gated_reglu__prompt_kernel_85:
    s_movk_i32 s86, 30000
WL_adaLN_cond__sliding_local_dilated__glu_gated_reglu__prompt_kernel_88:
    ds_read_b32 v0, v108 offset:1024
    s_waitcnt lgkmcnt(0)
    v_cmp_gt_u32 vcc, 24, v0
    s_cbranch_vccz WD_adaLN_cond__sliding_local_dilated__glu_gated_reglu__prompt_kernel_89
    s_sleep 1
    s_sub_u32 s86, s86, 1
    s_cmp_lg_u32 s86, 0
    s_cbranch_scc1 WL_adaLN_cond__sliding_local_dilated__glu_gated_reglu__prompt_kernel_88
WD_adaLN_cond__sliding_local_dilated__glu_gated_reglu__prompt_kernel_89:
    v_mov_b32 v11, 35
    ds_write_b32 v109, v11
    s_sleep 80
    v_mov_b32 v11, 44
    ds_write_b32 v109, v11
    buffer_load_dword v10, v12, s[68:71], s61 offen sc1
    s_waitcnt vmcnt(0)
    v_cmp_ne_u32 vcc, s77, v10
    s_and_b32 s90, vcc_lo, 0x7f
    s_cbranch_scc1 WS_adaLN_cond__sliding_local_dilated__glu_gated_reglu__prompt_kernel_90
WB_adaLN_cond__sliding_local_dilated__glu_gated_reglu__prompt_kernel_91:
    buffer_load_dwordx4 v[160:163], v14, s[68:71], s48 offen sc1
    buffer_load_dwordx4 v[164:167], v14, s[68:71], s48 offen offset:1024 sc1
    buffer_load_dwordx4 v[168:171], v14, s[68:71], s48 offen offset:2048 sc1
    buffer_load_dwordx4 v[172:175], v14, s[68:71], s48 offen offset:3072 sc1
    buffer_load_dwordx4 v[176:179], v14, s[68:71], s49 offen sc1
    buffer_load_dwordx4 v[180:183], v14, s[68:71], s49 offen offset:1024 sc1
    buffer_load_dwordx4 v[184:187], v14, s[68:71], s49 offen offset:2048 sc1
    buffer_load_dwordx4 v[188:191], v14, s[68:71], s49 offen offset:3072 sc1
    buffer_load_dwordx4 v[192:195], v14, s[68:71], s50 offen sc1
    buffer_load_dwordx4 v[196:199], v14, s[68:71], s50 offen offset:1024 sc1
    buffer_load_dwordx4 v[200:203], v14, s[68:71], s50 offen offset:2048 sc1
    buffer_load_dwordx4 v[204:207], v14, s[68:71], s50 offen offset:3072 sc1
    buffer_load_dwordx4 v[208:211], v14, s[68:71], s51 offen sc1
    buffer_load_dwordx4 v[212:215], v14, s[68:71], s51 offen offset:1024 sc1
    buffer_load_dwordx4 v[216:219], v14, s[68:71], s51 offen offset:2048 sc1
    buffer_load_dwordx4 v[220:223], v14, s[68:71], s51 offen offset:3072 sc1
    buffer_load_dwordx4 v[224:227], v14, s[68:71], s52 offen sc1
    buffer_load_dwordx4 v[228:231], v14, s[68:71], s52 offen offset:1024 sc1
    buffer_load_dwordx4 v[232:235], v14, s[68:71], s52 offen offset:2048 sc1
    buffer_load_dwordx4 v[236:239], v14, s[68:71], s52 offen offset:3072 sc1
    buffer_load_dwordx4 v[240:243], v14, s[68:71], s53 offen sc1
    buffer_load_dwordx4 v[244:247], v14, s[68:71], s53 offen offset:1024 sc1
    buffer_load_dwordx4 v[248:251], v14, s[68:71], s53 offen offset:2048 sc1
    buffer_load_dwordx4 v[252:255], v14, s[68:71], s53 offen offset:3072 sc1
    buffer_load_dwordx4 v[112:115], v14, s[68:71], s54 offen sc1
    buffer_load_dwordx4 v[116:119], v14, s[68:71], s54 offen offset:1024 sc1
    buffer_load_dwordx4 v[120:123], v14, s[68:71], s54 offen offset:2048 sc1
    buffer_load_dwordx4 v[124:127], v14, s[68:71], s54 offen offset:3072 sc1
    s_movk_i32 s86, 30000
WL_adaLN_cond__sliding_local_dilated__glu_gated_reglu__prompt_kernel_92:
    ds_read_b32 v0, v108 offset:1024
    s_waitcnt lgkmcnt(0)
    v_cmp_gt_u32 vcc, 27, v0
    s_cbranch_vccz WD_adaLN_cond__sliding_local_dilated__glu_gated_reglu__prompt_kernel_93
    s_sleep 1
    s_sub_u32 s86, s86, 1
    s_cmp_lg_u32 s86, 0
    s_cbranch_scc1 WL_adaLN_cond__sliding_local_dilated__glu_gated_reglu__prompt_kernel_92
WD_adaLN_cond__sliding_local_dilated__glu_gated_reglu__prompt_kernel_93:
    ds_read_b32 v0, v108 offset:1024
    s_lshl_b32 s80, s87, 13
    v_add_u32 v4, s80, v1
    v_xor_b32 v5, 64, v4
    v_add_u32 v2, 0x10000, v4
    v_add_u32 v3, 0x10000, v5
    s_lshl_b32 s80, s89, 12
    s_add_u32 s80, s80, 131072
    v_add_u32 v6, s80, v14
    v_xor_b32 v7, 0x2000, v6
    v_xor_b32 v111, 0x200, v109
    s_lshl_b32 s80, s74, 1
    s_add_u32 s80, s80, s88
    s_lshl_b32 s80, s80, 7
    s_add_u32 s80, s80, 152064
    v_and_b32 v8, 31, v15
    v_lshlrev_b32 v8, 2, v8
    v_add_u32 v8, s80, v8
    s_lshl_b32 s80, s75, 7
    s_lshl_b32 s81, s87, 6
    s_add_u32 s80, s80, s81
    s_add_u32 s80, s80, 155648
    v_lshrrev_b32 v11, 5, v15
    v_lshlrev_b32 v11, 3, v11
    v_add_u32 v110, s80, v11
    v_mov_b32 v11, 45
    ds_write_b32 v109, v11
    buffer_load_dword v10, v12, s[68:71], s61 offen sc1
    s_waitcnt vmcnt(0)
P3_DONE:
    s_nop 7
    s_nop 7
    s_waitcnt lgkmcnt(1)
    v_cmp_gt_u32 vcc, 34, v0
    s_cbranch_vccnz SLOW_adaLN_cond__sliding_local_dilated__glu_gated_reglu__prompt_kernel_94
BACK_adaLN_cond__sliding_local_dilated__glu_gated_reglu__prompt_kernel_95:
    ds_read_b64_tr_b16 v[80:81], v3
    ds_read_b64_tr_b16 v[82:83], v3 offset:1024
    ds_read_b64_tr_b16 v[84:85], v2
    ds_read_b64_tr_b16 v[86:87], v2 offset:1024
    ds_read_b64_tr_b16 v[88:89], v3 offset:2048
    ds_read_b64_tr_b16 v[90:91], v3 offset:3072
    ds_read_b32 v0, v108 offset:1024
    ds_read_b64_tr_b16 v[92:93], v2 offset:2048
    ds_read_b64_tr_b16 v[94:95], v2 offset:3072
    s_waitcnt vmcnt(31)
    s_waitcnt lgkmcnt(7)
    v_mfma_f32_32x32x16_bf16 v[32:47], v[80:83], v[160:163], 0
    ds_read_b64_tr_b16 v[96:97], v3 offset:4096
    ds_read_b64_tr_b16 v[98:99], v3 offset:5120
    s_waitcnt lgkmcnt(7)
    v_mfma_f32_32x32x16_bf16 v[16:31], v[84:87], v[160:163], 0
    ds_read_b64_tr_b16 v[100:101], v2 offset:4096
    ds_read_b64_tr_b16 v[102:103], v2 offset:5120
    s_waitcnt vmcnt(30)
    s_waitcnt lgkmcnt(7)
    v_mfma_f32_32x32x16_bf16 v[32:47], v[88:91], v[164:167], v[32:47]
    ds_read_b64_tr_b16 v[80:81], v3 offset:6144
    ds_read_b64_tr_b16 v[82:83], v3 offset:7168
    s_waitcnt lgkmcnt(6)
    v_mfma_f32_32x32x16_bf16 v[16:31], v[92:95], v[164:167], v[16:31]
    ds_read_b64_tr_b16 v[84:85], v2 offset:6144
    ds_read_b64_tr_b16 v[86:87], v2 offset:7168
    ds_inc_u32 v109, v109
    s_waitcnt vmcnt(29)
    s_waitcnt lgkmcnt(7)
    v_mfma_f32_32x32x16_bf16 v[32:47], v[96:99], v[168:171], v[32:47]
    v_cmp_gt_u32 vcc, 35, v0
    s_cbranch_vccnz SLOW_adaLN_cond__sliding_local_dilated__glu_gated_reglu__prompt_kernel_96
BACK_adaLN_cond__sliding_local_dilated__glu_gated_reglu__prompt_kernel_97:
    ds_read_b64_tr_b16 v[88:89], v3 offset:16384
    ds_read_b64_tr_b16 v[90:91], v3 offset:17408
    s_waitcnt vmcnt(15)
    v_cmp_ne_u32 vcc, s77, v10
    s_and_b32 s90, vcc_lo, 0x7f00
    s_cbranch_scc1 WS_adaLN_cond__sliding_local_dilated__glu_gated_reglu__prompt_kernel_98
WB_adaLN_cond__sliding_local_dilated__glu_gated_reglu__prompt_kernel_99:
    buffer_load_dwordx4 v[128:131], v13, s[68:71], s48 offen sc1
    s_waitcnt lgkmcnt(7)
    v_mfma_f32_32x32x16_bf16 v[16:31], v[100:103], v[168:171], v[16:31]
    ds_read_b64_tr_b16 v[92:93], v2 offset:16384
    ds_read_b64_tr_b16 v[94:95], v2 offset:17408
    buffer_load_dwordx4 v[132:135], v13, s[68:71], s48 offen offset:1024 sc1
    s_waitcnt lgkmcnt(7)
    v_mfma_f32_32x32x16_bf16 v[32:47], v[80:83], v[172:175], v[32:47]
    ds_read_b64_tr_b16 v[96:97], v3 offset:18432
    ds_read_b64_tr_b16 v[98:99], v3 offset:19456
    buffer_load_dwordx4 v[136:139], v13, s[68:71], s49 offen sc1
    s_waitcnt lgkmcnt(7)
    v_mfma_f32_32x32x16_bf16 v[16:31], v[84:87], v[172:175], v[16:31]
    ds_read_b32 v0, v108 offset:1024
    ds_read_b64_tr_b16 v[100:101], v2 offset:18432
    ds_read_b64_tr_b16 v[102:103], v2 offset:19456
    buffer_load_dwordx4 v[140:143], v13, s[68:71], s49 offen offset:1024 sc1
    s_waitcnt lgkmcnt(7)
    v_mfma_f32_32x32x16_bf16 v[32:47], v[88:91], v[176:179], v[32:47]
    ds_read_b64_tr_b16 v[80:81], v3 offset:20480
    ds_read_b64_tr_b16 v[82:83], v3 offset:21504
    buffer_load_dwordx4 v[160:163], v13, s[68:71], s50 offen sc1
    s_waitcnt lgkmcnt(7)
    v_mfma_f32_32x32x16_bf16 v[16:31], v[92:95], v[176:179], v[16:31]
    ds_read_b64_tr_b16 v[84:85], v2 offset:20480
    ds_read_b64_tr_b16 v[86:87], v2 offset:21504
    buffer_load_dwordx4 v[164:167], v13, s[68:71], s50 offen offset:1024 sc1
    s_waitcnt lgkmcnt(7)
    v_mfma_f32_32x32x16_bf16 v[32:47], v[96:99], v[180:183], v[32:47]
    ds_read_b64_tr_b16 v[88:89], v3 offset:22528
    ds_read_b64_tr_b16 v[90:91], v3 offset:23552
    s_waitcnt vmcnt(17)
    v_mov_b32 v11, s77
    s_mov_b64 exec, 1
    buffer_store_dword v11, off, s[68:71], s58 offset:64
    s_mov_b64 exec, -1
    ds_inc_u32 v109, v109
    buffer_load_dwordx4 v[168:171], v13, s[68:71], s51 offen sc1
    s_waitcnt lgkmcnt(7)
    v_mfma_f32_32x32x16_bf16 v[16:31], v[100:103], v[180:183], v[16:31]
    ds_read_b64_tr_b16 v[92:93], v2 offset:22528
    ds_read_b64_tr_b16 v[94:95], v2 offset:23552
    ds_inc_u32 v109, v109
    buffer_load_dwordx4 v[172:175], v13, s[68:71], s51 offen offset:1024 sc1
    s_waitcnt lgkmcnt(8)
    v_mfma_f32_32x32x16_bf16 v[32:47], v[80:83], v[184:187], v[32:47]
    v_cmp_gt_u32 vcc, 36, v0
    s_cbranch_vccnz SLOW_adaLN_cond__sliding_local_dilated__glu_gated_reglu__prompt_kernel_100
BACK_adaLN_cond__sliding_local_dilated__glu_gated_reglu__prompt_kernel_101:
    ds_read_b64_tr_b16 v[96:97], v3 offset:32768
    ds_read_b64_tr_b16 v[98:99], v3 offset:33792
    buffer_load_dwordx4 v[176:179], v13, s[68:71], s52 offen sc1
    s_waitcnt lgkmcnt(8)
    v_mfma_f32_32x32x16_bf16 v[16:31], v[84:87], v[184:187], v[16:31]
    ds_read_b64_tr_b16 v[100:101], v2 offset:32768
    ds_read_b64_tr_b16 v[102:103], v2 offset:33792
    buffer_load_dwordx4 v[180:183], v13, s[68:71], s52 offen offset:1024 sc1
    s_waitcnt lgkmcnt(8)
    v_mfma_f32_32x32x16_bf16 v[32:47], v[88:91], v[188:191], v[32:47]
    ds_read_b64_tr_b16 v[80:81], v3 offset:34816
    ds_read_b64_tr_b16 v[82:83], v3 offset:35840
    buffer_load_dwordx4 v[184:187], v13, s[68:71], s53 offen sc1
    s_waitcnt lgkmcnt(7)
    v_mfma_f32_32x32x16_bf16 v[16:31], v[92:95], v[188:191], v[16:31]
    ds_read_b32 v0, v108 offset:1024
    ds_read_b64_tr_b16 v[84:85], v2 offset:34816
    ds_read_b64_tr_b16 v[86:87], v2 offset:35840
    buffer_load_dwordx4 v[188:191], v13, s[68:71], s53 offen offset:1024 sc1
    s_waitcnt lgkmcnt(7)
    v_mfma_f32_32x32x16_bf16 v[32:47], v[96:99], v[192:195], v[32:47]
    ds_read_b64_tr_b16 v[88:89], v3 offset:36864
    ds_read_b64_tr_b16 v[90:91], v3 offset:37888
    s_waitcnt lgkmcnt(7)
    v_mfma_f32_32x32x16_bf16 v[16:31], v[100:103], v[192:195], v[16:31]
    ds_read_b64_tr_b16 v[92:93], v2 offset:36864
    ds_read_b64_tr_b16 v[94:95], v2 offset:37888
    buffer_load_dwordx4 v[192:195], v13, s[68:71], s54 offen sc1
    s_waitcnt lgkmcnt(7)
    v_mfma_f32_32x32x16_bf16 v[32:47], v[80:83], v[196:199], v[32:47]
    ds_read_b64_tr_b16 v[96:97], v3 offset:38912
    ds_read_b64_tr_b16 v[98:99], v3 offset:39936
    s_waitcnt lgkmcnt(6)
    v_mfma_f32_32x32x16_bf16 v[16:31], v[84:87], v[196:199], v[16:31]
    ds_read_b64_tr_b16 v[100:101], v2 offset:38912
    ds_read_b64_tr_b16 v[102:103], v2 offset:39936
    ds_inc_u32 v109, v109
    buffer_load_dwordx4 v[196:199], v13, s[68:71], s54 offen offset:1024 sc1
    s_waitcnt lgkmcnt(7)
    v_mfma_f32_32x32x16_bf16 v[32:47], v[88:91], v[200:203], v[32:47]
    v_cmp_gt_u32 vcc, 37, v0
    s_cbranch_vccnz SLOW_adaLN_cond__sliding_local_dilated__glu_gated_reglu__prompt_kernel_102
BACK_adaLN_cond__sliding_local_dilated__glu_gated_reglu__prompt_kernel_103:
    ds_read_b64_tr_b16 v[80:81], v3 offset:49152
    ds_read_b64_tr_b16 v[82:83], v3 offset:50176
    s_waitcnt lgkmcnt(7)
    v_mfma_f32_32x32x16_bf16 v[16:31], v[92:95], v[200:203], v[16:31]
    ds_read_b64_tr_b16 v[84:85], v2 offset:49152
    ds_read_b64_tr_b16 v[86:87], v2 offset:50176
    s_waitcnt lgkmcnt(7)
    v_mfma_f32_32x32x16_bf16 v[32:47], v[96:99], v[204:207], v[32:47]
    ds_read_b64_tr_b16 v[88:89], v3 offset:51200
    ds_read_b64_tr_b16 v[90:91], v3 offset:52224
    s_waitcnt lgkmcnt(7)
    v_mfma_f32_32x32x16_bf16 v[16:31], v[100:103], v[204:207], v[16:31]
    ds_read_b32 v0, v108 offset:1024
    ds_read_b64_tr_b16 v[92:93], v2 offset:51200
    ds_read_b64_tr_b16 v[94:95], v2 offset:52224
    s_waitcnt lgkmcnt(7)
    v_mfma_f32_32x32x16_bf16 v[32:47], v[80:83], v[208:211], v[32:47]
    ds_read_b64_tr_b16 v[96:97], v3 offset:53248
    ds_read_b64_tr_b16 v[98:99], v3 offset:54272
    buffer_load_dword v10, v12, s[68:71], s61 offen sc1
    s_waitcnt lgkmcnt(7)
    v_mfma_f32_32x32x16_bf16 v[16:31], v[84:87], v[208:211], v[16:31]
    ds_read_b64_tr_b16 v[100:101], v2 offset:53248
    ds_read_b64_tr_b16 v[102:103], v2 offset:54272
    s_waitcnt lgkmcnt(7)
    v_mfma_f32_32x32x16_bf16 v[32:47], v[88:91], v[212:215], v[32:47]
    ds_read_b64_tr_b16 v[80:81], v3 offset:55296
    ds_read_b64_tr_b16 v[82:83], v3 offset:56320
    s_waitcnt lgkmcnt(6)
    v_mfma_f32_32x32x16_bf16 v[16:31], v[92:95], v[212:215], v[16:31]
    ds_read_b64_tr_b16 v[84:85], v2 offset:55296
    ds_read_b64_tr_b16 v[86:87], v2 offset:56320
    ds_inc_u32 v109, v109
    s_waitcnt lgkmcnt(7)
    v_mfma_f32_32x32x16_bf16 v[32:47], v[96:99], v[216:219], v[32:47]
    v_cmp_gt_u32 vcc, 38, v0
    s_cbranch_vccnz SLOW_adaLN_cond__sliding_local_dilated__glu_gated_reglu__prompt_kernel_104
BACK_adaLN_cond__sliding_local_dilated__glu_gated_reglu__prompt_kernel_105:
    ds_read_b64_tr_b16 v[88:89], v5
    ds_read_b64_tr_b16 v[90:91], v5 offset:1024
    s_waitcnt lgkmcnt(7)
    v_mfma_f32_32x32x16_bf16 v[16:31], v[100:103], v[216:219], v[16:31]
    ds_read_b64_tr_b16 v[92:93], v4
    ds_read_b64_tr_b16 v[94:95], v4 offset:1024
    s_waitcnt lgkmcnt(7)
    v_mfma_f32_32x32x16_bf16 v[32:47], v[80:83], v[220:223], v[32:47]
    ds_read_b64_tr_b16 v[96:97], v5 offset:2048
    ds_read_b64_tr_b16 v[98:99], v5 offset:3072
    s_waitcnt lgkmcnt(7)
    v_mfma_f32_32x32x16_bf16 v[16:31], v[84:87], v[220:223], v[16:31]
    ds_read_b32 v0, v108 offset:1024
    ds_read_b64_tr_b16 v[100:101], v4 offset:2048
    ds_read_b64_tr_b16 v[102:103], v4 offset:3072
    s_waitcnt lgkmcnt(7)
    v_mfma_f32_32x32x16_bf16 v[32:47], v[88:91], v[224:227], v[32:47]
    ds_read_b64_tr_b16 v[80:81], v5 offset:4096
    ds_read_b64_tr_b16 v[82:83], v5 offset:5120
    s_waitcnt lgkmcnt(7)
    v_mfma_f32_32x32x16_bf16 v[16:31], v[92:95], v[224:227], v[16:31]
    ds_read_b64_tr_b16 v[84:85], v4 offset:4096
    ds_read_b64_tr_b16 v[86:87], v4 offset:5120
    s_waitcnt vmcnt(26)
    s_waitcnt lgkmcnt(7)
    v_mfma_f32_32x32x16_bf16 v[32:47], v[96:99], v[228:231], v[32:47]
    ds_read_b64_tr_b16 v[88:89], v5 offset:6144
    ds_read_b64_tr_b16 v[90:91], v5 offset:7168
    s_waitcnt lgkmcnt(6)
    v_mfma_f32_32x32x16_bf16 v[16:31], v[100:103], v[228:231], v[16:31]
    ds_read_b64_tr_b16 v[92:93], v4 offset:6144
    ds_read_b64_tr_b16 v[94:95], v4 offset:7168
    ds_inc_u32 v109, v109
    s_waitcnt vmcnt(25)
    s_waitcnt lgkmcnt(7)
    v_mfma_f32_32x32x16_bf16 v[32:47], v[80:83], v[232:235], v[32:47]
    v_cmp_gt_u32 vcc, 39, v0
    s_cbranch_vccnz SLOW_adaLN_cond__sliding_local_dilated__glu_gated_reglu__prompt_kernel_106
BACK_adaLN_cond__sliding_local_dilated__glu_gated_reglu__prompt_kernel_107:
    ds_read_b64_tr_b16 v[96:97], v5 offset:16384
    ds_read_b64_tr_b16 v[98:99], v5 offset:17408
    s_waitcnt lgkmcnt(7)
    v_mfma_f32_32x32x16_bf16 v[16:31], v[84:87], v[232:235], v[16:31]
    ds_read_b64_tr_b16 v[100:101], v4 offset:16384
    ds_read_b64_tr_b16 v[102:103], v4 offset:17408
    s_waitcnt vmcnt(24)
    s_waitcnt lgkmcnt(7)
    v_mfma_f32_32x32x16_bf16 v[32:47], v[88:91], v[236:239], v[32:47]
    ds_read_b64_tr_b16 v[80:81], v5 offset:18432
    ds_read_b64_tr_b16 v[82:83], v5 offset:19456
    s_waitcnt lgkmcnt(7)
    v_mfma_f32_32x32x16_bf16 v[16:31], v[92:95], v[236:239], v[16:31]
    ds_read_b32 v0, v108 offset:1024
    ds_read_b64_tr_b16 v[84:85], v4 offset:18432
    ds_read_b64_tr_b16 v[86:87], v4 offset:19456
    s_waitcnt vmcnt(23)
    s_waitcnt lgkmcnt(7)
    v_mfma_f32_32x32x16_bf16 v[32:47], v[96:99], v[240:243], v[32:47]
    ds_read_b64_tr_b16 v[88:89], v5 offset:20480
    ds_read_b64_tr_b16 v[90:91], v5 offset:21504
    s_waitcnt vmcnt(0)
    v_cmp_ne_u32 vcc, s77, v10
    s_and_b32 s90, vcc_lo, 0x7f0000
    s_cbranch_scc1 WS_adaLN_cond__sliding_local_dilated__glu_gated_reglu__prompt_kernel_108
WB_adaLN_cond__sliding_local_dilated__glu_gated_reglu__prompt_kernel_109:
    buffer_load_dwordx4 v[200:203], v13, s[68:71], s48 offen offset:2048 sc1
    s_waitcnt lgkmcnt(7)
    v_mfma_f32_32x32x16_bf16 v[16:31], v[100:103], v[240:243], v[16:31]
    ds_read_b64_tr_b16 v[92:93], v4 offset:20480
    ds_read_b64_tr_b16 v[94:95], v4 offset:21504
    buffer_load_dwordx4 v[204:207], v13, s[68:71], s48 offen offset:3072 sc1
    s_waitcnt lgkmcnt(7)
    v_mfma_f32_32x32x16_bf16 v[32:47], v[80:83], v[244:247], v[32:47]
    ds_read_b64_tr_b16 v[96:97], v5 offset:22528
    ds_read_b64_tr_b16 v[98:99], v5 offset:23552
    buffer_load_dwordx4 v[208:211], v13, s[68:71], s49 offen offset:2048 sc1
    s_waitcnt lgkmcnt(6)
    v_mfma_f32_32x32x16_bf16 v[16:31], v[84:87], v[244:247], v[16:31]
    ds_read_b64_tr_b16 v[100:101], v4 offset:22528
    ds_read_b64_tr_b16 v[102:103], v4 offset:23552
    ds_inc_u32 v109, v109
    buffer_load_dwordx4 v[212:215], v13, s[68:71], s49 offen offset:3072 sc1
    s_waitcnt lgkmcnt(7)
    v_mfma_f32_32x32x16_bf16 v[32:47], v[88:91], v[248:251], v[32:47]
    v_cmp_gt_u32 vcc, 40, v0
    s_cbranch_vccnz SLOW_adaLN_cond__sliding_local_dilated__glu_gated_reglu__prompt_kernel_110
BACK_adaLN_cond__sliding_local_dilated__glu_gated_reglu__prompt_kernel_111:
    ds_read_b64_tr_b16 v[80:81], v5 offset:32768
    ds_read_b64_tr_b16 v[82:83], v5 offset:33792
    buffer_load_dwordx4 v[216:219], v13, s[68:71], s50 offen offset:2048 sc1
    s_waitcnt lgkmcnt(7)
    v_mfma_f32_32x32x16_bf16 v[16:31], v[92:95], v[248:251], v[16:31]
    ds_read_b64_tr_b16 v[84:85], v4 offset:32768
    ds_read_b64_tr_b16 v[86:87], v4 offset:33792
    buffer_load_dwordx4 v[220:223], v13, s[68:71], s50 offen offset:3072 sc1
    s_waitcnt lgkmcnt(7)
    v_mfma_f32_32x32x16_bf16 v[32:47], v[96:99], v[252:255], v[32:47]
    ds_read_b64_tr_b16 v[88:89], v5 offset:34816
    ds_read_b64_tr_b16 v[90:91], v5 offset:35840
    buffer_load_dwordx4 v[224:227], v13, s[68:71], s51 offen offset:2048 sc1
    s_waitcnt lgkmcnt(7)
    v_mfma_f32_32x32x16_bf16 v[16:31], v[100:103], v[252:255], v[16:31]
    ds_read_b32 v0, v108 offset:1024
    ds_read_b64_tr_b16 v[92:93], v4 offset:34816
    ds_read_b64_tr_b16 v[94:95], v4 offset:35840
    buffer_load_dwordx4 v[228:231], v13, s[68:71], s51 offen offset:3072 sc1
    s_waitcnt lgkmcnt(7)
    v_mfma_f32_32x32x16_bf16 v[32:47], v[80:83], v[112:115], v[32:47]
    ds_read_b64_tr_b16 v[96:97], v5 offset:36864
    ds_read_b64_tr_b16 v[98:99], v5 offset:37888
    buffer_load_dwordx4 v[232:235], v13, s[68:71], s52 offen offset:2048 sc1
    s_waitcnt lgkmcnt(7)
    v_mfma_f32_32x32x16_bf16 v[16:31], v[84:87], v[112:115], v[16:31]
    ds_read_b64_tr_b16 v[100:101], v4 offset:36864
    ds_read_b64_tr_b16 v[102:103], v4 offset:37888
    buffer_load_dwordx4 v[236:239], v13, s[68:71], s52 offen offset:3072 sc1
    s_waitcnt lgkmcnt(7)
    v_mfma_f32_32x32x16_bf16 v[32:47], v[88:91], v[116:119], v[32:47]
    ds_read_b64_tr_b16 v[80:81], v5 offset:38912
    ds_read_b64_tr_b16 v[82:83], v5 offset:39936
    buffer_load_dwordx4 v[240:243], v13, s[68:71], s53 offen offset:2048 sc1
    s_waitcnt lgkmcnt(6)
    v_mfma_f32_32x32x16_bf16 v[16:31], v[92:95], v[116:119], v[16:31]
    ds_read_b64_tr_b16 v[84:85], v4 offset:38912
    ds_read_b64_tr_b16 v[86:87], v4 offset:39936
    buffer_load_dwordx4 v[244:247], v13, s[68:71], s53 offen offset:3072 sc1
    s_waitcnt lgkmcnt(6)
    v_mfma_f32_32x32x16_bf16 v[32:47], v[96:99], v[120:123], v[32:47]
    v_cmp_gt_u32 vcc, 41, v0
    s_cbranch_vccnz SLOW_adaLN_cond__sliding_local_dilated__glu_gated_reglu__prompt_kernel_112
BACK_adaLN_cond__sliding_local_dilated__glu_gated_reglu__prompt_kernel_113:
    ds_read_b64_tr_b16 v[88:89], v5 offset:49152
    ds_read_b64_tr_b16 v[90:91], v5 offset:50176
    buffer_load_dwordx4 v[248:251], v13, s[68:71], s54 offen offset:2048 sc1
    s_waitcnt lgkmcnt(6)
    v_mfma_f32_32x32x16_bf16 v[16:31], v[100:103], v[120:123], v[16:31]
    ds_read_b64_tr_b16 v[92:93], v4 offset:49152
    ds_read_b64_tr_b16 v[94:95], v4 offset:50176
    buffer_load_dwordx4 v[252:255], v13, s[68:71], s54 offen offset:3072 sc1
    s_waitcnt lgkmcnt(6)
    v_mfma_f32_32x32x16_bf16 v[32:47], v[80:83], v[124:127], v[32:47]
    ds_read_b64_tr_b16 v[96:97], v5 offset:51200
    ds_read_b64_tr_b16 v[98:99], v5 offset:52224
    s_waitcnt lgkmcnt(6)
    v_mfma_f32_32x32x16_bf16 v[16:31], v[84:87], v[124:127], v[16:31]
    ds_read_b32 v0, v108 offset:1024
    ds_read_b64_tr_b16 v[100:101], v4 offset:51200
    ds_read_b64_tr_b16 v[102:103], v4 offset:52224
    s_waitcnt lgkmcnt(7)
    v_mfma_f32_32x32x16_bf16 v[32:47], v[88:91], v[128:131], v[32:47]
    ds_read_b64_tr_b16 v[80:81], v5 offset:53248
    ds_read_b64_tr_b16 v[82:83], v5 offset:54272
    s_waitcnt lgkmcnt(7)
    v_mfma_f32_32x32x16_bf16 v[16:31], v[92:95], v[128:131], v[16:31]
    ds_read_b64_tr_b16 v[84:85], v4 offset:53248
    ds_read_b64_tr_b16 v[86:87], v4 offset:54272
    s_waitcnt lgkmcnt(7)
    v_mfma_f32_32x32x16_bf16 v[32:47], v[96:99], v[132:135], v[32:47]
    ds_read_b64_tr_b16 v[88:89], v5 offset:55296
    ds_read_b64_tr_b16 v[90:91], v5 offset:56320
    s_waitcnt lgkmcnt(6)
    v_mfma_f32_32x32x16_bf16 v[16:31], v[100:103], v[132:135], v[16:31]
    ds_read_b64_tr_b16 v[92:93], v4 offset:55296
    ds_read_b64_tr_b16 v[94:95], v4 offset:56320
    s_waitcnt lgkmcnt(6)
    v_mfma_f32_32x32x16_bf16 v[32:47], v[80:83], v[136:139], v[32:47]
    v_cmp_gt_u32 vcc, 42, v0
    s_cbranch_vccnz SLOW_adaLN_cond__sliding_local_dilated__glu_gated_reglu__prompt_kernel_114
BACK_adaLN_cond__sliding_local_dilated__glu_gated_reglu__prompt_kernel_115:
    ds_read_b64_tr_b16 v[96:97], v3
    ds_read_b64_tr_b16 v[98:99], v3 offset:1024
    ds_read_b64 v[64:65], v110 offset:3072
    ds_read_b64 v[66:67], v110 offset:3088
    s_waitcnt lgkmcnt(8)
    v_mfma_f32_32x32x16_bf16 v[16:31], v[84:87], v[136:139], v[16:31]
    ds_read_b64_tr_b16 v[100:101], v2
    ds_read_b64_tr_b16 v[102:103], v2 offset:1024
    ds_read_b64 v[68:69], v110 offset:3104
    ds_read_b64 v[70:71], v110 offset:3120
    s_waitcnt lgkmcnt(10)
    v_mfma_f32_32x32x16_bf16 v[32:47], v[88:91], v[140:143], v[32:47]
    ds_read_b64_tr_b16 v[80:81], v3 offset:2048
    ds_read_b64_tr_b16 v[82:83], v3 offset:3072
    ds_read_b32 v72, v8
    s_waitcnt lgkmcnt(11)
    v_mfma_f32_32x32x16_bf16 v[16:31], v[92:95], v[140:143], v[16:31]
    ds_read_b32 v0, v108 offset:1024
    ds_read_b64_tr_b16 v[84:85], v2 offset:2048
    ds_read_b64_tr_b16 v[86:87], v2 offset:3072
    s_waitcnt lgkmcnt(12)
    v_mfma_f32_32x32x16_bf16 v[32:47], v[96:99], v[160:163], v[32:47]
    ds_read_b64_tr_b16 v[88:89], v3 offset:4096
    ds_read_b64_tr_b16 v[90:91], v3 offset:5120
    s_waitcnt lgkmcnt(5)
    v_mfma_f32_32x32x16_bf16 v[16:31], v[100:103], v[160:163], v[16:31]
    ds_read_b64_tr_b16 v[92:93], v2 offset:4096
    ds_read_b64_tr_b16 v[94:95], v2 offset:5120
    v_lshlrev_b32 v48, 16, v64
    v_and_b32 v49, 0xffff0000, v64
    v_lshlrev_b32 v50, 16, v65
    v_and_b32 v51, 0xffff0000, v65
    v_mfma_f32_32x32x16_bf16 v[32:47], v[80:83], v[164:167], v[32:47]
    ds_read_b64_tr_b16 v[96:97], v3 offset:6144
    ds_read_b64_tr_b16 v[98:99], v3 offset:7168
    v_lshlrev_b32 v52, 16, v66
    v_and_b32 v53, 0xffff0000, v66
    v_lshlrev_b32 v54, 16, v67
    v_and_b32 v55, 0xffff0000, v67
    s_waitcnt lgkmcnt(6)
    v_mfma_f32_32x32x16_bf16 v[16:31], v[84:87], v[164:167], v[16:31]
    ds_read_b64_tr_b16 v[100:101], v2 offset:6144
    ds_read_b64_tr_b16 v[102:103], v2 offset:7168
    v_lshlrev_b32 v56, 16, v68
    v_and_b32 v57, 0xffff0000, v68
    v_lshlrev_b32 v58, 16, v69
    v_and_b32 v59, 0xffff0000, v69
    s_waitcnt lgkmcnt(6)
    v_mfma_f32_32x32x16_bf16 v[32:47], v[88:91], v[168:171], v[32:47]
    v_cmp_gt_u32 vcc, 43, v0
    s_cbranch_vccnz SLOW_adaLN_cond__sliding_local_dilated__glu_gated_reglu__prompt_kernel_116
BACK_adaLN_cond__sliding_local_dilated__glu_gated_reglu__prompt_kernel_117:
    ds_read_b64_tr_b16 v[80:81], v3 offset:16384
    ds_read_b64_tr_b16 v[82:83], v3 offset:17408
    v_lshlrev_b32 v60, 16, v70
    v_and_b32 v61, 0xffff0000, v70
    v_lshlrev_b32 v62, 16, v71
    v_and_b32 v63, 0xffff0000, v71
    s_waitcnt lgkmcnt(6)
    v_mfma_f32_32x32x16_bf16 v[16:31], v[92:95], v[168:171], v[16:31]
    ds_read_b64_tr_b16 v[84:85], v2 offset:16384
    ds_read_b64_tr_b16 v[86:87], v2 offset:17408
    v_mul_f32 v48, v48, v72
    v_mul_f32 v49, v49, v72
    s_waitcnt lgkmcnt(6)
    v_mfma_f32_32x32x16_bf16 v[32:47], v[96:99], v[172:175], v[32:47]
    ds_read_b64_tr_b16 v[88:89], v3 offset:18432
    ds_read_b64_tr_b16 v[90:91], v3 offset:19456
    v_mul_f32 v50, v50, v72
    v_mul_f32 v51, v51, v72
    s_waitcnt lgkmcnt(6)
    v_mfma_f32_32x32x16_bf16 v[16:31], v[100:103], v[172:175], v[16:31]
    ds_read_b32 v0, v108 offset:1024
    ds_read_b64_tr_b16 v[92:93], v2 offset:18432
    ds_read_b64_tr_b16 v[94:95], v2 offset:19456
    v_mul_f32 v52, v52, v72
    v_mul_f32 v53, v53, v72
    s_waitcnt lgkmcnt(7)
    v_mfma_f32_32x32x16_bf16 v[32:47], v[80:83], v[176:179], v[32:47]
    ds_read_b64_tr_b16 v[96:97], v3 offset:20480
    ds_read_b64_tr_b16 v[98:99], v3 offset:21504
    v_mul_f32 v54, v54, v72
    v_mul_f32 v55, v55, v72
    s_waitcnt lgkmcnt(7)
    v_mfma_f32_32x32x16_bf16 v[16:31], v[84:87], v[176:179], v[16:31]
    ds_read_b64_tr_b16 v[100:101], v2 offset:20480
    ds_read_b64_tr_b16 v[102:103], v2 offset:21504
    v_mul_f32 v56, v56, v72
    v_mul_f32 v57, v57, v72
    s_waitcnt lgkmcnt(7)
    v_mfma_f32_32x32x16_bf16 v[32:47], v[88:91], v[180:183], v[32:47]
    ds_read_b64_tr_b16 v[80:81], v3 offset:22528
    ds_read_b64_tr_b16 v[82:83], v3 offset:23552
    v_mul_f32 v58, v58, v72
    v_mul_f32 v59, v59, v72
    s_waitcnt lgkmcnt(6)
    v_mfma_f32_32x32x16_bf16 v[16:31], v[92:95], v[180:183], v[16:31]
    ds_read_b64_tr_b16 v[84:85], v2 offset:22528
    ds_read_b64_tr_b16 v[86:87], v2 offset:23552
    v_mul_f32 v60, v60, v72
    v_mul_f32 v61, v61, v72
    s_waitcnt lgkmcnt(6)
    v_mfma_f32_32x32x16_bf16 v[32:47], v[96:99], v[184:187], v[32:47]
    v_cmp_gt_u32 vcc, 44, v0
    s_cbranch_vccnz SLOW_adaLN_cond__sliding_local_dilated__glu_gated_reglu__prompt_kernel_118
BACK_adaLN_cond__sliding_local_dilated__glu_gated_reglu__prompt_kernel_119:
    ds_read_b64_tr_b16 v[88:89], v3 offset:32768
    ds_read_b64_tr_b16 v[90:91], v3 offset:33792
    v_mul_f32 v62, v62, v72
    v_mul_f32 v63, v63, v72
    s_waitcnt lgkmcnt(6)
    v_mfma_f32_32x32x16_bf16 v[16:31], v[100:103], v[184:187], v[16:31]
    ds_read_b32 v0, v108 offset:1024
    ds_read_b64_tr_b16 v[92:93], v2 offset:32768
    ds_read_b64_tr_b16 v[94:95], v2 offset:33792
    v_lshlrev_b32 v64, 16, v144
    v_and_b32 v65, 0xffff0000, v144
    v_lshlrev_b32 v66, 16, v145
    v_and_b32 v67, 0xffff0000, v145
    s_waitcnt lgkmcnt(7)
    v_mfma_f32_32x32x16_bf16 v[32:47], v[80:83], v[188:191], v[32:47]
    ds_read_b64_tr_b16 v[96:97], v3 offset:34816
    ds_read_b64_tr_b16 v[98:99], v3 offset:35840
    v_lshlrev_b32 v68, 16, v146
    v_and_b32 v69, 0xffff0000, v146
    v_lshlrev_b32 v70, 16, v147
    v_and_b32 v71, 0xffff0000, v147
    s_waitcnt lgkmcnt(7)
    v_mfma_f32_32x32x16_bf16 v[16:31], v[84:87], v[188:191], v[16:31]
    ds_read_b64_tr_b16 v[100:101], v3 offset:36864
    ds_read_b64_tr_b16 v[102:103], v3 offset:37888
    v_lshlrev_b32 v72, 16, v148
    v_and_b32 v73, 0xffff0000, v148
    v_lshlrev_b32 v74, 16, v149
    v_and_b32 v75, 0xffff0000, v149
    s_waitcnt lgkmcnt(7)
    v_mfma_f32_32x32x16_bf16 v[32:47], v[88:91], v[192:195], v[32:47]
    ds_read_b64_tr_b16 v[80:81], v2 offset:34816
    ds_read_b64_tr_b16 v[82:83], v2 offset:35840
    v_lshlrev_b32 v76, 16, v150
    v_and_b32 v77, 0xffff0000, v150
    v_lshlrev_b32 v78, 16, v151
    v_and_b32 v79, 0xffff0000, v151
    s_waitcnt lgkmcnt(6)
    v_mfma_f32_32x32x16_bf16 v[16:31], v[92:95], v[192:195], v[16:31]
    ds_read_b64_tr_b16 v[84:85], v3 offset:38912
    ds_read_b64_tr_b16 v[86:87], v3 offset:39936
    s_waitcnt lgkmcnt(6)
    v_mfma_f32_32x32x16_bf16 v[32:47], v[96:99], v[196:199], v[32:47]
    v_cmp_gt_u32 vcc, 45, v0
    s_cbranch_vccnz SLOW_adaLN_cond__sliding_local_dilated__glu_gated_reglu__prompt_kernel_120
BACK_adaLN_cond__sliding_local_dilated__glu_gated_reglu__prompt_kernel_121:
    ds_read_b64_tr_b16 v[88:89], v3 offset:49152
    ds_read_b64_tr_b16 v[90:91], v3 offset:50176
    s_waitcnt vmcnt(13)
    s_waitcnt lgkmcnt(6)
    v_mfma_f32_32x32x16_bf16 v[32:47], v[100:103], v[200:203], v[32:47]
    ds_read_b32 v0, v108 offset:1024
    ds_read_b64_tr_b16 v[92:93], v2 offset:36864
    ds_read_b64_tr_b16 v[94:95], v2 offset:37888
    s_waitcnt lgkmcnt(7)
    v_mfma_f32_32x32x16_bf16 v[16:31], v[80:83], v[196:199], v[16:31]
    ds_read_b64_tr_b16 v[96:97], v3 offset:51200
    ds_read_b64_tr_b16 v[98:99], v3 offset:52224
    s_waitcnt vmcnt(12)
    s_waitcnt lgkmcnt(7)
    v_mfma_f32_32x32x16_bf16 v[32:47], v[84:87], v[204:207], v[32:47]
    ds_read_b64_tr_b16 v[100:101], v3 offset:53248
    ds_read_b64_tr_b16 v[102:103], v3 offset:54272
    s_waitcnt vmcnt(11)
    s_waitcnt lgkmcnt(7)
    v_mfma_f32_32x32x16_bf16 v[32:47], v[88:91], v[208:211], v[32:47]
    ds_read_b64_tr_b16 v[80:81], v2 offset:38912
    ds_read_b64_tr_b16 v[82:83], v2 offset:39936
    s_waitcnt lgkmcnt(6)
    v_mfma_f32_32x32x16_bf16 v[16:31], v[92:95], v[200:203], v[16:31]
    ds_read_b64_tr_b16 v[84:85], v3 offset:55296
    ds_read_b64_tr_b16 v[86:87], v3 offset:56320
    s_waitcnt vmcnt(10)
    s_waitcnt lgkmcnt(6)
    v_mfma_f32_32x32x16_bf16 v[32:47], v[96:99], v[212:215], v[32:47]
    v_cmp_gt_u32 vcc, 46, v0
    s_cbranch_vccnz SLOW_adaLN_cond__sliding_local_dilated__glu_gated_reglu__prompt_kernel_122
BACK_adaLN_cond__sliding_local_dilated__glu_gated_reglu__prompt_kernel_123:
    ds_read_b64_tr_b16 v[88:89], v5
    ds_read_b64_tr_b16 v[90:91], v5 offset:1024
    s_waitcnt vmcnt(9)
    s_waitcnt lgkmcnt(6)
    v_mfma_f32_32x32x16_bf16 v[32:47], v[100:103], v[216:219], v[32:47]
    ds_read_b32 v0, v108 offset:1024
    ds_read_b64_tr_b16 v[92:93], v2 offset:49152
    ds_read_b64_tr_b16 v[94:95], v2 offset:50176
    s_waitcnt lgkmcnt(7)
    v_mfma_f32_32x32x16_bf16 v[16:31], v[80:83], v[204:207], v[16:31]
    ds_read_b64_tr_b16 v[96:97], v5 offset:2048
    ds_read_b64_tr_b16 v[98:99], v5 offset:3072
    s_waitcnt vmcnt(8)
    s_waitcnt lgkmcnt(7)
    v_mfma_f32_32x32x16_bf16 v[32:47], v[84:87], v[220:223], v[32:47]
    ds_read_b64_tr_b16 v[100:101], v5 offset:4096
    ds_read_b64_tr_b16 v[102:103], v5 offset:5120
    s_waitcnt vmcnt(7)
    s_waitcnt lgkmcnt(7)
    v_mfma_f32_32x32x16_bf16 v[32:47], v[88:91], v[224:227], v[32:47]
    ds_read_b64_tr_b16 v[80:81], v2 offset:51200
    ds_read_b64_tr_b16 v[82:83], v2 offset:52224
    s_waitcnt lgkmcnt(6)
    v_mfma_f32_32x32x16_bf16 v[16:31], v[92:95], v[208:211], v[16:31]
    ds_read_b64_tr_b16 v[84:85], v5 offset:6144
    ds_read_b64_tr_b16 v[86:87], v5 offset:7168
    s_waitcnt vmcnt(6)
    s_waitcnt lgkmcnt(6)
    v_mfma_f32_32x32x16_bf16 v[32:47], v[96:99], v[228:231], v[32:47]
    v_cmp_gt_u32 vcc, 47, v0
    s_cbranch_vccnz SLOW_adaLN_cond__sliding_local_dilated__glu_gated_reglu__prompt_kernel_124
BACK_adaLN_cond__sliding_local_dilated__glu_gated_reglu__prompt_kernel_125:
    ds_read_b64_tr_b16 v[88:89], v5 offset:16384
    ds_read_b64_tr_b16 v[90:91], v5 offset:17408
    s_waitcnt vmcnt(5)
    s_waitcnt lgkmcnt(6)
    v_mfma_f32_32x32x16_bf16 v[32:47], v[100:103], v[232:235], v[32:47]
    ds_read_b64_tr_b16 v[92:93], v2 offset:53248
    ds_read_b64_tr_b16 v[94:95], v2 offset:54272
    s_waitcnt lgkmcnt(6)
    v_mfma_f32_32x32x16_bf16 v[16:31], v[80:83], v[212:215], v[16:31]
    ds_read_b64_tr_b16 v[96:97], v5 offset:18432
    ds_read_b64_tr_b16 v[98:99], v5 offset:19456
    s_waitcnt vmcnt(4)
    s_waitcnt lgkmcnt(6)
    v_mfma_f32_32x32x16_bf16 v[32:47], v[84:87], v[236:239], v[32:47]
    ds_read_b64_tr_b16 v[100:101], v5 offset:20480
    ds_read_b64_tr_b16 v[102:103], v5 offset:21504
    s_waitcnt vmcnt(3)
    s_waitcnt lgkmcnt(6)
    v_mfma_f32_32x32x16_bf16 v[32:47], v[88:91], v[240:243], v[32:47]
    ds_read_b64_tr_b16 v[80:81], v2 offset:55296
    ds_read_b64_tr_b16 v[82:83], v2 offset:56320
    s_waitcnt lgkmcnt(6)
    v_mfma_f32_32x32x16_bf16 v[16:31], v[92:95], v[216:219], v[16:31]
    ds_read_b64_tr_b16 v[84:85], v5 offset:22528
    ds_read_b64_tr_b16 v[86:87], v5 offset:23552
    s_waitcnt vmcnt(2)
    s_waitcnt lgkmcnt(6)
    v_mfma_f32_32x32x16_bf16 v[32:47], v[96:99], v[244:247], v[32:47]
    ds_read_b64_tr_b16 v[88:89], v4
    ds_read_b64_tr_b16 v[90:91], v4 offset:1024
    s_waitcnt vmcnt(1)
    s_waitcnt lgkmcnt(6)
    v_mfma_f32_32x32x16_bf16 v[32:47], v[100:103], v[248:251], v[32:47]
    ds_read_b64_tr_b16 v[92:93], v4 offset:2048
    ds_read_b64_tr_b16 v[94:95], v4 offset:3072
    s_waitcnt lgkmcnt(6)
    v_mfma_f32_32x32x16_bf16 v[16:31], v[80:83], v[220:223], v[16:31]
    ds_read_b64_tr_b16 v[96:97], v4 offset:4096
    ds_read_b64_tr_b16 v[98:99], v4 offset:5120
    s_waitcnt vmcnt(0)
    s_waitcnt lgkmcnt(6)
    v_mfma_f32_32x32x16_bf16 v[32:47], v[84:87], v[252:255], v[32:47]
    ds_read_b64_tr_b16 v[100:101], v4 offset:6144
    ds_read_b64_tr_b16 v[102:103], v4 offset:7168
    s_waitcnt lgkmcnt(6)
    v_mfma_f32_32x32x16_bf16 v[16:31], v[88:91], v[224:227], v[16:31]
    ds_read_b64_tr_b16 v[80:81], v4 offset:16384
    ds_read_b64_tr_b16 v[82:83], v4 offset:17408
    s_waitcnt lgkmcnt(6)
    v_mfma_f32_32x32x16_bf16 v[16:31], v[92:95], v[228:231], v[16:31]
    ds_read_b64_tr_b16 v[84:85], v4 offset:18432
    ds_read_b64_tr_b16 v[86:87], v4 offset:19456
    s_nop 1
    ds_write_b128 v6, v[32:35]
    ds_write_b128 v6, v[36:39] offset:1024
    ds_write_b128 v6, v[40:43] offset:2048
    ds_write_b128 v6, v[44:47] offset:3072
    ds_inc_u32 v109, v109
    s_waitcnt lgkmcnt(11)
    v_mfma_f32_32x32x16_bf16 v[16:31], v[96:99], v[232:235], v[16:31]
    ds_read_b64_tr_b16 v[88:89], v4 offset:20480
    ds_read_b64_tr_b16 v[90:91], v4 offset:21504
    s_waitcnt lgkmcnt(11)
    v_mfma_f32_32x32x16_bf16 v[16:31], v[100:103], v[236:239], v[16:31]
    ds_read_b64_tr_b16 v[92:93], v4 offset:22528
    ds_read_b64_tr_b16 v[94:95], v4 offset:23552
    s_waitcnt lgkmcnt(11)
    v_mfma_f32_32x32x16_bf16 v[16:31], v[80:83], v[240:243], v[16:31]
    ds_read_b32 v0, v111
    s_waitcnt lgkmcnt(10)
    v_mfma_f32_32x32x16_bf16 v[16:31], v[84:87], v[244:247], v[16:31]
    s_waitcnt lgkmcnt(3)
    v_mfma_f32_32x32x16_bf16 v[16:31], v[88:91], v[248:251], v[16:31]
    s_waitcnt lgkmcnt(0)
    v_cmp_gt_u32 vcc, 53, v0
    s_cbranch_vccnz SLOW_adaLN_cond__sliding_local_dilated__glu_gated_reglu__prompt_kernel_126
BACK_adaLN_cond__sliding_local_dilated__glu_gated_reglu__prompt_kernel_127:
    ds_read_b128 v[32:35], v7
    ds_read_b128 v[36:39], v7 offset:1024
    ds_read_b128 v[40:43], v7 offset:2048
    ds_read_b128 v[44:47], v7 offset:3072
    v_mfma_f32_32x32x16_bf16 v[16:31], v[92:95], v[252:255], v[16:31]
    s_waitcnt lgkmcnt(0)
    v_pk_fma_f32 v[64:65], v[32:33], v[48:49], v[64:65]
    v_pk_fma_f32 v[66:67], v[34:35], v[50:51], v[66:67]
    v_pk_fma_f32 v[68:69], v[36:37], v[52:53], v[68:69]
    v_pk_fma_f32 v[70:71], v[38:39], v[54:55], v[70:71]
    v_pk_fma_f32 v[72:73], v[40:41], v[56:57], v[72:73]
    v_pk_fma_f32 v[74:75], v[42:43], v[58:59], v[74:75]
    v_pk_fma_f32 v[76:77], v[44:45], v[60:61], v[76:77]
    v_pk_fma_f32 v[78:79], v[46:47], v[62:63], v[78:79]
    s_nop 2
    v_pk_fma_f32 v[16:17], v[16:17], v[48:49], v[64:65]
    v_pk_fma_f32 v[18:19], v[18:19], v[50:51], v[66:67]
    v_pk_fma_f32 v[20:21], v[20:21], v[52:53], v[68:69]
    v_pk_fma_f32 v[22:23], v[22:23], v[54:55], v[70:71]
    v_cvt_pk_bf16_f32 v32, v16, v17
    v_cvt_pk_bf16_f32 v33, v18, v19
    v_cvt_pk_bf16_f32 v34, v20, v21
    v_cvt_pk_bf16_f32 v35, v22, v23
    s_nop 0
    v_permlane32_swap_b32 v32, v34
    v_permlane32_swap_b32 v33, v35
    buffer_store_dwordx4 v[32:35], v9, s[64:67], 0 offen
    v_pk_fma_f32 v[24:25], v[24:25], v[56:57], v[72:73]
    v_pk_fma_f32 v[26:27], v[26:27], v[58:59], v[74:75]
    v_pk_fma_f32 v[28:29], v[28:29], v[60:61], v[76:77]
    v_pk_fma_f32 v[30:31], v[30:31], v[62:63], v[78:79]
    v_cvt_pk_bf16_f32 v36, v24, v25
    v_cvt_pk_bf16_f32 v37, v26, v27
    v_cvt_pk_bf16_f32 v38, v28, v29
    v_cvt_pk_bf16_f32 v39, v30, v31
    s_nop 0
    v_permlane32_swap_b32 v36, v38
    v_permlane32_swap_b32 v37, v39
    buffer_store_dwordx4 v[36:39], v9, s[64:67], 0 offen offset:32
    s_branch FIN
MWAVE:
    s_nop 7
    s_nop 7
    s_sub_u32 s80, s7, 7
    s_cselect_b32 s80, s7, s80
    s_lshl_b32 s32, s80, 18
    s_add_u32 s80, s80, 1
    s_cmp_eq_u32 s80, 7
    s_cselect_b32 s80, 0, s80
    s_lshl_b32 s33, s80, 18
    s_add_u32 s80, s80, 1
    s_cmp_eq_u32 s80, 7
    s_cselect_b32 s80, 0, s80
    s_lshl_b32 s34, s80, 18
    s_add_u32 s80, s80, 1
    s_cmp_eq_u32 s80, 7
    s_cselect_b32 s80, 0, s80
    s_lshl_b32 s35, s80, 18
    s_add_u32 s80, s80, 1
    s_cmp_eq_u32 s80, 7
    s_cselect_b32 s80, 0, s80
    s_lshl_b32 s36, s80, 18
    s_add_u32 s80, s80, 1
    s_cmp_eq_u32 s80, 7
    s_cselect_b32 s80, 0, s80
    s_lshl_b32 s37, s80, 18
    s_add_u32 s80, s80, 1
    s_cmp_eq_u32 s80, 7
    s_cselect_b32 s80, 0, s80
    s_lshl_b32 s38, s80, 18
    s_cmp_eq_u32 s79, 7
    s_cselect_b32 s39, 0, s7
    s_mul_i32 s80, s2, 7168
    v_min_u32 v8, 55, v15
    v_lshlrev_b32 v8, 7, v8
    buffer_load_dword v20, v8, s[52:55], s80 offen
    s_movk_i32 s86, 30000
WL_adaLN_cond__sliding_local_dilated__glu_gated_reglu__prompt_kernel_128:
    ds_read_b32 v30, v28
    s_waitcnt lgkmcnt(0)
    v_cmp_gt_u32 vcc, 10, v30
    s_cbranch_vccz WD_adaLN_cond__sliding_local_dilated__glu_gated_reglu__prompt_kernel_129
    s_sleep 1
    s_sub_u32 s86, s86, 1
    s_cmp_lg_u32 s86, 0
    s_cbranch_scc1 WL_adaLN_cond__sliding_local_dilated__glu_gated_reglu__prompt_kernel_128
WD_adaLN_cond__sliding_local_dilated__glu_gated_reglu__prompt_kernel_129:
    s_add_u32 m0, s84, 0
    s_lshl_b32 s80, s64, 8
    buffer_load_dwordx4 v1, s[40:43], s80 offen lds
    s_add_u32 m0, s84, 4096
    s_lshl_b32 s80, s64, 8
    s_add_u32 s80, s80, 32768
    buffer_load_dwordx4 v1, s[40:43], s80 offen lds
    s_add_u32 m0, s84, 8192
    s_lshl_b32 s80, s65, 8
    buffer_load_dwordx4 v1, s[40:43], s80 offen lds
    s_movk_i32 s86, 30000
WL_adaLN_cond__sliding_local_dilated__glu_gated_reglu__prompt_kernel_130:
    ds_read_b32 v30, v28
    s_waitcnt lgkmcnt(0)
    v_cmp_gt_u32 vcc, 11, v30
    s_cbranch_vccz WD_adaLN_cond__sliding_local_dilated__glu_gated_reglu__prompt_kernel_131
    s_sleep 1
    s_sub_u32 s86, s86, 1
    s_cmp_lg_u32 s86, 0
    s_cbranch_scc1 WL_adaLN_cond__sliding_local_dilated__glu_gated_reglu__prompt_kernel_130
WD_adaLN_cond__sliding_local_dilated__glu_gated_reglu__prompt_kernel_131:
    s_add_u32 m0, s84, 12288
    s_lshl_b32 s80, s65, 8
    s_add_u32 s80, s80, 32768
    buffer_load_dwordx4 v1, s[40:43], s80 offen lds
    s_add_u32 m0, s84, 16384
    s_lshl_b32 s80, s66, 8
    buffer_load_dwordx4 v1, s[40:43], s80 offen lds
    s_add_u32 m0, s84, 20480
    s_lshl_b32 s80, s66, 8
    s_add_u32 s80, s80, 32768
    buffer_load_dwordx4 v1, s[40:43], s80 offen lds
    s_movk_i32 s86, 30000
WL_adaLN_cond__sliding_local_dilated__glu_gated_reglu__prompt_kernel_132:
    ds_read_b32 v30, v28
    s_waitcnt lgkmcnt(0)
    v_cmp_gt_u32 vcc, 12, v30
    s_cbranch_vccz WD_adaLN_cond__sliding_local_dilated__glu_gated_reglu__prompt_kernel_133
    s_sleep 1
    s_sub_u32 s86, s86, 1
    s_cmp_lg_u32 s86, 0
    s_cbranch_scc1 WL_adaLN_cond__sliding_local_dilated__glu_gated_reglu__prompt_kernel_132
WD_adaLN_cond__sliding_local_dilated__glu_gated_reglu__prompt_kernel_133:
    s_add_u32 m0, s84, 24576
    s_lshl_b32 s80, s67, 8
    buffer_load_dwordx4 v1, s[40:43], s80 offen lds
    s_add_u32 m0, s84, 28672
    s_lshl_b32 s80, s67, 8
    s_add_u32 s80, s80, 32768
    buffer_load_dwordx4 v1, s[40:43], s80 offen lds
    s_add_u32 m0, s84, 32768
    s_lshl_b32 s80, s64, 8
    s_add_u32 s80, s80, 262144
    buffer_load_dwordx4 v1, s[40:43], s80 offen lds
    s_movk_i32 s86, 30000
WL_adaLN_cond__sliding_local_dilated__glu_gated_reglu__prompt_kernel_134:
    ds_read_b32 v30, v28
    s_waitcnt lgkmcnt(0)
    v_cmp_gt_u32 vcc, 14, v30
    s_cbranch_vccz WD_adaLN_cond__sliding_local_dilated__glu_gated_reglu__prompt_kernel_135
    s_sleep 1
    s_sub_u32 s86, s86, 1
    s_cmp_lg_u32 s86, 0
    s_cbranch_scc1 WL_adaLN_cond__sliding_local_dilated__glu_gated_reglu__prompt_kernel_134
WD_adaLN_cond__sliding_local_dilated__glu_gated_reglu__prompt_kernel_135:
    s_add_u32 m0, s84, 36864
    s_lshl_b32 s80, s64, 8
    s_add_u32 s80, s80, 294912
    buffer_load_dwordx4 v1, s[40:43], s80 offen lds
    s_add_u32 m0, s84, 40960
    s_lshl_b32 s80, s65, 8
    s_add_u32 s80, s80, 262144
    buffer_load_dwordx4 v1, s[40:43], s80 offen lds
    s_add_u32 m0, s84, 45056
    s_lshl_b32 s80, s65, 8
    s_add_u32 s80, s80, 294912
    buffer_load_dwordx4 v1, s[40:43], s80 offen lds
    s_movk_i32 s86, 30000
WL_adaLN_cond__sliding_local_dilated__glu_gated_reglu__prompt_kernel_136:
    ds_read_b32 v30, v28
    s_waitcnt lgkmcnt(0)
    v_cmp_gt_u32 vcc, 15, v30
    s_cbranch_vccz WD_adaLN_cond__sliding_local_dilated__glu_gated_reglu__prompt_kernel_137
    s_sleep 1
    s_sub_u32 s86, s86, 1
    s_cmp_lg_u32 s86, 0
    s_cbranch_scc1 WL_adaLN_cond__sliding_local_dilated__glu_gated_reglu__prompt_kernel_136
WD_adaLN_cond__sliding_local_dilated__glu_gated_reglu__prompt_kernel_137:
    s_add_u32 m0, s84, 49152
    s_lshl_b32 s80, s66, 8
    s_add_u32 s80, s80, 262144
    buffer_load_dwordx4 v1, s[40:43], s80 offen lds
    s_add_u32 m0, s84, 53248
    s_lshl_b32 s80, s66, 8
    s_add_u32 s80, s80, 294912
    buffer_load_dwordx4 v1, s[40:43], s80 offen lds
    s_add_u32 m0, s84, 57344
    s_lshl_b32 s80, s67, 8
    s_add_u32 s80, s80, 262144
    buffer_load_dwordx4 v1, s[40:43], s80 offen lds
    s_movk_i32 s86, 30000
WL_adaLN_cond__sliding_local_dilated__glu_gated_reglu__prompt_kernel_138:
    ds_read_b32 v30, v28
    s_waitcnt lgkmcnt(0)
    v_cmp_gt_u32 vcc, 16, v30
    s_cbranch_vccz WD_adaLN_cond__sliding_local_dilated__glu_gated_reglu__prompt_kernel_139
    s_sleep 1
    s_sub_u32 s86, s86, 1
    s_cmp_lg_u32 s86, 0
    s_cbranch_scc1 WL_adaLN_cond__sliding_local_dilated__glu_gated_reglu__prompt_kernel_138
WD_adaLN_cond__sliding_local_dilated__glu_gated_reglu__prompt_kernel_139:
    s_add_u32 m0, s84, 61440
    s_lshl_b32 s80, s67, 8
    s_add_u32 s80, s80, 294912
    buffer_load_dwordx4 v1, s[40:43], s80 offen lds
    s_branch HMERGE
HELPER:
    s_nop 7
    s_nop 7
    s_lshl_b32 s80, s3, 8
    s_add_u32 s80, s80, 159744
    v_lshlrev_b32 v29, 2, v15
    v_add_u32 v29, s80, v29
    v_and_b32 v28, 3, v15
    v_mul_u32_u24 v28, 260, v28
    v_add_u32 v28, 159744, v28
    v_mov_b32 v30, 0
    ds_write_b32 v29, v30
    v_mov_b32 v31, 16
    s_cmp_lg_u32 s3, 6
    s_cbranch_scc1 NOT6
    ds_write_b32 v29, v31 offset:256
    ds_write_b32 v28, v30 offset:2048
    ds_write_b32 v28, v30 offset:3200
NOT6:
    v_lshrrev_b32 v2, 3, v15
    v_and_b32 v3, 7, v15
    v_and_b32 v12, 2, v2
    v_xor_b32 v3, v3, v12
    s_movk_i32 s80, 3072
    v_mul_u32_u24 v12, s80, v2
    v_lshl_add_u32 v12, v3, 4, v12
    s_lshl_b32 s80, s75, 7
    s_lshl_b32 s84, s89, 10
    s_add_u32 s80, s80, s84
    v_add_u32 v12, s80, v12
    v_xor_b32 v13, 64, v12
    v_add_u32 v13, 24576, v13
    s_and_b32 s64, s6, 3
    s_lshl_b32 s64, s64, 8
    s_add_u32 s65, s6, 1
    s_and_b32 s65, s65, 3
    s_lshl_b32 s65, s65, 8
    s_add_u32 s66, s6, 2
    s_and_b32 s66, s66, 3
    s_lshl_b32 s66, s66, 8
    s_add_u32 s67, s6, 3
    s_and_b32 s67, s67, 3
    s_lshl_b32 s67, s67, 8
    s_waitcnt lgkmcnt(0)
    s_mul_i32 s0, s74, 196608
    s_sub_u32 s1, 196608, s0
    s_mov_b32 s36, s10
    s_and_b32 s37, s11, 0xffff
    s_mov_b32 s38, 0x180000
    s_mov_b32 s39, 0x20000
    s_barrier
    s_mul_i32 s80, s64, 1536
    s_add_u32 s80, s80, s0
    s_add_u32 s81, s80, 49152
    s_add_u32 m0, s84, 24576
    s_nop 0
    buffer_load_dwordx4 v12, s[36:39], s80 offen lds
    s_add_u32 m0, s84, 27648
    s_nop 0
    buffer_load_dwordx4 v13, s[36:39], s80 offen lds
    s_add_u32 m0, s84, 30720
    s_nop 0
    buffer_load_dwordx4 v12, s[36:39], s81 offen lds
    s_add_u32 m0, s84, 33792
    s_nop 0
    buffer_load_dwordx4 v13, s[36:39], s81 offen lds
    s_mul_i32 s80, s64, 1536
    s_add_u32 s80, s80, s0
    s_add_u32 s80, s80, 98304
    s_add_u32 s81, s80, 49152
    s_add_u32 m0, s84, 36864
    s_nop 0
    buffer_load_dwordx4 v12, s[36:39], s80 offen lds
    s_add_u32 m0, s84, 39936
    s_nop 0
    buffer_load_dwordx4 v13, s[36:39], s80 offen lds
    s_add_u32 m0, s84, 43008
    s_nop 0
    buffer_load_dwordx4 v12, s[36:39], s81 offen lds
    s_add_u32 m0, s84, 46080
    s_nop 0
    buffer_load_dwordx4 v13, s[36:39], s81 offen lds
    s_mul_i32 s80, s64, 1536
    s_add_u32 s80, s80, s1
    s_add_u32 s81, s80, 49152
    s_add_u32 m0, s84, 49152
    s_nop 0
    buffer_load_dwordx4 v12, s[36:39], s80 offen lds
    s_add_u32 m0, s84, 52224
    s_nop 0
    buffer_load_dwordx4 v13, s[36:39], s80 offen lds
    s_add_u32 m0, s84, 55296
    s_nop 0
    buffer_load_dwordx4 v12, s[36:39], s81 offen lds
    s_add_u32 m0, s84, 58368
    s_nop 0
    buffer_load_dwordx4 v13, s[36:39], s81 offen lds
    s_mul_i32 s80, s64, 1536
    s_add_u32 s80, s80, s1
    s_add_u32 s80, s80, 98304
    s_add_u32 s81, s80, 49152
    s_add_u32 m0, s84, 61440
    s_nop 0
    buffer_load_dwordx4 v12, s[36:39], s80 offen lds
    s_add_u32 m0, s84, 64512
    s_nop 0
    buffer_load_dwordx4 v13, s[36:39], s80 offen lds
    s_add_u32 m0, s84, 67584
    s_nop 0
    buffer_load_dwordx4 v12, s[36:39], s81 offen lds
    s_add_u32 m0, s84, 70656
    s_nop 0
    buffer_load_dwordx4 v13, s[36:39], s81 offen lds
    s_mul_i32 s80, s65, 1536
    s_add_u32 s80, s80, s0
    s_add_u32 s81, s80, 49152
    s_add_u32 m0, s84, 73728
    s_nop 0
    buffer_load_dwordx4 v12, s[36:39], s80 offen lds
    s_add_u32 m0, s84, 76800
    s_nop 0
    buffer_load_dwordx4 v13, s[36:39], s80 offen lds
    s_add_u32 m0, s84, 79872
    s_nop 0
    buffer_load_dwordx4 v12, s[36:39], s81 offen lds
    s_add_u32 m0, s84, 82944
    s_nop 0
    buffer_load_dwordx4 v13, s[36:39], s81 offen lds
    s_mul_i32 s80, s65, 1536
    s_add_u32 s80, s80, s0
    s_add_u32 s80, s80, 98304
    s_add_u32 s81, s80, 49152
    s_add_u32 m0, s84, 86016
    s_nop 0
    buffer_load_dwordx4 v12, s[36:39], s80 offen lds
    s_add_u32 m0, s84, 89088
    s_nop 0
    buffer_load_dwordx4 v13, s[36:39], s80 offen lds
    s_add_u32 m0, s84, 92160
    s_nop 0
    buffer_load_dwordx4 v12, s[36:39], s81 offen lds
    s_add_u32 m0, s84, 95232
    s_nop 0
    buffer_load_dwordx4 v13, s[36:39], s81 offen lds
    s_mov_b32 s68, s30
    s_and_b32 s69, s31, 0xffff
    s_mov_b32 s70, 0xe00000
    s_mov_b32 s71, 0x20000
    s_mov_b32 s40, s12
    s_and_b32 s41, s13, 0xffff
    s_mov_b32 s42, 0x80000
    s_mov_b32 s43, 0x20000
    s_mov_b32 s44, s16
    s_and_b32 s45, s17, 0xffff
    s_mov_b32 s46, 0x1c0000
    s_mov_b32 s47, 0x20000
    s_mov_b32 s48, s18
    s_and_b32 s49, s19, 0xffff
    s_mov_b32 s50, 0x1c0000
    s_mov_b32 s51, 0x20000
    s_mov_b32 s52, s20
    s_and_b32 s53, s21, 0xffff
    s_mov_b32 s54, 0x1c0000
    s_mov_b32 s55, 0x20000
    v_lshrrev_b32 v0, 3, v15
    v_and_b32 v11, 7, v15
    v_and_b32 v5, 2, v0
    v_xor_b32 v4, v11, v5
    s_lshl_b32 s81, s88, 2
    v_xor_b32 v4, s81, v4
    v_lshlrev_b32 v5, 1, v5
    v_xor_b32 v5, v11, v5
    s_lshl_b32 s81, s89, 3
    v_add_u32 v1, s81, v0
    v_lshlrev_b32 v1, 10, v1
    v_lshl_add_u32 v1, v5, 4, v1
    s_lshl_b32 s81, s75, 7
    v_add_u32 v1, s81, v1
    s_lshl_b32 s81, s87, 3
    v_add_u32 v2, s81, v0
    s_movk_i32 s81, 3584
    v_mul_u32_u24 v2, s81, v2
    v_lshl_add_u32 v2, v4, 4, v2
    s_lshl_b32 s81, s78, 8
    s_lshr_b32 s83, s73, 3
    s_lshl_b32 s82, s72, 1
    s_add_u32 s83, s83, s82
    s_min_u32 s83, s83, 27
    s_lshl_b32 s83, s83, 7
    s_cmp_eq_u32 s79, 7
    s_cselect_b32 s81, s83, s81
    s_cselect_b32 s83, 0, 0x1c0000
    v_add_u32 v2, s81, v2
    s_lshl_b32 s84, s89, 10
    v_add_u32 v4, s84, v14
    v_add_u32 v5, 0x10000, v4
    s_bitcmp1_b32 s89, 0
    s_cselect_b32 s44, s48, s44
    s_cselect_b32 s45, s49, s45
    s_mov_b32 s48, s44
    s_mov_b32 s49, s45
    s_mov_b32 s50, s83
    s_lshl_b32 s100, s72, 14
    s_add_u32 s100, s100, 0x60000
    s_lshl_b32 s80, s73, 7
    s_add_u32 s95, s100, s80
    v_lshlrev_b32 v3, 7, v15
    s_waitcnt vmcnt(20)
    ds_inc_u32 v29, v29
    s_waitcnt vmcnt(16)
    ds_inc_u32 v29, v29
    s_movk_i32 s86, 30000
WL_adaLN_cond__sliding_local_dilated__glu_gated_reglu__prompt_kernel_140:
    ds_read_b32 v30, v28 offset:2048
    s_waitcnt lgkmcnt(0)
    v_cmp_gt_u32 vcc, 2, v30
    s_cbranch_vccz WD_adaLN_cond__sliding_local_dilated__glu_gated_reglu__prompt_kernel_141
    s_sleep 1
    s_sub_u32 s86, s86, 1
    s_cmp_lg_u32 s86, 0
    s_cbranch_scc1 WL_adaLN_cond__sliding_local_dilated__glu_gated_reglu__prompt_kernel_140
WD_adaLN_cond__sliding_local_dilated__glu_gated_reglu__prompt_kernel_141:
    s_mul_i32 s80, s65, 1536
    s_add_u32 s80, s80, s1
    s_add_u32 s81, s80, 49152
    s_add_u32 m0, s84, 98304
    s_nop 0
    buffer_load_dwordx4 v12, s[36:39], s80 offen lds
    s_add_u32 m0, s84, 101376
    s_nop 0
    buffer_load_dwordx4 v13, s[36:39], s80 offen lds
    s_add_u32 m0, s84, 104448
    s_nop 0
    buffer_load_dwordx4 v12, s[36:39], s81 offen lds
    s_add_u32 m0, s84, 107520
    s_nop 0
    buffer_load_dwordx4 v13, s[36:39], s81 offen lds
    s_mul_i32 s80, s65, 1536
    s_add_u32 s80, s80, s1
    s_add_u32 s80, s80, 98304
    s_add_u32 s81, s80, 49152
    s_add_u32 m0, s84, 0
    s_nop 0
    buffer_load_dwordx4 v12, s[36:39], s80 offen lds
    s_add_u32 m0, s84, 3072
    s_nop 0
    buffer_load_dwordx4 v13, s[36:39], s80 offen lds
    s_add_u32 m0, s84, 6144
    s_nop 0
    buffer_load_dwordx4 v12, s[36:39], s81 offen lds
    s_add_u32 m0, s84, 9216
    s_nop 0
    buffer_load_dwordx4 v13, s[36:39], s81 offen lds
    s_waitcnt vmcnt(20)
    ds_inc_u32 v29, v29
    s_waitcnt vmcnt(16)
    ds_inc_u32 v29, v29
    s_waitcnt vmcnt(12)
    ds_inc_u32 v29, v29
    s_waitcnt vmcnt(8)
    ds_inc_u32 v29, v29
    s_mul_i32 s80, s66, 1536
    s_add_u32 s80, s80, s0
    s_add_u32 s81, s80, 49152
    s_add_u32 m0, s84, 12288
    s_nop 0
    buffer_load_dwordx4 v12, s[36:39], s80 offen lds
    s_add_u32 m0, s84, 15360
    s_nop 0
    buffer_load_dwordx4 v13, s[36:39], s80 offen lds
    s_add_u32 m0, s84, 18432
    s_nop 0
    buffer_load_dwordx4 v12, s[36:39], s81 offen lds
    s_add_u32 m0, s84, 21504
    s_nop 0
    buffer_load_dwordx4 v13, s[36:39], s81 offen lds
    s_waitcnt vmcnt(8)
    ds_inc_u32 v29, v29
    s_movk_i32 s86, 30000
WL_adaLN_cond__sliding_local_dilated__glu_gated_reglu__prompt_kernel_142:
    ds_read_b32 v30, v28
    s_waitcnt lgkmcnt(0)
    v_cmp_gt_u32 vcc, 2, v30
    s_cbranch_vccz WD_adaLN_cond__sliding_local_dilated__glu_gated_reglu__prompt_kernel_143
    s_sleep 1
    s_sub_u32 s86, s86, 1
    s_cmp_lg_u32 s86, 0
    s_cbranch_scc1 WL_adaLN_cond__sliding_local_dilated__glu_gated_reglu__prompt_kernel_142
WD_adaLN_cond__sliding_local_dilated__glu_gated_reglu__prompt_kernel_143:
    v_mov_b32 v31, 162816
    ds_read_b32 v31, v31
    s_mul_i32 s80, s66, 1536
    s_add_u32 s80, s80, s0
    s_add_u32 s80, s80, 98304
    s_add_u32 s81, s80, 49152
    s_add_u32 m0, s84, 24576
    s_nop 0
    buffer_load_dwordx4 v12, s[36:39], s80 offen lds
    s_add_u32 m0, s84, 27648
    s_nop 0
    buffer_load_dwordx4 v13, s[36:39], s80 offen lds
    s_add_u32 m0, s84, 30720
    s_nop 0
    buffer_load_dwordx4 v12, s[36:39], s81 offen lds
    s_add_u32 m0, s84, 33792
    s_nop 0
    buffer_load_dwordx4 v13, s[36:39], s81 offen lds
    s_waitcnt lgkmcnt(0)
    v_readfirstlane_b32 s77, v31
    s_waitcnt vmcnt(8)
    ds_inc_u32 v29, v29
    s_movk_i32 s86, 30000
WL_adaLN_cond__sliding_local_dilated__glu_gated_reglu__prompt_kernel_144:
    ds_read_b32 v30, v28
    s_waitcnt lgkmcnt(0)
    v_cmp_gt_u32 vcc, 3, v30
    s_cbranch_vccz WD_adaLN_cond__sliding_local_dilated__glu_gated_reglu__prompt_kernel_145
    s_sleep 1
    s_sub_u32 s86, s86, 1
    s_cmp_lg_u32 s86, 0
    s_cbranch_scc1 WL_adaLN_cond__sliding_local_dilated__glu_gated_reglu__prompt_kernel_144
WD_adaLN_cond__sliding_local_dilated__glu_gated_reglu__prompt_kernel_145:
    s_mul_i32 s80, s66, 1536
    s_add_u32 s80, s80, s1
    s_add_u32 s81, s80, 49152
    s_add_u32 m0, s84, 36864
    s_nop 0
    buffer_load_dwordx4 v12, s[36:39], s80 offen lds
    s_add_u32 m0, s84, 39936
    s_nop 0
    buffer_load_dwordx4 v13, s[36:39], s80 offen lds
    s_add_u32 m0, s84, 43008
    s_nop 0
    buffer_load_dwordx4 v12, s[36:39], s81 offen lds
    s_add_u32 m0, s84, 46080
    s_nop 0
    buffer_load_dwordx4 v13, s[36:39], s81 offen lds
    s_waitcnt vmcnt(8)
    ds_inc_u32 v29, v29
    s_movk_i32 s86, 30000
WL_adaLN_cond__sliding_local_dilated__glu_gated_reglu__prompt_kernel_146:
    ds_read_b32 v30, v28
    s_waitcnt lgkmcnt(0)
    v_cmp_gt_u32 vcc, 4, v30
    s_cbranch_vccz WD_adaLN_cond__sliding_local_dilated__glu_gated_reglu__prompt_kernel_147
    s_sleep 1
    s_sub_u32 s86, s86, 1
    s_cmp_lg_u32 s86, 0
    s_cbranch_scc1 WL_adaLN_cond__sliding_local_dilated__glu_gated_reglu__prompt_kernel_146
WD_adaLN_cond__sliding_local_dilated__glu_gated_reglu__prompt_kernel_147:
    s_mul_i32 s80, s66, 1536
    s_add_u32 s80, s80, s1
    s_add_u32 s80, s80, 98304
    s_add_u32 s81, s80, 49152
    s_add_u32 m0, s84, 49152
    s_nop 0
    buffer_load_dwordx4 v12, s[36:39], s80 offen lds
    s_add_u32 m0, s84, 52224
    s_nop 0
    buffer_load_dwordx4 v13, s[36:39], s80 offen lds
    s_add_u32 m0, s84, 55296
    s_nop 0
    buffer_load_dwordx4 v12, s[36:39], s81 offen lds
    s_add_u32 m0, s84, 58368
    s_nop 0
    buffer_load_dwordx4 v13, s[36:39], s81 offen lds
    s_waitcnt vmcnt(8)
    ds_inc_u32 v29, v29
    s_movk_i32 s86, 30000
WL_adaLN_cond__sliding_local_dilated__glu_gated_reglu__prompt_kernel_148:
    ds_read_b32 v30, v28
    s_waitcnt lgkmcnt(0)
    v_cmp_gt_u32 vcc, 5, v30
    s_cbranch_vccz WD_adaLN_cond__sliding_local_dilated__glu_gated_reglu__prompt_kernel_149
    s_sleep 1
    s_sub_u32 s86, s86, 1
    s_cmp_lg_u32 s86, 0
    s_cbranch_scc1 WL_adaLN_cond__sliding_local_dilated__glu_gated_reglu__prompt_kernel_148
WD_adaLN_cond__sliding_local_dilated__glu_gated_reglu__prompt_kernel_149:
    s_mul_i32 s80, s67, 1536
    s_add_u32 s80, s80, s0
    s_add_u32 s81, s80, 49152
    s_add_u32 m0, s84, 61440
    s_nop 0
    buffer_load_dwordx4 v12, s[36:39], s80 offen lds
    s_add_u32 m0, s84, 64512
    s_nop 0
    buffer_load_dwordx4 v13, s[36:39], s80 offen lds
    s_add_u32 m0, s84, 67584
    s_nop 0
    buffer_load_dwordx4 v12, s[36:39], s81 offen lds
    s_add_u32 m0, s84, 70656
    s_nop 0
    buffer_load_dwordx4 v13, s[36:39], s81 offen lds
    s_waitcnt vmcnt(8)
    ds_inc_u32 v29, v29
    s_movk_i32 s86, 30000
WL_adaLN_cond__sliding_local_dilated__glu_gated_reglu__prompt_kernel_150:
    ds_read_b32 v30, v28
    s_waitcnt lgkmcnt(0)
    v_cmp_gt_u32 vcc, 6, v30
    s_cbranch_vccz WD_adaLN_cond__sliding_local_dilated__glu_gated_reglu__prompt_kernel_151
    s_sleep 1
    s_sub_u32 s86, s86, 1
    s_cmp_lg_u32 s86, 0
    s_cbranch_scc1 WL_adaLN_cond__sliding_local_dilated__glu_gated_reglu__prompt_kernel_150
WD_adaLN_cond__sliding_local_dilated__glu_gated_reglu__prompt_kernel_151:
    s_mul_i32 s80, s67, 1536
    s_add_u32 s80, s80, s0
    s_add_u32 s80, s80, 98304
    s_add_u32 s81, s80, 49152
    s_add_u32 m0, s84, 73728
    s_nop 0
    buffer_load_dwordx4 v12, s[36:39], s80 offen lds
    s_add_u32 m0, s84, 76800
    s_nop 0
    buffer_load_dwordx4 v13, s[36:39], s80 offen lds
    s_add_u32 m0, s84, 79872
    s_nop 0
    buffer_load_dwordx4 v12, s[36:39], s81 offen lds
    s_add_u32 m0, s84, 82944
    s_nop 0
    buffer_load_dwordx4 v13, s[36:39], s81 offen lds
    s_waitcnt vmcnt(8)
    ds_inc_u32 v29, v29
    s_movk_i32 s86, 30000
WL_adaLN_cond__sliding_local_dilated__glu_gated_reglu__prompt_kernel_152:
    ds_read_b32 v30, v28
    s_waitcnt lgkmcnt(0)
    v_cmp_gt_u32 vcc, 7, v30
    s_cbranch_vccz WD_adaLN_cond__sliding_local_dilated__glu_gated_reglu__prompt_kernel_153
    s_sleep 1
    s_sub_u32 s86, s86, 1
    s_cmp_lg_u32 s86, 0
    s_cbranch_scc1 WL_adaLN_cond__sliding_local_dilated__glu_gated_reglu__prompt_kernel_152
WD_adaLN_cond__sliding_local_dilated__glu_gated_reglu__prompt_kernel_153:
    s_mul_i32 s80, s67, 1536
    s_add_u32 s80, s80, s1
    s_add_u32 s81, s80, 49152
    s_add_u32 m0, s84, 86016
    s_nop 0
    buffer_load_dwordx4 v12, s[36:39], s80 offen lds
    s_add_u32 m0, s84, 89088
    s_nop 0
    buffer_load_dwordx4 v13, s[36:39], s80 offen lds
    s_add_u32 m0, s84, 92160
    s_nop 0
    buffer_load_dwordx4 v12, s[36:39], s81 offen lds
    s_add_u32 m0, s84, 95232
    s_nop 0
    buffer_load_dwordx4 v13, s[36:39], s81 offen lds
    s_waitcnt vmcnt(8)
    ds_inc_u32 v29, v29
    s_movk_i32 s86, 30000
WL_adaLN_cond__sliding_local_dilated__glu_gated_reglu__prompt_kernel_154:
    ds_read_b32 v30, v28
    s_waitcnt lgkmcnt(0)
    v_cmp_gt_u32 vcc, 9, v30
    s_cbranch_vccz WD_adaLN_cond__sliding_local_dilated__glu_gated_reglu__prompt_kernel_155
    s_sleep 1
    s_sub_u32 s86, s86, 1
    s_cmp_lg_u32 s86, 0
    s_cbranch_scc1 WL_adaLN_cond__sliding_local_dilated__glu_gated_reglu__prompt_kernel_154
WD_adaLN_cond__sliding_local_dilated__glu_gated_reglu__prompt_kernel_155:
    s_mul_i32 s80, s67, 1536
    s_add_u32 s80, s80, s1
    s_add_u32 s80, s80, 98304
    s_add_u32 s81, s80, 49152
    s_add_u32 m0, s84, 98304
    s_nop 0
    buffer_load_dwordx4 v12, s[36:39], s80 offen lds
    s_add_u32 m0, s84, 101376
    s_nop 0
    buffer_load_dwordx4 v13, s[36:39], s80 offen lds
    s_add_u32 m0, s84, 104448
    s_nop 0
    buffer_load_dwordx4 v12, s[36:39], s81 offen lds
    s_add_u32 m0, s84, 107520
    s_nop 0
    buffer_load_dwordx4 v13, s[36:39], s81 offen lds
    s_lshr_b32 s80, s4, 1
    s_lshl_b32 s80, s80, 5
    s_add_u32 s80, s80, s5
    s_and_b32 s81, s4, 1
    v_min_u32 v8, 55, v15
    s_cmp_eq_u32 s3, 6
    s_cbranch_scc1 TCH_adaLN_cond__sliding_local_dilated__glu_gated_reglu__prompt_kernel_156
    v_mul_u32_u24 v9, 37, v8
    v_lshrrev_b32 v9, 9, v9
    v_mul_u32_u24 v9, 1792, v9
    v_lshl_add_u32 v9, v8, 7, v9
    s_mul_i32 s82, s80, 14336
    s_mul_i32 s83, s81, 1792
    s_add_u32 s82, s82, s83
    buffer_load_dword v16, v9, s[44:47], s82 offen
    s_branch TCH_adaLN_cond__sliding_local_dilated__glu_gated_reglu__prompt_kernel_157
TCH_adaLN_cond__sliding_local_dilated__glu_gated_reglu__prompt_kernel_156:
    v_lshrrev_b32 v9, 2, v8
    v_and_b32 v8, 3, v8
    v_lshlrev_b32 v8, 7, v8
    v_lshl_add_u32 v8, v9, 10, v8
    v_and_b32 v9, 0xfff, v8
    s_lshl_b32 s81, s81, 9
    s_lshl_b32 s83, s80, 12
    s_add_u32 s83, s83, s81
    buffer_load_dword v18, v9, s[40:43], s83 offen
    s_mul_i32 s82, s80, 14336
    s_add_u32 s82, s82, s81
TCH_adaLN_cond__sliding_local_dilated__glu_gated_reglu__prompt_kernel_157:
    s_waitcnt vmcnt(9)
    ds_inc_u32 v29, v29
    s_sub_u32 s80, s7, 7
    s_cselect_b32 s80, s7, s80
    s_lshl_b32 s32, s80, 18
    s_add_u32 s80, s80, 1
    s_cmp_eq_u32 s80, 7
    s_cselect_b32 s80, 0, s80
    s_lshl_b32 s33, s80, 18
    s_add_u32 s80, s80, 1
    s_cmp_eq_u32 s80, 7
    s_cselect_b32 s80, 0, s80
    s_lshl_b32 s34, s80, 18
    s_add_u32 s80, s80, 1
    s_cmp_eq_u32 s80, 7
    s_cselect_b32 s80, 0, s80
    s_lshl_b32 s35, s80, 18
    s_add_u32 s80, s80, 1
    s_cmp_eq_u32 s80, 7
    s_cselect_b32 s80, 0, s80
    s_lshl_b32 s36, s80, 18
    s_add_u32 s80, s80, 1
    s_cmp_eq_u32 s80, 7
    s_cselect_b32 s80, 0, s80
    s_lshl_b32 s37, s80, 18
    s_add_u32 s80, s80, 1
    s_cmp_eq_u32 s80, 7
    s_cselect_b32 s80, 0, s80
    s_lshl_b32 s38, s80, 18
    s_cmp_eq_u32 s79, 7
    s_cselect_b32 s39, 0, s7
    s_movk_i32 s86, 30000
WL_adaLN_cond__sliding_local_dilated__glu_gated_reglu__prompt_kernel_158:
    ds_read_b32 v30, v28
    s_waitcnt lgkmcnt(0)
    v_cmp_gt_u32 vcc, 10, v30
    s_cbranch_vccz WD_adaLN_cond__sliding_local_dilated__glu_gated_reglu__prompt_kernel_159
    s_sleep 1
    s_sub_u32 s86, s86, 1
    s_cmp_lg_u32 s86, 0
    s_cbranch_scc1 WL_adaLN_cond__sliding_local_dilated__glu_gated_reglu__prompt_kernel_158
WD_adaLN_cond__sliding_local_dilated__glu_gated_reglu__prompt_kernel_159:
    s_add_u32 m0, s84, 0
    s_lshl_b32 s80, s64, 8
    buffer_load_dwordx4 v1, s[40:43], s80 offen lds
    s_add_u32 m0, s84, 4096
    s_lshl_b32 s80, s64, 8
    s_add_u32 s80, s80, 32768
    buffer_load_dwordx4 v1, s[40:43], s80 offen lds
    s_add_u32 m0, s84, 8192
    s_lshl_b32 s80, s65, 8
    buffer_load_dwordx4 v1, s[40:43], s80 offen lds
    s_waitcnt vmcnt(8)
    ds_inc_u32 v29, v29
    s_movk_i32 s86, 30000
WL_adaLN_cond__sliding_local_dilated__glu_gated_reglu__prompt_kernel_160:
    ds_read_b32 v30, v28
    s_waitcnt lgkmcnt(0)
    v_cmp_gt_u32 vcc, 11, v30
    s_cbranch_vccz WD_adaLN_cond__sliding_local_dilated__glu_gated_reglu__prompt_kernel_161
    s_sleep 1
    s_sub_u32 s86, s86, 1
    s_cmp_lg_u32 s86, 0
    s_cbranch_scc1 WL_adaLN_cond__sliding_local_dilated__glu_gated_reglu__prompt_kernel_160
WD_adaLN_cond__sliding_local_dilated__glu_gated_reglu__prompt_kernel_161:
    s_add_u32 m0, s84, 12288
    s_lshl_b32 s80, s65, 8
    s_add_u32 s80, s80, 32768
    buffer_load_dwordx4 v1, s[40:43], s80 offen lds
    s_add_u32 m0, s84, 16384
    s_lshl_b32 s80, s66, 8
    buffer_load_dwordx4 v1, s[40:43], s80 offen lds
    s_add_u32 m0, s84, 20480
    s_lshl_b32 s80, s66, 8
    s_add_u32 s80, s80, 32768
    buffer_load_dwordx4 v1, s[40:43], s80 offen lds
    s_waitcnt vmcnt(7)
    ds_inc_u32 v29, v29
    s_movk_i32 s86, 30000
WL_adaLN_cond__sliding_local_dilated__glu_gated_reglu__prompt_kernel_162:
    ds_read_b32 v30, v28
    s_waitcnt lgkmcnt(0)
    v_cmp_gt_u32 vcc, 12, v30
    s_cbranch_vccz WD_adaLN_cond__sliding_local_dilated__glu_gated_reglu__prompt_kernel_163
    s_sleep 1
    s_sub_u32 s86, s86, 1
    s_cmp_lg_u32 s86, 0
    s_cbranch_scc1 WL_adaLN_cond__sliding_local_dilated__glu_gated_reglu__prompt_kernel_162
WD_adaLN_cond__sliding_local_dilated__glu_gated_reglu__prompt_kernel_163:
    s_add_u32 m0, s84, 24576
    s_lshl_b32 s80, s67, 8
    buffer_load_dwordx4 v1, s[40:43], s80 offen lds
    s_add_u32 m0, s84, 28672
    s_lshl_b32 s80, s67, 8
    s_add_u32 s80, s80, 32768
    buffer_load_dwordx4 v1, s[40:43], s80 offen lds
    s_add_u32 m0, s84, 32768
    s_lshl_b32 s80, s64, 8
    s_add_u32 s80, s80, 262144
    buffer_load_dwordx4 v1, s[40:43], s80 offen lds
    s_movk_i32 s86, 30000
WL_adaLN_cond__sliding_local_dilated__glu_gated_reglu__prompt_kernel_164:
    ds_read_b32 v30, v28
    s_waitcnt lgkmcnt(0)
    v_cmp_gt_u32 vcc, 14, v30
    s_cbranch_vccz WD_adaLN_cond__sliding_local_dilated__glu_gated_reglu__prompt_kernel_165
    s_sleep 1
    s_sub_u32 s86, s86, 1
    s_cmp_lg_u32 s86, 0
    s_cbranch_scc1 WL_adaLN_cond__sliding_local_dilated__glu_gated_reglu__prompt_kernel_164
WD_adaLN_cond__sliding_local_dilated__glu_gated_reglu__prompt_kernel_165:
    s_add_u32 m0, s84, 36864
    s_lshl_b32 s80, s64, 8
    s_add_u32 s80, s80, 294912
    buffer_load_dwordx4 v1, s[40:43], s80 offen lds
    s_add_u32 m0, s84, 40960
    s_lshl_b32 s80, s65, 8
    s_add_u32 s80, s80, 262144
    buffer_load_dwordx4 v1, s[40:43], s80 offen lds
    s_add_u32 m0, s84, 45056
    s_lshl_b32 s80, s65, 8
    s_add_u32 s80, s80, 294912
    buffer_load_dwordx4 v1, s[40:43], s80 offen lds
    s_movk_i32 s86, 30000
WL_adaLN_cond__sliding_local_dilated__glu_gated_reglu__prompt_kernel_166:
    ds_read_b32 v30, v28
    s_waitcnt lgkmcnt(0)
    v_cmp_gt_u32 vcc, 15, v30
    s_cbranch_vccz WD_adaLN_cond__sliding_local_dilated__glu_gated_reglu__prompt_kernel_167
    s_sleep 1
    s_sub_u32 s86, s86, 1
    s_cmp_lg_u32 s86, 0
    s_cbranch_scc1 WL_adaLN_cond__sliding_local_dilated__glu_gated_reglu__prompt_kernel_166
WD_adaLN_cond__sliding_local_dilated__glu_gated_reglu__prompt_kernel_167:
    s_add_u32 m0, s84, 49152
    s_lshl_b32 s80, s66, 8
    s_add_u32 s80, s80, 262144
    buffer_load_dwordx4 v1, s[40:43], s80 offen lds
    s_add_u32 m0, s84, 53248
    s_lshl_b32 s80, s66, 8
    s_add_u32 s80, s80, 294912
    buffer_load_dwordx4 v1, s[40:43], s80 offen lds
    s_add_u32 m0, s84, 57344
    s_lshl_b32 s80, s67, 8
    s_add_u32 s80, s80, 262144
    buffer_load_dwordx4 v1, s[40:43], s80 offen lds
    s_movk_i32 s86, 30000
WL_adaLN_cond__sliding_local_dilated__glu_gated_reglu__prompt_kernel_168:
    ds_read_b32 v30, v28
    s_waitcnt lgkmcnt(0)
    v_cmp_gt_u32 vcc, 16, v30
    s_cbranch_vccz WD_adaLN_cond__sliding_local_dilated__glu_gated_reglu__prompt_kernel_169
    s_sleep 1
    s_sub_u32 s86, s86, 1
    s_cmp_lg_u32 s86, 0
    s_cbranch_scc1 WL_adaLN_cond__sliding_local_dilated__glu_gated_reglu__prompt_kernel_168
WD_adaLN_cond__sliding_local_dilated__glu_gated_reglu__prompt_kernel_169:
    s_add_u32 m0, s84, 61440
    s_lshl_b32 s80, s67, 8
    s_add_u32 s80, s80, 294912
    buffer_load_dwordx4 v1, s[40:43], s80 offen lds
HMERGE:
    s_nop 7
    s_nop 7
    s_lshl_b32 s83, s89, 13
    s_add_u32 s83, s83, 0xa4000
    v_lshrrev_b32 v8, 1, v15
    v_and_b32 v9, 1, v15
    v_lshlrev_b32 v8, 7, v8
    v_lshl_add_u32 v8, v9, 4, v8
    v_add_u32 v9, 0x1000, v8
    s_lshl_b32 s80, s75, 10
    v_and_b32 v10, 0x3ff, v8
    v_add_u32 v10, s80, v10
    s_cmp_eq_u32 s79, 7
    s_cselect_b64 vcc, -1, 0
    v_cndmask_b32 v8, v10, v8, vcc
    v_cndmask_b32 v9, v10, v9, vcc
    buffer_load_dwordx4 v[16:19], v8, s[68:71], s83 offen sc1
    buffer_load_dwordx4 v[20:23], v9, s[68:71], s83 offen sc1
    s_add_u32 s85, s39, 4
    s_and_b32 s85, s85, 7
    s_mul_i32 s85, s85, 229376
    s_add_u32 s80, s85, 0
    buffer_load_dwordx4 v[32:35], v2, s[44:47], s80 offen
    s_add_u32 s80, s85, 57344
    buffer_load_dwordx4 v[36:39], v2, s[44:47], s80 offen
    s_add_u32 s80, s85, 114688
    buffer_load_dwordx4 v[40:43], v2, s[44:47], s80 offen
    s_add_u32 s80, s85, 172032
    buffer_load_dwordx4 v[44:47], v2, s[44:47], s80 offen
    s_add_u32 s85, s39, 5
    s_and_b32 s85, s85, 7
    s_mul_i32 s85, s85, 229376
    s_add_u32 s80, s85, 0
    buffer_load_dwordx4 v[48:51], v2, s[44:47], s80 offen
    s_add_u32 s80, s85, 57344
    buffer_load_dwordx4 v[52:55], v2, s[44:47], s80 offen
    s_add_u32 s80, s85, 114688
    buffer_load_dwordx4 v[56:59], v2, s[44:47], s80 offen
    s_add_u32 s80, s85, 172032
    buffer_load_dwordx4 v[60:63], v2, s[44:47], s80 offen
    s_waitcnt vmcnt(10)
    ds_inc_u32 v29, v29
    v_lshlrev_b32 v10, 3, v15
    v_add_u32 v10, s84, v10
    v_add_u32 v10, 155648, v10
    s_waitcnt vmcnt(8)
    s_movk_i32 s86, 3000
    s_branch PCHK_adaLN_cond__sliding_local_dilated__glu_gated_reglu__prompt_kernel_172
POLL_adaLN_cond__sliding_local_dilated__glu_gated_reglu__prompt_kernel_170:
    buffer_load_dwordx4 v[16:19], v8, s[68:71], s83 offen sc1
    buffer_load_dwordx4 v[20:23], v9, s[68:71], s83 offen sc1
    s_waitcnt vmcnt(0)
PCHK_adaLN_cond__sliding_local_dilated__glu_gated_reglu__prompt_kernel_172:
    v_xor_b32 v11, s77, v17
    v_xor_b32 v19, s77, v19
    v_xor_b32 v21, s77, v21
    v_xor_b32 v23, s77, v23
    v_or3_b32 v11, v11, v19, v21
    v_or_b32 v11, v11, v23
    v_cmp_ne_u32 vcc, 0, v11
    s_cbranch_vccz PDONE_adaLN_cond__sliding_local_dilated__glu_gated_reglu__prompt_kernel_171
    s_mov_b64 exec, vcc
    s_sub_u32 s86, s86, 1
    s_cmp_lg_u32 s86, 0
    s_cbranch_scc1 POLL_adaLN_cond__sliding_local_dilated__glu_gated_reglu__prompt_kernel_170
PDONE_adaLN_cond__sliding_local_dilated__glu_gated_reglu__prompt_kernel_171:
    s_mov_b64 exec, -1
    v_mov_b32 v17, v18
    v_mov_b32 v21, v22
    ds_write_b64 v10, v[16:17]
    ds_write_b64 v10, v[20:21] offset:512
    v_mov_b32 v10, 151552
    v_mov_b32 v24, 0
    v_mov_b32 v25, 0
    v_mov_b32 v26, 0
    v_mov_b32 v27, 0
    ds_write_b128 v10, v[24:27]
    ds_inc_u32 v29, v29
    s_movk_i32 s86, 30000
WL_adaLN_cond__sliding_local_dilated__glu_gated_reglu__prompt_kernel_173:
    ds_read_b32 v30, v28
    s_waitcnt lgkmcnt(0)
    v_cmp_gt_u32 vcc, 19, v30
    s_cbranch_vccz WD_adaLN_cond__sliding_local_dilated__glu_gated_reglu__prompt_kernel_174
    s_sleep 1
    s_sub_u32 s86, s86, 1
    s_cmp_lg_u32 s86, 0
    s_cbranch_scc1 WL_adaLN_cond__sliding_local_dilated__glu_gated_reglu__prompt_kernel_173
WD_adaLN_cond__sliding_local_dilated__glu_gated_reglu__prompt_kernel_174:
    s_add_u32 m0, s84, 65536
    s_add_u32 s85, s39, 0
    s_and_b32 s85, s85, 7
    s_mul_i32 s85, s85, 229376
    s_add_u32 s80, s85, 0
    buffer_load_dwordx4 v2, s[44:47], s80 offen lds
    s_add_u32 m0, s84, 69632
    s_add_u32 s80, s85, 57344
    buffer_load_dwordx4 v2, s[44:47], s80 offen lds
    s_add_u32 m0, s84, 73728
    s_add_u32 s80, s85, 114688
    buffer_load_dwordx4 v2, s[44:47], s80 offen lds
    s_add_u32 m0, s84, 77824
    s_add_u32 s80, s85, 172032
    buffer_load_dwordx4 v2, s[44:47], s80 offen lds
    s_add_u32 m0, s84, 81920
    s_add_u32 s85, s39, 1
    s_and_b32 s85, s85, 7
    s_mul_i32 s85, s85, 229376
    s_add_u32 s80, s85, 0
    buffer_load_dwordx4 v2, s[44:47], s80 offen lds
    s_add_u32 m0, s84, 86016
    s_add_u32 s80, s85, 57344
    buffer_load_dwordx4 v2, s[44:47], s80 offen lds
    s_add_u32 m0, s84, 90112
    s_add_u32 s80, s85, 114688
    buffer_load_dwordx4 v2, s[44:47], s80 offen lds
    s_add_u32 m0, s84, 94208
    s_add_u32 s80, s85, 172032
    buffer_load_dwordx4 v2, s[44:47], s80 offen lds
    s_add_u32 m0, s84, 98304
    s_add_u32 s85, s39, 2
    s_and_b32 s85, s85, 7
    s_mul_i32 s85, s85, 229376
    s_add_u32 s80, s85, 0
    buffer_load_dwordx4 v2, s[44:47], s80 offen lds
    s_add_u32 m0, s84, 102400
    s_add_u32 s80, s85, 57344
    buffer_load_dwordx4 v2, s[44:47], s80 offen lds
    s_add_u32 m0, s84, 106496
    s_add_u32 s80, s85, 114688
    buffer_load_dwordx4 v2, s[44:47], s80 offen lds
    s_add_u32 m0, s84, 110592
    s_add_u32 s80, s85, 172032
    buffer_load_dwordx4 v2, s[44:47], s80 offen lds
    s_add_u32 m0, s84, 114688
    s_add_u32 s85, s39, 3
    s_and_b32 s85, s85, 7
    s_mul_i32 s85, s85, 229376
    s_add_u32 s80, s85, 0
    buffer_load_dwordx4 v2, s[44:47], s80 offen lds
    s_add_u32 m0, s84, 118784
    s_add_u32 s80, s85, 57344
    buffer_load_dwordx4 v2, s[44:47], s80 offen lds
    s_add_u32 m0, s84, 122880
    s_add_u32 s80, s85, 114688
    buffer_load_dwordx4 v2, s[44:47], s80 offen lds
    s_add_u32 m0, s84, 126976
    s_add_u32 s80, s85, 172032
    buffer_load_dwordx4 v2, s[44:47], s80 offen lds
    s_cmp_lg_u32 s3, 6
    s_cbranch_scc1 ONLY_adaLN_cond__sliding_local_dilated__glu_gated_reglu__prompt_kernel_175
    s_add_u32 s80, s95, 0
    v_mov_b32 v31, s77
    s_movk_i32 s86, 30000
WL_adaLN_cond__sliding_local_dilated__glu_gated_reglu__prompt_kernel_176:
    ds_read_b32 v30, v28
    s_waitcnt lgkmcnt(0)
    v_cmp_gt_u32 vcc, 20, v30
    s_cbranch_vccz WD_adaLN_cond__sliding_local_dilated__glu_gated_reglu__prompt_kernel_177
    s_sub_u32 s86, s86, 1
    s_cmp_lg_u32 s86, 0
    s_cbranch_scc1 WL_adaLN_cond__sliding_local_dilated__glu_gated_reglu__prompt_kernel_176
WD_adaLN_cond__sliding_local_dilated__glu_gated_reglu__prompt_kernel_177:
    s_mov_b64 exec, 1
    buffer_store_dword v31, off, s[68:71], s80 sc1
    s_mov_b64 exec, -1
ONLY_adaLN_cond__sliding_local_dilated__glu_gated_reglu__prompt_kernel_175:
    s_nop 7
    s_nop 7
    s_movk_i32 s86, 30000
WL_adaLN_cond__sliding_local_dilated__glu_gated_reglu__prompt_kernel_178:
    ds_read_b32 v30, v28
    s_waitcnt lgkmcnt(0)
    v_cmp_gt_u32 vcc, 21, v30
    s_cbranch_vccz WD_adaLN_cond__sliding_local_dilated__glu_gated_reglu__prompt_kernel_179
    s_sleep 1
    s_sub_u32 s86, s86, 1
    s_cmp_lg_u32 s86, 0
    s_cbranch_scc1 WL_adaLN_cond__sliding_local_dilated__glu_gated_reglu__prompt_kernel_178
WD_adaLN_cond__sliding_local_dilated__glu_gated_reglu__prompt_kernel_179:
    s_waitcnt vmcnt(0)
    ds_inc_u32 v29, v29
    s_add_u32 s85, s39, 6
    s_and_b32 s85, s85, 7
    s_mul_i32 s85, s85, 229376
    s_add_u32 s80, s85, 0
    buffer_load_dwordx4 v[64:67], v2, s[44:47], s80 offen
    s_add_u32 s80, s85, 57344
    buffer_load_dwordx4 v[68:71], v2, s[44:47], s80 offen
    s_add_u32 s80, s85, 114688
    buffer_load_dwordx4 v[72:75], v2, s[44:47], s80 offen
    s_add_u32 s80, s85, 172032
    buffer_load_dwordx4 v[76:79], v2, s[44:47], s80 offen
    s_add_u32 s85, s39, 7
    s_and_b32 s85, s85, 7
    s_mul_i32 s85, s85, 229376
    s_add_u32 s80, s85, 0
    buffer_load_dwordx4 v[80:83], v2, s[44:47], s80 offen
    s_add_u32 s80, s85, 57344
    buffer_load_dwordx4 v[84:87], v2, s[44:47], s80 offen
    s_add_u32 s80, s85, 114688
    buffer_load_dwordx4 v[88:91], v2, s[44:47], s80 offen
    s_add_u32 s80, s85, 172032
    buffer_load_dwordx4 v[92:95], v2, s[44:47], s80 offen
    s_add_u32 s85, s39, 0
    s_and_b32 s85, s85, 7
    s_mul_i32 s85, s85, 229376
    s_add_u32 s80, s85, 128
    buffer_load_dwordx4 v[96:99], v2, s[48:51], s80 offen
    s_add_u32 s80, s85, 57472
    buffer_load_dwordx4 v[100:103], v2, s[48:51], s80 offen
    s_add_u32 s80, s85, 114816
    buffer_load_dwordx4 v[104:107], v2, s[48:51], s80 offen
    s_add_u32 s80, s85, 172160
    buffer_load_dwordx4 v[108:111], v2, s[48:51], s80 offen
    s_add_u32 s85, s39, 1
    s_and_b32 s85, s85, 7
    s_mul_i32 s85, s85, 229376
    s_add_u32 s80, s85, 128
    buffer_load_dwordx4 v[112:115], v2, s[48:51], s80 offen
    s_add_u32 s80, s85, 57472
    buffer_load_dwordx4 v[116:119], v2, s[48:51], s80 offen
    s_add_u32 s80, s85, 114816
    buffer_load_dwordx4 v[120:123], v2, s[48:51], s80 offen
    s_add_u32 s80, s85, 172160
    buffer_load_dwordx4 v[124:127], v2, s[48:51], s80 offen
    s_add_u32 s85, s39, 2
    s_and_b32 s85, s85, 7
    s_mul_i32 s85, s85, 229376
    s_add_u32 s80, s85, 128
    buffer_load_dwordx4 v[128:131], v2, s[48:51], s80 offen
    s_add_u32 s80, s85, 57472
    buffer_load_dwordx4 v[132:135], v2, s[48:51], s80 offen
    s_add_u32 s80, s85, 114816
    buffer_load_dwordx4 v[136:139], v2, s[48:51], s80 offen
    s_add_u32 s80, s85, 172160
    buffer_load_dwordx4 v[140:143], v2, s[48:51], s80 offen
    s_add_u32 s85, s39, 3
    s_and_b32 s85, s85, 7
    s_mul_i32 s85, s85, 229376
    s_add_u32 s80, s85, 128
    buffer_load_dwordx4 v[144:147], v2, s[48:51], s80 offen
    s_add_u32 s80, s85, 57472
    buffer_load_dwordx4 v[148:151], v2, s[48:51], s80 offen
    s_add_u32 s80, s85, 114816
    buffer_load_dwordx4 v[152:155], v2, s[48:51], s80 offen
    s_add_u32 s80, s85, 172160
    buffer_load_dwordx4 v[156:159], v2, s[48:51], s80 offen
    s_add_u32 s85, s39, 4
    s_and_b32 s85, s85, 7
    s_mul_i32 s85, s85, 229376
    s_add_u32 s80, s85, 128
    buffer_load_dwordx4 v[160:163], v2, s[48:51], s80 offen
    s_add_u32 s80, s85, 57472
    buffer_load_dwordx4 v[164:167], v2, s[48:51], s80 offen
    s_add_u32 s80, s85, 114816
    buffer_load_dwordx4 v[168:171], v2, s[48:51], s80 offen
    s_add_u32 s80, s85, 172160
    buffer_load_dwordx4 v[172:175], v2, s[48:51], s80 offen
    s_add_u32 s85, s39, 5
    s_and_b32 s85, s85, 7
    s_mul_i32 s85, s85, 229376
    s_add_u32 s80, s85, 128
    buffer_load_dwordx4 v[176:179], v2, s[48:51], s80 offen
    s_add_u32 s80, s85, 57472
    buffer_load_dwordx4 v[180:183], v2, s[48:51], s80 offen
    s_add_u32 s80, s85, 114816
    buffer_load_dwordx4 v[184:187], v2, s[48:51], s80 offen
    s_add_u32 s80, s85, 172160
    buffer_load_dwordx4 v[188:191], v2, s[48:51], s80 offen
    s_add_u32 s85, s39, 6
    s_and_b32 s85, s85, 7
    s_mul_i32 s85, s85, 229376
    s_add_u32 s80, s85, 128
    buffer_load_dwordx4 v[192:195], v2, s[48:51], s80 offen
    s_add_u32 s80, s85, 57472
    buffer_load_dwordx4 v[196:199], v2, s[48:51], s80 offen
    s_add_u32 s80, s85, 114816
    buffer_load_dwordx4 v[200:203], v2, s[48:51], s80 offen
    s_add_u32 s80, s85, 172160
    buffer_load_dwordx4 v[204:207], v2, s[48:51], s80 offen
    s_add_u32 s85, s39, 7
    s_and_b32 s85, s85, 7
    s_mul_i32 s85, s85, 229376
    s_add_u32 s80, s85, 128
    buffer_load_dwordx4 v[208:211], v2, s[48:51], s80 offen
    s_add_u32 s80, s85, 57472
    buffer_load_dwordx4 v[212:215], v2, s[48:51], s80 offen
    s_add_u32 s80, s85, 114816
    buffer_load_dwordx4 v[216:219], v2, s[48:51], s80 offen
    s_add_u32 s80, s85, 172160
    buffer_load_dwordx4 v[220:223], v2, s[48:51], s80 offen
    s_movk_i32 s86, 30000
WL_adaLN_cond__sliding_local_dilated__glu_gated_reglu__prompt_kernel_180:
    ds_read_b32 v30, v28
    s_waitcnt lgkmcnt(0)
    v_cmp_gt_u32 vcc, 22, v30
    s_cbranch_vccz WD_adaLN_cond__sliding_local_dilated__glu_gated_reglu__prompt_kernel_181
    s_sleep 1
    s_sub_u32 s86, s86, 1
    s_cmp_lg_u32 s86, 0
    s_cbranch_scc1 WL_adaLN_cond__sliding_local_dilated__glu_gated_reglu__prompt_kernel_180
WD_adaLN_cond__sliding_local_dilated__glu_gated_reglu__prompt_kernel_181:
    ds_write_b128 v4, v[32:35]
    ds_write_b128 v4, v[36:39] offset:4096
    ds_write_b128 v4, v[40:43] offset:8192
    ds_write_b128 v4, v[44:47] offset:12288
    ds_inc_u32 v29, v29
    ds_write_b128 v4, v[48:51] offset:16384
    ds_write_b128 v4, v[52:55] offset:20480
    ds_write_b128 v4, v[56:59] offset:24576
    ds_write_b128 v4, v[60:63] offset:28672
    ds_inc_u32 v29, v29
    s_waitcnt vmcnt(36)
    ds_write_b128 v4, v[64:67] offset:32768
    ds_write_b128 v4, v[68:71] offset:36864
    ds_write_b128 v4, v[72:75] offset:40960
    ds_write_b128 v4, v[76:79] offset:45056
    ds_inc_u32 v29, v29
    s_waitcnt vmcnt(32)
    ds_write_b128 v4, v[80:83] offset:49152
    ds_write_b128 v4, v[84:87] offset:53248
    ds_write_b128 v4, v[88:91] offset:57344
    ds_write_b128 v4, v[92:95] offset:61440
    ds_inc_u32 v29, v29
    s_cmp_lg_u32 s79, 7
    s_cbranch_scc1 UBH_adaLN_cond__sliding_local_dilated__glu_gated_reglu__prompt_kernel_182
    v_lshrrev_b32 v19, 5, v15
    v_bfe_u32 v20, v15, 4, 1
    v_bfe_u32 v21, v15, 2, 2
    v_bfe_u32 v22, v15, 1, 1
    v_and_b32 v16, 2, v21
    v_xor_b32 v22, v22, v16
    v_lshlrev_b32 v16, 2, v20
    v_xor_b32 v22, v22, v16
    v_lshlrev_b32 v16, 10, v20
    v_lshl_add_u32 v16, v21, 7, v16
    v_lshl_add_u32 v16, v19, 9, v16
    v_lshl_add_u32 v16, v22, 4, v16
    v_and_b32 v18, 1, v15
    v_lshl_add_u32 v16, v18, 3, v16
    s_lshl_b32 s80, s89, 5
    v_xor_b32 v16, s80, v16
    v_add_u32 v17, 0x10000, v16
    v_lshlrev_b32 v18, 10, v18
    v_sub_u32 v18, 157696, v18
    v_lshl_add_u32 v18, v19, 3, v18
    v_mov_b32 v240, 0
    v_mov_b32 v241, 0
    v_mov_b32 v242, 0
    v_mov_b32 v243, 0
    v_mov_b32 v244, 0
    v_mov_b32 v245, 0
    v_mov_b32 v246, 0
    v_mov_b32 v247, 0
    v_mov_b32 v248, 0
    v_mov_b32 v249, 0
    v_mov_b32 v250, 0
    v_mov_b32 v251, 0
    v_mov_b32 v252, 0
    v_mov_b32 v253, 0
    v_mov_b32 v254, 0
    v_mov_b32 v255, 0
    s_mov_b32 s81, 3
    s_movk_i32 s86, 30000
WL_adaLN_cond__sliding_local_dilated__glu_gated_reglu__prompt_kernel_184:
    ds_read_b32 v30, v28 offset:1024
    s_waitcnt lgkmcnt(0)
    v_cmp_gt_u32 vcc, 23, v30
    s_cbranch_vccz WD_adaLN_cond__sliding_local_dilated__glu_gated_reglu__prompt_kernel_185
    s_sub_u32 s86, s86, 1
    s_cmp_lg_u32 s86, 0
    s_cbranch_scc1 WL_adaLN_cond__sliding_local_dilated__glu_gated_reglu__prompt_kernel_184
WD_adaLN_cond__sliding_local_dilated__glu_gated_reglu__prompt_kernel_185:
UBL_adaLN_cond__sliding_local_dilated__glu_gated_reglu__prompt_kernel_183:
    ds_read_b64_tr_b16 v[32:33], v17
    ds_read_b64_tr_b16 v[34:35], v17 offset:2048
    ds_read2_b64 v[36:39], v18 offset0:0 offset1:2
    ds_read_b64_tr_b16 v[40:41], v17 offset:4096
    ds_read_b64_tr_b16 v[42:43], v17 offset:6144
    ds_read2_b64 v[44:47], v18 offset0:4 offset1:6
    ds_read_b64_tr_b16 v[48:49], v17 offset:8192
    ds_read_b64_tr_b16 v[50:51], v17 offset:10240
    ds_read2_b64 v[52:55], v18 offset0:8 offset1:10
    ds_read_b64_tr_b16 v[56:57], v17 offset:12288
    ds_read_b64_tr_b16 v[58:59], v17 offset:14336
    ds_read2_b64 v[60:63], v18 offset0:12 offset1:14
    ds_read_b64_tr_b16 v[64:65], v17 offset:16384
    ds_read_b64_tr_b16 v[66:67], v17 offset:18432
    ds_read2_b64 v[68:71], v18 offset0:16 offset1:18
    s_waitcnt lgkmcnt(12)
    v_mfma_f32_32x32x16_bf16 v[240:255], v[36:39], v[32:35], v[240:255]
    ds_read_b64_tr_b16 v[72:73], v17 offset:20480
    ds_read_b64_tr_b16 v[74:75], v17 offset:22528
    ds_read2_b64 v[76:79], v18 offset0:20 offset1:22
    s_waitcnt lgkmcnt(12)
    v_mfma_f32_32x32x16_bf16 v[240:255], v[44:47], v[40:43], v[240:255]
    ds_read_b64_tr_b16 v[80:81], v17 offset:24576
    ds_read_b64_tr_b16 v[82:83], v17 offset:26624
    ds_read2_b64 v[84:87], v18 offset0:24 offset1:26
    s_waitcnt lgkmcnt(12)
    v_mfma_f32_32x32x16_bf16 v[240:255], v[52:55], v[48:51], v[240:255]
    ds_read_b64_tr_b16 v[88:89], v17 offset:28672
    ds_read_b64_tr_b16 v[90:91], v17 offset:30720
    ds_read2_b64 v[92:95], v18 offset0:28 offset1:30
    s_waitcnt lgkmcnt(12)
    v_mfma_f32_32x32x16_bf16 v[240:255], v[60:63], v[56:59], v[240:255]
    s_waitcnt lgkmcnt(9)
    v_mfma_f32_32x32x16_bf16 v[240:255], v[68:71], v[64:67], v[240:255]
    v_add_u32 v17, 0x8000, v17
    v_and_b32 v17, 0x1ffff, v17
    v_add_u32 v18, 0x100, v18
    s_waitcnt lgkmcnt(6)
    v_mfma_f32_32x32x16_bf16 v[240:255], v[76:79], v[72:75], v[240:255]
    s_waitcnt lgkmcnt(3)
    v_mfma_f32_32x32x16_bf16 v[240:255], v[84:87], v[80:83], v[240:255]
    s_waitcnt lgkmcnt(0)
    v_mfma_f32_32x32x16_bf16 v[240:255], v[92:95], v[88:91], v[240:255]
    s_sub_u32 s81, s81, 1
    s_cbranch_scc0 UBL_adaLN_cond__sliding_local_dilated__glu_gated_reglu__prompt_kernel_183
    s_lshr_b32 s80, s73, 3
    s_lshl1_add_u32 s80, s72, s80
    s_cmp_ge_u32 s80, 28
    s_cbranch_scc1 UBH_adaLN_cond__sliding_local_dilated__glu_gated_reglu__prompt_kernel_182
    s_lshl_b32 s80, s80, 11
    s_lshl_b32 s81, s89, 9
    s_add_u32 s80, s80, s81
    s_add_u32 s80, s80, 0x10000
    s_nop 1
    v_mov_b32 v242, v241
    v_mov_b32 v241, s77
    v_mov_b32 v243, s77
    s_mov_b32 exec_hi, 0
    buffer_store_dwordx4 v[240:243], v14, s[68:71], s80 offen sc1
    s_mov_b32 exec_hi, -1
UBH_adaLN_cond__sliding_local_dilated__glu_gated_reglu__prompt_kernel_182:
    s_nop 7
    s_nop 7
    s_nop 7
    s_nop 7
    ds_inc_u32 v29, v29
    s_cmp_lg_u32 s3, 6
    s_cbranch_scc1 ONLY_adaLN_cond__sliding_local_dilated__glu_gated_reglu__prompt_kernel_186
    s_add_u32 s80, s95, 2048
    v_mov_b32 v31, s77
    s_movk_i32 s86, 30000
WL_adaLN_cond__sliding_local_dilated__glu_gated_reglu__prompt_kernel_187:
    ds_read_b32 v30, v28
    s_waitcnt lgkmcnt(0)
    v_cmp_gt_u32 vcc, 25, v30
    s_cbranch_vccz WD_adaLN_cond__sliding_local_dilated__glu_gated_reglu__prompt_kernel_188
    s_sub_u32 s86, s86, 1
    s_cmp_lg_u32 s86, 0
    s_cbranch_scc1 WL_adaLN_cond__sliding_local_dilated__glu_gated_reglu__prompt_kernel_187
WD_adaLN_cond__sliding_local_dilated__glu_gated_reglu__prompt_kernel_188:
    s_mov_b64 exec, 1
    buffer_store_dword v31, off, s[68:71], s80 sc1
    s_mov_b64 exec, -1
ONLY_adaLN_cond__sliding_local_dilated__glu_gated_reglu__prompt_kernel_186:
    s_nop 7
    s_nop 7
    v_lshrrev_b32 v10, 5, v15
    v_and_b32 v11, 31, v15
    v_lshlrev_b32 v12, 11, v10
    v_lshl_add_u32 v12, v11, 3, v12
    s_lshl_b32 s82, s72, 2
    s_add_u32 s82, s82, s89
    s_lshl_b32 s81, s82, 12
    s_add_u32 s81, s81, 0x20000
    s_min_u32 s83, s78, 13
    s_lshl_b32 s83, s83, 12
    s_add_u32 s83, s83, s84
    s_add_u32 s83, s83, 0x10000
    s_movk_i32 s86, 30000
WL_adaLN_cond__sliding_local_dilated__glu_gated_reglu__prompt_kernel_189:
    ds_read_b32 v30, v28
    s_waitcnt lgkmcnt(0)
    v_cmp_gt_u32 vcc, 27, v30
    s_cbranch_vccz WD_adaLN_cond__sliding_local_dilated__glu_gated_reglu__prompt_kernel_190
    s_sleep 1
    s_sub_u32 s86, s86, 1
    s_cmp_lg_u32 s86, 0
    s_cbranch_scc1 WL_adaLN_cond__sliding_local_dilated__glu_gated_reglu__prompt_kernel_189
WD_adaLN_cond__sliding_local_dilated__glu_gated_reglu__prompt_kernel_190:
    s_mov_b32 s94, s81
    buffer_load_dwordx2 v[224:225], v12, s[68:71], s94 offen sc1
    buffer_load_dwordx2 v[226:227], v12, s[68:71], s94 offen offset:256 sc1
    buffer_load_dwordx2 v[228:229], v12, s[68:71], s94 offen offset:512 sc1
    buffer_load_dwordx2 v[230:231], v12, s[68:71], s94 offen offset:768 sc1
    buffer_load_dwordx2 v[232:233], v12, s[68:71], s94 offen offset:1024 sc1
    buffer_load_dwordx2 v[234:235], v12, s[68:71], s94 offen offset:1280 sc1
    buffer_load_dwordx2 v[236:237], v12, s[68:71], s94 offen offset:1536 sc1
    buffer_load_dwordx2 v[238:239], v12, s[68:71], s94 offen offset:1792 sc1
    buffer_load_dwordx4 v[8:11], v14, s[68:71], s83 offen sc1
    s_waitcnt vmcnt(37)
    ds_write_b128 v5, v[96:99]
    ds_write_b128 v5, v[100:103] offset:4096
    ds_write_b128 v5, v[104:107] offset:8192
    ds_write_b128 v5, v[108:111] offset:12288
    ds_inc_u32 v29, v29
    s_movk_i32 s86, 30000
WL_adaLN_cond__sliding_local_dilated__glu_gated_reglu__prompt_kernel_191:
    ds_read_b32 v30, v28
    s_waitcnt lgkmcnt(0)
    v_cmp_gt_u32 vcc, 28, v30
    s_cbranch_vccz WD_adaLN_cond__sliding_local_dilated__glu_gated_reglu__prompt_kernel_192
    s_sleep 1
    s_sub_u32 s86, s86, 1
    s_cmp_lg_u32 s86, 0
    s_cbranch_scc1 WL_adaLN_cond__sliding_local_dilated__glu_gated_reglu__prompt_kernel_191
WD_adaLN_cond__sliding_local_dilated__glu_gated_reglu__prompt_kernel_192:
    s_waitcnt vmcnt(33)
    ds_write_b128 v5, v[112:115] offset:16384
    ds_write_b128 v5, v[116:119] offset:20480
    ds_write_b128 v5, v[120:123] offset:24576
    ds_write_b128 v5, v[124:127] offset:28672
    ds_inc_u32 v29, v29
    s_waitcnt vmcnt(1)
    v_add_f32 v224, v224, v232
    v_add_f32 v225, v225, v233
    v_add_f32 v226, v226, v234
    v_add_f32 v227, v227, v235
    v_add_f32 v228, v228, v236
    v_add_f32 v229, v229, v237
    v_add_f32 v230, v230, v238
    v_add_f32 v231, v231, v239
    v_add_f32 v224, v224, v228
    v_add_f32 v225, v225, v229
    v_add_f32 v226, v226, v230
    v_add_f32 v227, v227, v231
    v_add_f32 v224, v224, v226
    v_add_f32 v225, v225, v227
    v_mov_b32 v226, v224
    v_mov_b32 v227, v225
    s_nop 0
    v_permlane32_swap_b32 v224, v226
    v_permlane32_swap_b32 v225, v227
    v_add_f32 v224, v224, v226
    v_add_f32 v225, v225, v227
    v_mul_f32 v224, 0xbb000000, v224
    v_mul_f32 v225, 0x3b000000, v225
    v_fma_f32 v225, -v224, v224, v225
    v_max_f32 v225, 0, v225
    v_add_f32 v225, 0x3727c5ac, v225
    v_sqrt_f32 v226, v225
    v_rcp_f32 v227, v225
    v_cvt_pk_bf16_f32 v228, v224, v224
    v_and_b32 v228, 0xffff0000, v228
    v_sub_f32 v229, v224, v228
    v_cvt_pk_bf16_f32 v230, v226, v226
    v_and_b32 v230, 0xffff0000, v230
    v_sub_f32 v231, v226, v230
    v_cvt_pk_bf16_f32 v232, v228, v229
    v_cvt_pk_bf16_f32 v233, v228, v230
    v_cvt_pk_bf16_f32 v234, v231, v230
    v_mov_b32 v235, 0
    s_lshl_b32 s80, s89, 9
    s_add_u32 s80, s80, 153600
    v_add_u32 v12, s80, v14
    s_lshl_b32 s80, s89, 7
    s_add_u32 s80, s80, 152064
    v_lshlrev_b32 v13, 2, v15
    v_add_u32 v236, s80, v13
    s_mov_b32 exec_hi, 0
    ds_write_b128 v12, v[232:235]
    ds_write_b32 v236, v227
    s_mov_b32 exec_hi, -1
    s_waitcnt vmcnt(0)
    s_movk_i32 s86, 3000
    s_branch PCHK_adaLN_cond__sliding_local_dilated__glu_gated_reglu__prompt_kernel_195
POLL_adaLN_cond__sliding_local_dilated__glu_gated_reglu__prompt_kernel_193:
    buffer_load_dwordx4 v[8:11], v14, s[68:71], s83 offen sc1
    s_waitcnt vmcnt(0)
PCHK_adaLN_cond__sliding_local_dilated__glu_gated_reglu__prompt_kernel_195:
    v_xor_b32 v12, s77, v9
    v_xor_b32 v11, s77, v11
    v_or_b32 v12, v12, v11
    v_cmp_ne_u32 vcc, 0, v12
    s_cbranch_vccz PDONE_adaLN_cond__sliding_local_dilated__glu_gated_reglu__prompt_kernel_194
    s_mov_b64 exec, vcc
    s_sub_u32 s86, s86, 1
    s_cmp_lg_u32 s86, 0
    s_cbranch_scc1 POLL_adaLN_cond__sliding_local_dilated__glu_gated_reglu__prompt_kernel_193
PDONE_adaLN_cond__sliding_local_dilated__glu_gated_reglu__prompt_kernel_194:
    s_mov_b64 exec, -1
    v_cvt_pk_bf16_f32 v20, v8, v8
    v_and_b32 v20, 0xffff0000, v20
    v_sub_f32 v21, v8, v20
    v_cvt_pk_bf16_f32 v22, v10, v10
    v_and_b32 v22, 0xffff0000, v22
    v_sub_f32 v23, v10, v22
    v_cvt_pk_bf16_f32 v24, v20, v20
    v_cvt_pk_bf16_f32 v25, v21, v22
    v_cvt_pk_bf16_f32 v26, v22, v23
    v_mov_b32 v27, 0
    v_add_u32 v12, 147456, v4
    ds_write_b128 v12, v[24:27]
    ds_inc_u32 v29, v29
    s_movk_i32 s86, 30000
WL_adaLN_cond__sliding_local_dilated__glu_gated_reglu__prompt_kernel_196:
    ds_read_b32 v30, v28
    s_waitcnt lgkmcnt(0)
    v_cmp_gt_u32 vcc, 29, v30
    s_cbranch_vccz WD_adaLN_cond__sliding_local_dilated__glu_gated_reglu__prompt_kernel_197
    s_sleep 1
    s_sub_u32 s86, s86, 1
    s_cmp_lg_u32 s86, 0
    s_cbranch_scc1 WL_adaLN_cond__sliding_local_dilated__glu_gated_reglu__prompt_kernel_196
WD_adaLN_cond__sliding_local_dilated__glu_gated_reglu__prompt_kernel_197:
    ds_write_b128 v5, v[128:131] offset:32768
    ds_write_b128 v5, v[132:135] offset:36864
    ds_write_b128 v5, v[136:139] offset:40960
    ds_write_b128 v5, v[140:143] offset:45056
    ds_inc_u32 v29, v29
    s_add_u32 s80, s32, 0
    buffer_load_dwordx4 v[240:243], v1, s[52:55], s80 offen
    s_add_u32 s80, s32, 32768
    buffer_load_dwordx4 v[244:247], v1, s[52:55], s80 offen
    s_add_u32 s80, s32, 131072
    buffer_load_dwordx4 v[248:251], v1, s[52:55], s80 offen
    s_add_u32 s80, s32, 163840
    buffer_load_dwordx4 v[252:255], v1, s[52:55], s80 offen
    s_add_u32 s80, s33, 0
    buffer_load_dwordx4 v[32:35], v1, s[52:55], s80 offen
    s_add_u32 s80, s33, 32768
    buffer_load_dwordx4 v[36:39], v1, s[52:55], s80 offen
    s_add_u32 s80, s33, 131072
    buffer_load_dwordx4 v[40:43], v1, s[52:55], s80 offen
    s_add_u32 s80, s33, 163840
    buffer_load_dwordx4 v[44:47], v1, s[52:55], s80 offen
    s_movk_i32 s86, 30000
WL_adaLN_cond__sliding_local_dilated__glu_gated_reglu__prompt_kernel_198:
    ds_read_b32 v30, v28
    s_waitcnt lgkmcnt(0)
    v_cmp_gt_u32 vcc, 30, v30
    s_cbranch_vccz WD_adaLN_cond__sliding_local_dilated__glu_gated_reglu__prompt_kernel_199
    s_sleep 1
    s_sub_u32 s86, s86, 1
    s_cmp_lg_u32 s86, 0
    s_cbranch_scc1 WL_adaLN_cond__sliding_local_dilated__glu_gated_reglu__prompt_kernel_198
WD_adaLN_cond__sliding_local_dilated__glu_gated_reglu__prompt_kernel_199:
    ds_write_b128 v5, v[144:147] offset:49152
    ds_write_b128 v5, v[148:151] offset:53248
    ds_write_b128 v5, v[152:155] offset:57344
    ds_write_b128 v5, v[156:159] offset:61440
    ds_inc_u32 v29, v29
    s_add_u32 s80, s34, 0
    buffer_load_dwordx4 v[48:51], v1, s[52:55], s80 offen
    s_add_u32 s80, s34, 32768
    buffer_load_dwordx4 v[52:55], v1, s[52:55], s80 offen
    s_add_u32 s80, s34, 131072
    buffer_load_dwordx4 v[56:59], v1, s[52:55], s80 offen
    s_add_u32 s80, s34, 163840
    buffer_load_dwordx4 v[60:63], v1, s[52:55], s80 offen
    s_add_u32 s80, s35, 0
    buffer_load_dwordx4 v[64:67], v1, s[52:55], s80 offen
    s_add_u32 s80, s35, 32768
    buffer_load_dwordx4 v[68:71], v1, s[52:55], s80 offen
    s_add_u32 s80, s35, 131072
    buffer_load_dwordx4 v[72:75], v1, s[52:55], s80 offen
    s_add_u32 s80, s35, 163840
    buffer_load_dwordx4 v[76:79], v1, s[52:55], s80 offen
    s_movk_i32 s86, 30000
WL_adaLN_cond__sliding_local_dilated__glu_gated_reglu__prompt_kernel_200:
    ds_read_b32 v30, v28
    s_waitcnt lgkmcnt(0)
    v_cmp_gt_u32 vcc, 31, v30
    s_cbranch_vccz WD_adaLN_cond__sliding_local_dilated__glu_gated_reglu__prompt_kernel_201
    s_sleep 1
    s_sub_u32 s86, s86, 1
    s_cmp_lg_u32 s86, 0
    s_cbranch_scc1 WL_adaLN_cond__sliding_local_dilated__glu_gated_reglu__prompt_kernel_200
WD_adaLN_cond__sliding_local_dilated__glu_gated_reglu__prompt_kernel_201:
    ds_write_b128 v4, v[160:163]
    ds_write_b128 v4, v[164:167] offset:4096
    ds_write_b128 v4, v[168:171] offset:8192
    ds_write_b128 v4, v[172:175] offset:12288
    ds_inc_u32 v29, v29
    s_add_u32 s80, s36, 0
    buffer_load_dwordx4 v[80:83], v1, s[52:55], s80 offen
    s_add_u32 s80, s36, 32768
    buffer_load_dwordx4 v[84:87], v1, s[52:55], s80 offen
    s_add_u32 s80, s36, 131072
    buffer_load_dwordx4 v[88:91], v1, s[52:55], s80 offen
    s_add_u32 s80, s36, 163840
    buffer_load_dwordx4 v[92:95], v1, s[52:55], s80 offen
    s_add_u32 s80, s37, 0
    buffer_load_dwordx4 v[96:99], v1, s[52:55], s80 offen
    s_add_u32 s80, s37, 32768
    buffer_load_dwordx4 v[100:103], v1, s[52:55], s80 offen
    s_add_u32 s80, s37, 131072
    buffer_load_dwordx4 v[104:107], v1, s[52:55], s80 offen
    s_add_u32 s80, s37, 163840
    buffer_load_dwordx4 v[108:111], v1, s[52:55], s80 offen
    s_movk_i32 s86, 30000
WL_adaLN_cond__sliding_local_dilated__glu_gated_reglu__prompt_kernel_202:
    ds_read_b32 v30, v28
    s_waitcnt lgkmcnt(0)
    v_cmp_gt_u32 vcc, 32, v30
    s_cbranch_vccz WD_adaLN_cond__sliding_local_dilated__glu_gated_reglu__prompt_kernel_203
    s_sleep 1
    s_sub_u32 s86, s86, 1
    s_cmp_lg_u32 s86, 0
    s_cbranch_scc1 WL_adaLN_cond__sliding_local_dilated__glu_gated_reglu__prompt_kernel_202
WD_adaLN_cond__sliding_local_dilated__glu_gated_reglu__prompt_kernel_203:
    ds_write_b128 v4, v[176:179] offset:16384
    ds_write_b128 v4, v[180:183] offset:20480
    ds_write_b128 v4, v[184:187] offset:24576
    ds_write_b128 v4, v[188:191] offset:28672
    ds_inc_u32 v29, v29
    s_add_u32 s80, s38, 0
    buffer_load_dwordx4 v[112:115], v1, s[52:55], s80 offen
    s_add_u32 s80, s38, 32768
    buffer_load_dwordx4 v[116:119], v1, s[52:55], s80 offen
    s_add_u32 s80, s38, 131072
    buffer_load_dwordx4 v[120:123], v1, s[52:55], s80 offen
    s_add_u32 s80, s38, 163840
    buffer_load_dwordx4 v[124:127], v1, s[52:55], s80 offen
    s_add_u32 s80, s32, 65536
    buffer_load_dwordx4 v[224:227], v1, s[52:55], s80 offen
    s_add_u32 s80, s33, 65536
    buffer_load_dwordx4 v[228:231], v1, s[52:55], s80 offen
    s_add_u32 s80, s32, 196608
    buffer_load_dwordx4 v[232:235], v1, s[52:55], s80 offen
    s_add_u32 s80, s33, 196608
    buffer_load_dwordx4 v[236:239], v1, s[52:55], s80 offen
    s_movk_i32 s86, 30000
WL_adaLN_cond__sliding_local_dilated__glu_gated_reglu__prompt_kernel_204:
    ds_read_b32 v30, v28
    s_waitcnt lgkmcnt(0)
    v_cmp_gt_u32 vcc, 33, v30
    s_cbranch_vccz WD_adaLN_cond__sliding_local_dilated__glu_gated_reglu__prompt_kernel_205
    s_sleep 1
    s_sub_u32 s86, s86, 1
    s_cmp_lg_u32 s86, 0
    s_cbranch_scc1 WL_adaLN_cond__sliding_local_dilated__glu_gated_reglu__prompt_kernel_204
WD_adaLN_cond__sliding_local_dilated__glu_gated_reglu__prompt_kernel_205:
    ds_write_b128 v4, v[192:195] offset:32768
    ds_write_b128 v4, v[196:199] offset:36864
    ds_write_b128 v4, v[200:203] offset:40960
    ds_write_b128 v4, v[204:207] offset:45056
    ds_inc_u32 v29, v29
    s_add_u32 s80, s34, 65536
    buffer_load_dwordx4 v[128:131], v1, s[52:55], s80 offen
    s_add_u32 s80, s35, 65536
    buffer_load_dwordx4 v[132:135], v1, s[52:55], s80 offen
    s_add_u32 s80, s34, 196608
    buffer_load_dwordx4 v[136:139], v1, s[52:55], s80 offen
    s_add_u32 s80, s35, 196608
    buffer_load_dwordx4 v[140:143], v1, s[52:55], s80 offen
    s_add_u32 s80, s36, 65536
    buffer_load_dwordx4 v[144:147], v1, s[52:55], s80 offen
    s_add_u32 s80, s37, 65536
    buffer_load_dwordx4 v[148:151], v1, s[52:55], s80 offen
    s_add_u32 s80, s36, 196608
    buffer_load_dwordx4 v[152:155], v1, s[52:55], s80 offen
    s_add_u32 s80, s37, 196608
    buffer_load_dwordx4 v[156:159], v1, s[52:55], s80 offen
    s_movk_i32 s86, 30000
WL_adaLN_cond__sliding_local_dilated__glu_gated_reglu__prompt_kernel_206:
    ds_read_b32 v30, v28
    s_waitcnt lgkmcnt(0)
    v_cmp_gt_u32 vcc, 34, v30
    s_cbranch_vccz WD_adaLN_cond__sliding_local_dilated__glu_gated_reglu__prompt_kernel_207
    s_sleep 1
    s_sub_u32 s86, s86, 1
    s_cmp_lg_u32 s86, 0
    s_cbranch_scc1 WL_adaLN_cond__sliding_local_dilated__glu_gated_reglu__prompt_kernel_206
WD_adaLN_cond__sliding_local_dilated__glu_gated_reglu__prompt_kernel_207:
    ds_write_b128 v4, v[208:211] offset:49152
    ds_write_b128 v4, v[212:215] offset:53248
    ds_write_b128 v4, v[216:219] offset:57344
    ds_write_b128 v4, v[220:223] offset:61440
    ds_inc_u32 v29, v29
    s_add_u32 s80, s38, 65536
    buffer_load_dwordx4 v[160:163], v1, s[52:55], s80 offen
    s_add_u32 s80, s32, 98304
    buffer_load_dwordx4 v[164:167], v1, s[52:55], s80 offen
    s_add_u32 s80, s38, 196608
    buffer_load_dwordx4 v[168:171], v1, s[52:55], s80 offen
    s_add_u32 s80, s32, 229376
    buffer_load_dwordx4 v[172:175], v1, s[52:55], s80 offen
    s_add_u32 s80, s33, 98304
    buffer_load_dwordx4 v[176:179], v1, s[52:55], s80 offen
    s_add_u32 s80, s34, 98304
    buffer_load_dwordx4 v[180:183], v1, s[52:55], s80 offen
    s_add_u32 s80, s33, 229376
    buffer_load_dwordx4 v[184:187], v1, s[52:55], s80 offen
    s_add_u32 s80, s34, 229376
    buffer_load_dwordx4 v[188:191], v1, s[52:55], s80 offen
    s_cmp_lg_u32 s3, 6
    s_cbranch_scc1 ONLY_adaLN_cond__sliding_local_dilated__glu_gated_reglu__prompt_kernel_208
    s_add_u32 s80, s95, 4096
    v_mov_b32 v31, s77
    s_movk_i32 s86, 30000
WL_adaLN_cond__sliding_local_dilated__glu_gated_reglu__prompt_kernel_209:
    ds_read_b32 v30, v28
    s_waitcnt lgkmcnt(0)
    v_cmp_gt_u32 vcc, 35, v30
    s_cbranch_vccz WD_adaLN_cond__sliding_local_dilated__glu_gated_reglu__prompt_kernel_210
    s_sub_u32 s86, s86, 1
    s_cmp_lg_u32 s86, 0
    s_cbranch_scc1 WL_adaLN_cond__sliding_local_dilated__glu_gated_reglu__prompt_kernel_209
WD_adaLN_cond__sliding_local_dilated__glu_gated_reglu__prompt_kernel_210:
    s_mov_b64 exec, 1
    buffer_store_dword v31, off, s[68:71], s80 sc1
    s_mov_b64 exec, -1
ONLY_adaLN_cond__sliding_local_dilated__glu_gated_reglu__prompt_kernel_208:
    s_nop 7
    s_nop 7
    s_movk_i32 s86, 30000
WL_adaLN_cond__sliding_local_dilated__glu_gated_reglu__prompt_kernel_211:
    ds_read_b32 v30, v28
    s_waitcnt lgkmcnt(0)
    v_cmp_gt_u32 vcc, 36, v30
    s_cbranch_vccz WD_adaLN_cond__sliding_local_dilated__glu_gated_reglu__prompt_kernel_212
    s_sleep 1
    s_sub_u32 s86, s86, 1
    s_cmp_lg_u32 s86, 0
    s_cbranch_scc1 WL_adaLN_cond__sliding_local_dilated__glu_gated_reglu__prompt_kernel_211
WD_adaLN_cond__sliding_local_dilated__glu_gated_reglu__prompt_kernel_212:
    s_waitcnt vmcnt(44)
    ds_write_b128 v5, v[240:243]
    ds_write_b128 v5, v[244:247] offset:4096
    ds_write_b128 v5, v[248:251] offset:8192
    ds_write_b128 v5, v[252:255] offset:12288
    ds_inc_u32 v29, v29
    s_add_u32 s80, s35, 98304
    buffer_load_dwordx4 v[192:195], v1, s[52:55], s80 offen
    s_add_u32 s80, s36, 98304
    buffer_load_dwordx4 v[196:199], v1, s[52:55], s80 offen
    s_add_u32 s80, s35, 229376
    buffer_load_dwordx4 v[200:203], v1, s[52:55], s80 offen
    s_add_u32 s80, s36, 229376
    buffer_load_dwordx4 v[204:207], v1, s[52:55], s80 offen
    s_add_u32 s80, s37, 98304
    buffer_load_dwordx4 v[208:211], v1, s[52:55], s80 offen
    s_add_u32 s80, s38, 98304
    buffer_load_dwordx4 v[212:215], v1, s[52:55], s80 offen
    s_add_u32 s80, s37, 229376
    buffer_load_dwordx4 v[216:219], v1, s[52:55], s80 offen
    s_add_u32 s80, s38, 229376
    buffer_load_dwordx4 v[220:223], v1, s[52:55], s80 offen
    s_movk_i32 s86, 30000
WL_adaLN_cond__sliding_local_dilated__glu_gated_reglu__prompt_kernel_213:
    ds_read_b32 v30, v28
    s_waitcnt lgkmcnt(0)
    v_cmp_gt_u32 vcc, 37, v30
    s_cbranch_vccz WD_adaLN_cond__sliding_local_dilated__glu_gated_reglu__prompt_kernel_214
    s_sleep 1
    s_sub_u32 s86, s86, 1
    s_cmp_lg_u32 s86, 0
    s_cbranch_scc1 WL_adaLN_cond__sliding_local_dilated__glu_gated_reglu__prompt_kernel_213
WD_adaLN_cond__sliding_local_dilated__glu_gated_reglu__prompt_kernel_214:
    s_waitcnt vmcnt(48)
    ds_write_b128 v5, v[32:35] offset:16384
    ds_write_b128 v5, v[36:39] offset:20480
    ds_write_b128 v5, v[40:43] offset:24576
    ds_write_b128 v5, v[44:47] offset:28672
    ds_inc_u32 v29, v29
    s_movk_i32 s86, 30000
WL_adaLN_cond__sliding_local_dilated__glu_gated_reglu__prompt_kernel_215:
    ds_read_b32 v30, v28
    s_waitcnt lgkmcnt(0)
    v_cmp_gt_u32 vcc, 38, v30
    s_cbranch_vccz WD_adaLN_cond__sliding_local_dilated__glu_gated_reglu__prompt_kernel_216
    s_sleep 1
    s_sub_u32 s86, s86, 1
    s_cmp_lg_u32 s86, 0
    s_cbranch_scc1 WL_adaLN_cond__sliding_local_dilated__glu_gated_reglu__prompt_kernel_215
WD_adaLN_cond__sliding_local_dilated__glu_gated_reglu__prompt_kernel_216:
    s_waitcnt vmcnt(44)
    ds_write_b128 v5, v[48:51] offset:32768
    ds_write_b128 v5, v[52:55] offset:36864
    ds_write_b128 v5, v[56:59] offset:40960
    ds_write_b128 v5, v[60:63] offset:45056
    ds_inc_u32 v29, v29
    s_movk_i32 s86, 30000
WL_adaLN_cond__sliding_local_dilated__glu_gated_reglu__prompt_kernel_217:
    ds_read_b32 v30, v28
    s_waitcnt lgkmcnt(0)
    v_cmp_gt_u32 vcc, 39, v30
    s_cbranch_vccz WD_adaLN_cond__sliding_local_dilated__glu_gated_reglu__prompt_kernel_218
    s_sleep 1
    s_sub_u32 s86, s86, 1
    s_cmp_lg_u32 s86, 0
    s_cbranch_scc1 WL_adaLN_cond__sliding_local_dilated__glu_gated_reglu__prompt_kernel_217
WD_adaLN_cond__sliding_local_dilated__glu_gated_reglu__prompt_kernel_218:
    s_waitcnt vmcnt(40)
    ds_write_b128 v5, v[64:67] offset:49152
    ds_write_b128 v5, v[68:71] offset:53248
    ds_write_b128 v5, v[72:75] offset:57344
    ds_write_b128 v5, v[76:79] offset:61440
    ds_inc_u32 v29, v29
    s_movk_i32 s86, 30000
WL_adaLN_cond__sliding_local_dilated__glu_gated_reglu__prompt_kernel_219:
    ds_read_b32 v30, v28
    s_waitcnt lgkmcnt(0)
    v_cmp_gt_u32 vcc, 40, v30
    s_cbranch_vccz WD_adaLN_cond__sliding_local_dilated__glu_gated_reglu__prompt_kernel_220
    s_sleep 1
    s_sub_u32 s86, s86, 1
    s_cmp_lg_u32 s86, 0
    s_cbranch_scc1 WL_adaLN_cond__sliding_local_dilated__glu_gated_reglu__prompt_kernel_219
WD_adaLN_cond__sliding_local_dilated__glu_gated_reglu__prompt_kernel_220:
    s_waitcnt vmcnt(36)
    ds_write_b128 v4, v[80:83]
    ds_write_b128 v4, v[84:87] offset:4096
    ds_write_b128 v4, v[88:91] offset:8192
    ds_write_b128 v4, v[92:95] offset:12288
    ds_inc_u32 v29, v29
    s_cmp_lg_u32 s3, 6
    s_cbranch_scc1 ONLY_adaLN_cond__sliding_local_dilated__glu_gated_reglu__prompt_kernel_221
    s_add_u32 s80, s95, 6144
    v_mov_b32 v31, s77
    s_movk_i32 s86, 30000
WL_adaLN_cond__sliding_local_dilated__glu_gated_reglu__prompt_kernel_222:
    ds_read_b32 v30, v28
    s_waitcnt lgkmcnt(0)
    v_cmp_gt_u32 vcc, 41, v30
    s_cbranch_vccz WD_adaLN_cond__sliding_local_dilated__glu_gated_reglu__prompt_kernel_223
    s_sub_u32 s86, s86, 1
    s_cmp_lg_u32 s86, 0
    s_cbranch_scc1 WL_adaLN_cond__sliding_local_dilated__glu_gated_reglu__prompt_kernel_222
WD_adaLN_cond__sliding_local_dilated__glu_gated_reglu__prompt_kernel_223:
    s_mov_b64 exec, 1
    buffer_store_dword v31, off, s[68:71], s80 sc1
    s_mov_b64 exec, -1
ONLY_adaLN_cond__sliding_local_dilated__glu_gated_reglu__prompt_kernel_221:
    s_nop 7
    s_nop 7
    s_movk_i32 s86, 30000
WL_adaLN_cond__sliding_local_dilated__glu_gated_reglu__prompt_kernel_224:
    ds_read_b32 v30, v28
    s_waitcnt lgkmcnt(0)
    v_cmp_gt_u32 vcc, 42, v30
    s_cbranch_vccz WD_adaLN_cond__sliding_local_dilated__glu_gated_reglu__prompt_kernel_225
    s_sleep 1
    s_sub_u32 s86, s86, 1
    s_cmp_lg_u32 s86, 0
    s_cbranch_scc1 WL_adaLN_cond__sliding_local_dilated__glu_gated_reglu__prompt_kernel_224
WD_adaLN_cond__sliding_local_dilated__glu_gated_reglu__prompt_kernel_225:
    s_waitcnt vmcnt(32)
    ds_write_b128 v4, v[96:99] offset:16384
    ds_write_b128 v4, v[100:103] offset:20480
    ds_write_b128 v4, v[104:107] offset:24576
    ds_write_b128 v4, v[108:111] offset:28672
    ds_inc_u32 v29, v29
    s_movk_i32 s86, 30000
WL_adaLN_cond__sliding_local_dilated__glu_gated_reglu__prompt_kernel_226:
    ds_read_b32 v30, v28
    s_waitcnt lgkmcnt(0)
    v_cmp_gt_u32 vcc, 43, v30
    s_cbranch_vccz WD_adaLN_cond__sliding_local_dilated__glu_gated_reglu__prompt_kernel_227
    s_sleep 1
    s_sub_u32 s86, s86, 1
    s_cmp_lg_u32 s86, 0
    s_cbranch_scc1 WL_adaLN_cond__sliding_local_dilated__glu_gated_reglu__prompt_kernel_226
WD_adaLN_cond__sliding_local_dilated__glu_gated_reglu__prompt_kernel_227:
    s_waitcnt vmcnt(28)
    ds_write_b128 v4, v[112:115] offset:32768
    ds_write_b128 v4, v[116:119] offset:36864
    ds_write_b128 v4, v[120:123] offset:40960
    ds_write_b128 v4, v[124:127] offset:45056
    ds_inc_u32 v29, v29
    s_movk_i32 s86, 30000
WL_adaLN_cond__sliding_local_dilated__glu_gated_reglu__prompt_kernel_228:
    ds_read_b32 v30, v28
    s_waitcnt lgkmcnt(0)
    v_cmp_gt_u32 vcc, 44, v30
    s_cbranch_vccz WD_adaLN_cond__sliding_local_dilated__glu_gated_reglu__prompt_kernel_229
    s_sleep 1
    s_sub_u32 s86, s86, 1
    s_cmp_lg_u32 s86, 0
    s_cbranch_scc1 WL_adaLN_cond__sliding_local_dilated__glu_gated_reglu__prompt_kernel_228
WD_adaLN_cond__sliding_local_dilated__glu_gated_reglu__prompt_kernel_229:
    s_waitcnt vmcnt(24)
    ds_write_b128 v4, v[224:227] offset:49152
    ds_write_b128 v4, v[228:231] offset:53248
    ds_write_b128 v4, v[232:235] offset:57344
    ds_write_b128 v4, v[236:239] offset:61440
    ds_inc_u32 v29, v29
    s_movk_i32 s86, 30000
WL_adaLN_cond__sliding_local_dilated__glu_gated_reglu__prompt_kernel_230:
    ds_read_b32 v30, v28
    s_waitcnt lgkmcnt(0)
    v_cmp_gt_u32 vcc, 46, v30
    s_cbranch_vccz WD_adaLN_cond__sliding_local_dilated__glu_gated_reglu__prompt_kernel_231
    s_sleep 1
    s_sub_u32 s86, s86, 1
    s_cmp_lg_u32 s86, 0
    s_cbranch_scc1 WL_adaLN_cond__sliding_local_dilated__glu_gated_reglu__prompt_kernel_230
WD_adaLN_cond__sliding_local_dilated__glu_gated_reglu__prompt_kernel_231:
    s_waitcnt vmcnt(20)
    ds_write_b128 v5, v[128:131]
    ds_write_b128 v5, v[132:135] offset:4096
    ds_write_b128 v5, v[136:139] offset:8192
    ds_write_b128 v5, v[140:143] offset:12288
    ds_inc_u32 v29, v29
    s_cmp_lg_u32 s3, 6
    s_cbranch_scc1 ONLY_adaLN_cond__sliding_local_dilated__glu_gated_reglu__prompt_kernel_232
    s_add_u32 s80, s95, 8192
    v_mov_b32 v31, s77
    s_movk_i32 s86, 30000
WL_adaLN_cond__sliding_local_dilated__glu_gated_reglu__prompt_kernel_233:
    ds_read_b32 v30, v28
    s_waitcnt lgkmcnt(0)
    v_cmp_gt_u32 vcc, 47, v30
    s_cbranch_vccz WD_adaLN_cond__sliding_local_dilated__glu_gated_reglu__prompt_kernel_234
    s_sub_u32 s86, s86, 1
    s_cmp_lg_u32 s86, 0
    s_cbranch_scc1 WL_adaLN_cond__sliding_local_dilated__glu_gated_reglu__prompt_kernel_233
WD_adaLN_cond__sliding_local_dilated__glu_gated_reglu__prompt_kernel_234:
    s_mov_b64 exec, 1
    buffer_store_dword v31, off, s[68:71], s80 sc1
    s_mov_b64 exec, -1
ONLY_adaLN_cond__sliding_local_dilated__glu_gated_reglu__prompt_kernel_232:
    s_nop 7
    s_nop 7
    s_movk_i32 s86, 30000
WL_adaLN_cond__sliding_local_dilated__glu_gated_reglu__prompt_kernel_235:
    ds_read_b32 v30, v28
    s_waitcnt lgkmcnt(0)
    v_cmp_gt_u32 vcc, 48, v30
    s_cbranch_vccz WD_adaLN_cond__sliding_local_dilated__glu_gated_reglu__prompt_kernel_236
    s_sleep 1
    s_sub_u32 s86, s86, 1
    s_cmp_lg_u32 s86, 0
    s_cbranch_scc1 WL_adaLN_cond__sliding_local_dilated__glu_gated_reglu__prompt_kernel_235
WD_adaLN_cond__sliding_local_dilated__glu_gated_reglu__prompt_kernel_236:
    s_waitcnt vmcnt(16)
    ds_write_b128 v5, v[144:147] offset:16384
    ds_write_b128 v5, v[148:151] offset:20480
    ds_write_b128 v5, v[152:155] offset:24576
    ds_write_b128 v5, v[156:159] offset:28672
    ds_inc_u32 v29, v29
    s_movk_i32 s86, 30000
WL_adaLN_cond__sliding_local_dilated__glu_gated_reglu__prompt_kernel_237:
    ds_read_b32 v30, v28
    s_waitcnt lgkmcnt(0)
    v_cmp_gt_u32 vcc, 49, v30
    s_cbranch_vccz WD_adaLN_cond__sliding_local_dilated__glu_gated_reglu__prompt_kernel_238
    s_sleep 1
    s_sub_u32 s86, s86, 1
    s_cmp_lg_u32 s86, 0
    s_cbranch_scc1 WL_adaLN_cond__sliding_local_dilated__glu_gated_reglu__prompt_kernel_237
WD_adaLN_cond__sliding_local_dilated__glu_gated_reglu__prompt_kernel_238:
    s_waitcnt vmcnt(12)
    ds_write_b128 v5, v[160:163] offset:32768
    ds_write_b128 v5, v[164:167] offset:36864
    ds_write_b128 v5, v[168:171] offset:40960
    ds_write_b128 v5, v[172:175] offset:45056
    ds_inc_u32 v29, v29
    s_movk_i32 s86, 30000
WL_adaLN_cond__sliding_local_dilated__glu_gated_reglu__prompt_kernel_239:
    ds_read_b32 v30, v28
    s_waitcnt lgkmcnt(0)
    v_cmp_gt_u32 vcc, 50, v30
    s_cbranch_vccz WD_adaLN_cond__sliding_local_dilated__glu_gated_reglu__prompt_kernel_240
    s_sleep 1
    s_sub_u32 s86, s86, 1
    s_cmp_lg_u32 s86, 0
    s_cbranch_scc1 WL_adaLN_cond__sliding_local_dilated__glu_gated_reglu__prompt_kernel_239
WD_adaLN_cond__sliding_local_dilated__glu_gated_reglu__prompt_kernel_240:
    s_waitcnt vmcnt(8)
    ds_write_b128 v5, v[176:179] offset:49152
    ds_write_b128 v5, v[180:183] offset:53248
    ds_write_b128 v5, v[184:187] offset:57344
    ds_write_b128 v5, v[188:191] offset:61440
    ds_inc_u32 v29, v29
    s_movk_i32 s86, 30000
WL_adaLN_cond__sliding_local_dilated__glu_gated_reglu__prompt_kernel_241:
    ds_read_b32 v30, v28
    s_waitcnt lgkmcnt(0)
    v_cmp_gt_u32 vcc, 51, v30
    s_cbranch_vccz WD_adaLN_cond__sliding_local_dilated__glu_gated_reglu__prompt_kernel_242
    s_sleep 1
    s_sub_u32 s86, s86, 1
    s_cmp_lg_u32 s86, 0
    s_cbranch_scc1 WL_adaLN_cond__sliding_local_dilated__glu_gated_reglu__prompt_kernel_241
WD_adaLN_cond__sliding_local_dilated__glu_gated_reglu__prompt_kernel_242:
    s_waitcnt vmcnt(4)
    ds_write_b128 v4, v[192:195]
    ds_write_b128 v4, v[196:199] offset:4096
    ds_write_b128 v4, v[200:203] offset:8192
    ds_write_b128 v4, v[204:207] offset:12288
    ds_inc_u32 v29, v29
    s_movk_i32 s86, 30000
WL_adaLN_cond__sliding_local_dilated__glu_gated_reglu__prompt_kernel_243:
    ds_read_b32 v30, v28
    s_waitcnt lgkmcnt(0)
    v_cmp_gt_u32 vcc, 52, v30
    s_cbranch_vccz WD_adaLN_cond__sliding_local_dilated__glu_gated_reglu__prompt_kernel_244
    s_sleep 1
    s_sub_u32 s86, s86, 1
    s_cmp_lg_u32 s86, 0
    s_cbranch_scc1 WL_adaLN_cond__sliding_local_dilated__glu_gated_reglu__prompt_kernel_243
WD_adaLN_cond__sliding_local_dilated__glu_gated_reglu__prompt_kernel_244:
    s_waitcnt vmcnt(0)
    ds_write_b128 v4, v[208:211] offset:16384
    ds_write_b128 v4, v[212:215] offset:20480
    ds_write_b128 v4, v[216:219] offset:24576
    ds_write_b128 v4, v[220:223] offset:28672
    ds_inc_u32 v29, v29
FIN:
    s_nop 7
    s_nop 7
END:
    s_endpgm
    s_nop 7
    s_nop 7
SLOW_adaLN_cond__sliding_local_dilated__glu_gated_reglu__prompt_kernel_6:
    s_movk_i32 s86, 30000
SL_adaLN_cond__sliding_local_dilated__glu_gated_reglu__prompt_kernel_245:
    ds_read_b32 v0, v108 offset:1024
    s_waitcnt lgkmcnt(0)
    v_cmp_gt_u32 vcc, 2, v0
    s_cbranch_vccz BACK_adaLN_cond__sliding_local_dilated__glu_gated_reglu__prompt_kernel_7
    s_sub_u32 s86, s86, 1
    s_cmp_lg_u32 s86, 0
    s_cbranch_scc1 SL_adaLN_cond__sliding_local_dilated__glu_gated_reglu__prompt_kernel_245
    s_branch BACK_adaLN_cond__sliding_local_dilated__glu_gated_reglu__prompt_kernel_7
    s_nop 7
    s_nop 7
SLOW_adaLN_cond__sliding_local_dilated__glu_gated_reglu__prompt_kernel_8:
    s_movk_i32 s86, 30000
SL_adaLN_cond__sliding_local_dilated__glu_gated_reglu__prompt_kernel_246:
    ds_read_b32 v110, v108
    s_waitcnt lgkmcnt(0)
    v_cmp_gt_u32 vcc, 1, v110
    s_cbranch_vccz BACK_adaLN_cond__sliding_local_dilated__glu_gated_reglu__prompt_kernel_9
    s_sub_u32 s86, s86, 1
    s_cmp_lg_u32 s86, 0
    s_cbranch_scc1 SL_adaLN_cond__sliding_local_dilated__glu_gated_reglu__prompt_kernel_246
    s_branch BACK_adaLN_cond__sliding_local_dilated__glu_gated_reglu__prompt_kernel_9
    s_nop 7
    s_nop 7
SLOW_adaLN_cond__sliding_local_dilated__glu_gated_reglu__prompt_kernel_10:
    s_movk_i32 s86, 30000
SL_adaLN_cond__sliding_local_dilated__glu_gated_reglu__prompt_kernel_247:
    ds_read_b32 v0, v108 offset:1024
    s_waitcnt lgkmcnt(0)
    v_cmp_gt_u32 vcc, 4, v0
    s_cbranch_vccz BACK_adaLN_cond__sliding_local_dilated__glu_gated_reglu__prompt_kernel_11
    s_sub_u32 s86, s86, 1
    s_cmp_lg_u32 s86, 0
    s_cbranch_scc1 SL_adaLN_cond__sliding_local_dilated__glu_gated_reglu__prompt_kernel_247
    s_branch BACK_adaLN_cond__sliding_local_dilated__glu_gated_reglu__prompt_kernel_11
    s_nop 7
    s_nop 7
SLOW_adaLN_cond__sliding_local_dilated__glu_gated_reglu__prompt_kernel_12:
    s_movk_i32 s86, 30000
SL_adaLN_cond__sliding_local_dilated__glu_gated_reglu__prompt_kernel_248:
    ds_read_b32 v0, v108 offset:1024
    s_waitcnt lgkmcnt(0)
    v_cmp_gt_u32 vcc, 6, v0
    s_cbranch_vccz BACK_adaLN_cond__sliding_local_dilated__glu_gated_reglu__prompt_kernel_13
    s_sub_u32 s86, s86, 1
    s_cmp_lg_u32 s86, 0
    s_cbranch_scc1 SL_adaLN_cond__sliding_local_dilated__glu_gated_reglu__prompt_kernel_248
    s_branch BACK_adaLN_cond__sliding_local_dilated__glu_gated_reglu__prompt_kernel_13
    s_nop 7
    s_nop 7
SLOW_adaLN_cond__sliding_local_dilated__glu_gated_reglu__prompt_kernel_14:
    s_movk_i32 s86, 30000
SL_adaLN_cond__sliding_local_dilated__glu_gated_reglu__prompt_kernel_249:
    ds_read_b32 v110, v108
    s_waitcnt lgkmcnt(0)
    v_cmp_gt_u32 vcc, 4, v110
    s_cbranch_vccz BACK_adaLN_cond__sliding_local_dilated__glu_gated_reglu__prompt_kernel_15
    s_sub_u32 s86, s86, 1
    s_cmp_lg_u32 s86, 0
    s_cbranch_scc1 SL_adaLN_cond__sliding_local_dilated__glu_gated_reglu__prompt_kernel_249
    s_branch BACK_adaLN_cond__sliding_local_dilated__glu_gated_reglu__prompt_kernel_15
    s_nop 7
    s_nop 7
SLOW_adaLN_cond__sliding_local_dilated__glu_gated_reglu__prompt_kernel_16:
    s_movk_i32 s86, 30000
SL_adaLN_cond__sliding_local_dilated__glu_gated_reglu__prompt_kernel_250:
    ds_read_b32 v110, v108
    s_waitcnt lgkmcnt(0)
    v_cmp_gt_u32 vcc, 5, v110
    s_cbranch_vccz BACK_adaLN_cond__sliding_local_dilated__glu_gated_reglu__prompt_kernel_17
    s_sub_u32 s86, s86, 1
    s_cmp_lg_u32 s86, 0
    s_cbranch_scc1 SL_adaLN_cond__sliding_local_dilated__glu_gated_reglu__prompt_kernel_250
    s_branch BACK_adaLN_cond__sliding_local_dilated__glu_gated_reglu__prompt_kernel_17
    s_nop 7
    s_nop 7
SLOW_adaLN_cond__sliding_local_dilated__glu_gated_reglu__prompt_kernel_18:
    s_movk_i32 s86, 30000
SL_adaLN_cond__sliding_local_dilated__glu_gated_reglu__prompt_kernel_251:
    ds_read_b32 v0, v108 offset:1024
    s_waitcnt lgkmcnt(0)
    v_cmp_gt_u32 vcc, 9, v0
    s_cbranch_vccz BACK_adaLN_cond__sliding_local_dilated__glu_gated_reglu__prompt_kernel_19
    s_sub_u32 s86, s86, 1
    s_cmp_lg_u32 s86, 0
    s_cbranch_scc1 SL_adaLN_cond__sliding_local_dilated__glu_gated_reglu__prompt_kernel_251
    s_branch BACK_adaLN_cond__sliding_local_dilated__glu_gated_reglu__prompt_kernel_19
    s_nop 7
    s_nop 7
SLOW_adaLN_cond__sliding_local_dilated__glu_gated_reglu__prompt_kernel_20:
    s_movk_i32 s86, 30000
SL_adaLN_cond__sliding_local_dilated__glu_gated_reglu__prompt_kernel_252:
    ds_read_b32 v110, v108
    s_waitcnt lgkmcnt(0)
    v_cmp_gt_u32 vcc, 8, v110
    s_cbranch_vccz BACK_adaLN_cond__sliding_local_dilated__glu_gated_reglu__prompt_kernel_21
    s_sub_u32 s86, s86, 1
    s_cmp_lg_u32 s86, 0
    s_cbranch_scc1 SL_adaLN_cond__sliding_local_dilated__glu_gated_reglu__prompt_kernel_252
    s_branch BACK_adaLN_cond__sliding_local_dilated__glu_gated_reglu__prompt_kernel_21
    s_nop 7
    s_nop 7
SLOW_adaLN_cond__sliding_local_dilated__glu_gated_reglu__prompt_kernel_22:
    s_movk_i32 s86, 30000
SL_adaLN_cond__sliding_local_dilated__glu_gated_reglu__prompt_kernel_253:
    ds_read_b32 v0, v108 offset:1024
    s_waitcnt lgkmcnt(0)
    v_cmp_gt_u32 vcc, 10, v0
    s_cbranch_vccz BACK_adaLN_cond__sliding_local_dilated__glu_gated_reglu__prompt_kernel_23
    s_sub_u32 s86, s86, 1
    s_cmp_lg_u32 s86, 0
    s_cbranch_scc1 SL_adaLN_cond__sliding_local_dilated__glu_gated_reglu__prompt_kernel_253
    s_branch BACK_adaLN_cond__sliding_local_dilated__glu_gated_reglu__prompt_kernel_23
    s_nop 7
    s_nop 7
SLOW_adaLN_cond__sliding_local_dilated__glu_gated_reglu__prompt_kernel_24:
    s_movk_i32 s86, 30000
SL_adaLN_cond__sliding_local_dilated__glu_gated_reglu__prompt_kernel_254:
    ds_read_b32 v110, v108
    s_waitcnt lgkmcnt(0)
    v_cmp_gt_u32 vcc, 10, v110
    s_cbranch_vccz BACK_adaLN_cond__sliding_local_dilated__glu_gated_reglu__prompt_kernel_25
    s_sub_u32 s86, s86, 1
    s_cmp_lg_u32 s86, 0
    s_cbranch_scc1 SL_adaLN_cond__sliding_local_dilated__glu_gated_reglu__prompt_kernel_254
    s_branch BACK_adaLN_cond__sliding_local_dilated__glu_gated_reglu__prompt_kernel_25
    s_nop 7
    s_nop 7
SLOW_adaLN_cond__sliding_local_dilated__glu_gated_reglu__prompt_kernel_26:
    s_movk_i32 s86, 30000
SL_adaLN_cond__sliding_local_dilated__glu_gated_reglu__prompt_kernel_255:
    ds_read_b32 v0, v108 offset:1024
    s_waitcnt lgkmcnt(0)
    v_cmp_gt_u32 vcc, 11, v0
    s_cbranch_vccz BACK_adaLN_cond__sliding_local_dilated__glu_gated_reglu__prompt_kernel_27
    s_sub_u32 s86, s86, 1
    s_cmp_lg_u32 s86, 0
    s_cbranch_scc1 SL_adaLN_cond__sliding_local_dilated__glu_gated_reglu__prompt_kernel_255
    s_branch BACK_adaLN_cond__sliding_local_dilated__glu_gated_reglu__prompt_kernel_27
    s_nop 7
    s_nop 7
SLOW_adaLN_cond__sliding_local_dilated__glu_gated_reglu__prompt_kernel_28:
    s_movk_i32 s86, 30000
SL_adaLN_cond__sliding_local_dilated__glu_gated_reglu__prompt_kernel_256:
    ds_read_b32 v0, v108 offset:1024
    s_waitcnt lgkmcnt(0)
    v_cmp_gt_u32 vcc, 12, v0
    s_cbranch_vccz BACK_adaLN_cond__sliding_local_dilated__glu_gated_reglu__prompt_kernel_29
    s_sub_u32 s86, s86, 1
    s_cmp_lg_u32 s86, 0
    s_cbranch_scc1 SL_adaLN_cond__sliding_local_dilated__glu_gated_reglu__prompt_kernel_256
    s_branch BACK_adaLN_cond__sliding_local_dilated__glu_gated_reglu__prompt_kernel_29
    s_nop 7
    s_nop 7
SLOW_adaLN_cond__sliding_local_dilated__glu_gated_reglu__prompt_kernel_30:
    s_movk_i32 s86, 30000
SL_adaLN_cond__sliding_local_dilated__glu_gated_reglu__prompt_kernel_257:
    ds_read_b32 v0, v108 offset:1024
    s_waitcnt lgkmcnt(0)
    v_cmp_gt_u32 vcc, 13, v0
    s_cbranch_vccz BACK_adaLN_cond__sliding_local_dilated__glu_gated_reglu__prompt_kernel_31
    s_sub_u32 s86, s86, 1
    s_cmp_lg_u32 s86, 0
    s_cbranch_scc1 SL_adaLN_cond__sliding_local_dilated__glu_gated_reglu__prompt_kernel_257
    s_branch BACK_adaLN_cond__sliding_local_dilated__glu_gated_reglu__prompt_kernel_31
    s_nop 7
    s_nop 7
SLOW_adaLN_cond__sliding_local_dilated__glu_gated_reglu__prompt_kernel_32:
    s_movk_i32 s86, 30000
SL_adaLN_cond__sliding_local_dilated__glu_gated_reglu__prompt_kernel_258:
    ds_read_b32 v110, v108
    s_waitcnt lgkmcnt(0)
    v_cmp_gt_u32 vcc, 13, v110
    s_cbranch_vccz BACK_adaLN_cond__sliding_local_dilated__glu_gated_reglu__prompt_kernel_33
    s_sub_u32 s86, s86, 1
    s_cmp_lg_u32 s86, 0
    s_cbranch_scc1 SL_adaLN_cond__sliding_local_dilated__glu_gated_reglu__prompt_kernel_258
    s_branch BACK_adaLN_cond__sliding_local_dilated__glu_gated_reglu__prompt_kernel_33
    s_nop 7
    s_nop 7
SLOW_adaLN_cond__sliding_local_dilated__glu_gated_reglu__prompt_kernel_34:
    s_movk_i32 s86, 30000
SL_adaLN_cond__sliding_local_dilated__glu_gated_reglu__prompt_kernel_259:
    ds_read_b32 v0, v108 offset:1024
    s_waitcnt lgkmcnt(0)
    v_cmp_gt_u32 vcc, 14, v0
    s_cbranch_vccz BACK_adaLN_cond__sliding_local_dilated__glu_gated_reglu__prompt_kernel_35
    s_sub_u32 s86, s86, 1
    s_cmp_lg_u32 s86, 0
    s_cbranch_scc1 SL_adaLN_cond__sliding_local_dilated__glu_gated_reglu__prompt_kernel_259
    s_branch BACK_adaLN_cond__sliding_local_dilated__glu_gated_reglu__prompt_kernel_35
    s_nop 7
    s_nop 7
SLOW_adaLN_cond__sliding_local_dilated__glu_gated_reglu__prompt_kernel_36:
    s_movk_i32 s86, 30000
SL_adaLN_cond__sliding_local_dilated__glu_gated_reglu__prompt_kernel_260:
    ds_read_b32 v0, v108 offset:1024
    s_waitcnt lgkmcnt(0)
    v_cmp_gt_u32 vcc, 15, v0
    s_cbranch_vccz BACK_adaLN_cond__sliding_local_dilated__glu_gated_reglu__prompt_kernel_37
    s_sub_u32 s86, s86, 1
    s_cmp_lg_u32 s86, 0
    s_cbranch_scc1 SL_adaLN_cond__sliding_local_dilated__glu_gated_reglu__prompt_kernel_260
    s_branch BACK_adaLN_cond__sliding_local_dilated__glu_gated_reglu__prompt_kernel_37
    s_nop 7
    s_nop 7
SLOW_adaLN_cond__sliding_local_dilated__glu_gated_reglu__prompt_kernel_38:
    s_movk_i32 s86, 30000
SL_adaLN_cond__sliding_local_dilated__glu_gated_reglu__prompt_kernel_261:
    ds_read_b32 v0, v108 offset:1024
    s_waitcnt lgkmcnt(0)
    v_cmp_gt_u32 vcc, 16, v0
    s_cbranch_vccz BACK_adaLN_cond__sliding_local_dilated__glu_gated_reglu__prompt_kernel_39
    s_sub_u32 s86, s86, 1
    s_cmp_lg_u32 s86, 0
    s_cbranch_scc1 SL_adaLN_cond__sliding_local_dilated__glu_gated_reglu__prompt_kernel_261
    s_branch BACK_adaLN_cond__sliding_local_dilated__glu_gated_reglu__prompt_kernel_39
    s_nop 7
    s_nop 7
WS_adaLN_cond__sliding_local_dilated__glu_gated_reglu__prompt_kernel_40:
    s_mov_b32 s62, 1
    v_lshlrev_b32 v11, 7, v15
    s_add_u32 s91, s100, 0
    s_movk_i32 s86, 3000
    s_mov_b64 exec, 0xffff
WL_adaLN_cond__sliding_local_dilated__glu_gated_reglu__prompt_kernel_263:
    buffer_load_dword v10, v11, s[68:71], s91 offen sc1
    s_waitcnt vmcnt(0)
    v_cmp_ne_u32 vcc, s77, v10
    s_and_b32 s90, vcc_lo, s92
    s_cbranch_scc0 WD_adaLN_cond__sliding_local_dilated__glu_gated_reglu__prompt_kernel_264
    s_sleep 2
    s_sub_u32 s86, s86, 1
    s_cmp_lg_u32 s86, 0
    s_cbranch_scc1 WL_adaLN_cond__sliding_local_dilated__glu_gated_reglu__prompt_kernel_263
WD_adaLN_cond__sliding_local_dilated__glu_gated_reglu__prompt_kernel_264:
    s_mov_b64 exec, -1
    s_branch WB_adaLN_cond__sliding_local_dilated__glu_gated_reglu__prompt_kernel_41
    s_nop 7
    s_nop 7
SLOW_adaLN_cond__sliding_local_dilated__glu_gated_reglu__prompt_kernel_44:
    s_movk_i32 s86, 30000
SL_adaLN_cond__sliding_local_dilated__glu_gated_reglu__prompt_kernel_265:
    ds_read_b32 v0, v108 offset:1024
    s_waitcnt lgkmcnt(0)
    v_cmp_gt_u32 vcc, 17, v0
    s_cbranch_vccz BACK_adaLN_cond__sliding_local_dilated__glu_gated_reglu__prompt_kernel_45
    s_sub_u32 s86, s86, 1
    s_cmp_lg_u32 s86, 0
    s_cbranch_scc1 SL_adaLN_cond__sliding_local_dilated__glu_gated_reglu__prompt_kernel_265
    s_branch BACK_adaLN_cond__sliding_local_dilated__glu_gated_reglu__prompt_kernel_45
    s_nop 7
    s_nop 7
SLOW_adaLN_cond__sliding_local_dilated__glu_gated_reglu__prompt_kernel_46:
    s_movk_i32 s86, 30000
SL_adaLN_cond__sliding_local_dilated__glu_gated_reglu__prompt_kernel_266:
    ds_read_b32 v0, v108 offset:1024
    s_waitcnt lgkmcnt(0)
    v_cmp_gt_u32 vcc, 18, v0
    s_cbranch_vccz BACK_adaLN_cond__sliding_local_dilated__glu_gated_reglu__prompt_kernel_47
    s_sub_u32 s86, s86, 1
    s_cmp_lg_u32 s86, 0
    s_cbranch_scc1 SL_adaLN_cond__sliding_local_dilated__glu_gated_reglu__prompt_kernel_266
    s_branch BACK_adaLN_cond__sliding_local_dilated__glu_gated_reglu__prompt_kernel_47
    s_nop 7
    s_nop 7
SLOW_adaLN_cond__sliding_local_dilated__glu_gated_reglu__prompt_kernel_48:
    s_movk_i32 s86, 30000
SL_adaLN_cond__sliding_local_dilated__glu_gated_reglu__prompt_kernel_267:
    ds_read_b32 v0, v111
    s_waitcnt lgkmcnt(0)
    v_cmp_gt_u32 vcc, 23, v0
    s_cbranch_vccz BACK_adaLN_cond__sliding_local_dilated__glu_gated_reglu__prompt_kernel_49
    s_sub_u32 s86, s86, 1
    s_cmp_lg_u32 s86, 0
    s_cbranch_scc1 SL_adaLN_cond__sliding_local_dilated__glu_gated_reglu__prompt_kernel_267
    s_branch BACK_adaLN_cond__sliding_local_dilated__glu_gated_reglu__prompt_kernel_49
    s_nop 7
    s_nop 7
WS_adaLN_cond__sliding_local_dilated__glu_gated_reglu__prompt_kernel_50:
    s_mov_b32 s62, 1
    v_lshlrev_b32 v11, 7, v15
    s_add_u32 s91, s100, 2048
    s_movk_i32 s86, 3000
    s_mov_b64 exec, 0xffff
WL_adaLN_cond__sliding_local_dilated__glu_gated_reglu__prompt_kernel_269:
    buffer_load_dword v10, v11, s[68:71], s91 offen sc1
    s_waitcnt vmcnt(0)
    v_cmp_ne_u32 vcc, s77, v10
    s_and_b32 s90, vcc_lo, 0xffff
    s_cbranch_scc0 WD_adaLN_cond__sliding_local_dilated__glu_gated_reglu__prompt_kernel_270
    s_sleep 2
    s_sub_u32 s86, s86, 1
    s_cmp_lg_u32 s86, 0
    s_cbranch_scc1 WL_adaLN_cond__sliding_local_dilated__glu_gated_reglu__prompt_kernel_269
WD_adaLN_cond__sliding_local_dilated__glu_gated_reglu__prompt_kernel_270:
    s_mov_b64 exec, -1
    s_branch WB_adaLN_cond__sliding_local_dilated__glu_gated_reglu__prompt_kernel_51
    s_nop 7
    s_nop 7
SLOW_adaLN_cond__sliding_local_dilated__glu_gated_reglu__prompt_kernel_54:
    s_movk_i32 s86, 30000
SL_adaLN_cond__sliding_local_dilated__glu_gated_reglu__prompt_kernel_271:
    ds_read_b32 v0, v108 offset:1024
    s_waitcnt lgkmcnt(0)
    v_cmp_gt_u32 vcc, 19, v0
    s_cbranch_vccz BACK_adaLN_cond__sliding_local_dilated__glu_gated_reglu__prompt_kernel_55
    s_sub_u32 s86, s86, 1
    s_cmp_lg_u32 s86, 0
    s_cbranch_scc1 SL_adaLN_cond__sliding_local_dilated__glu_gated_reglu__prompt_kernel_271
    s_branch BACK_adaLN_cond__sliding_local_dilated__glu_gated_reglu__prompt_kernel_55
    s_nop 7
    s_nop 7
SLOW_adaLN_cond__sliding_local_dilated__glu_gated_reglu__prompt_kernel_56:
    s_movk_i32 s86, 30000
SL_adaLN_cond__sliding_local_dilated__glu_gated_reglu__prompt_kernel_272:
    ds_read_b32 v0, v108 offset:1024
    s_waitcnt lgkmcnt(0)
    v_cmp_gt_u32 vcc, 20, v0
    s_cbranch_vccz BACK_adaLN_cond__sliding_local_dilated__glu_gated_reglu__prompt_kernel_57
    s_sub_u32 s86, s86, 1
    s_cmp_lg_u32 s86, 0
    s_cbranch_scc1 SL_adaLN_cond__sliding_local_dilated__glu_gated_reglu__prompt_kernel_272
    s_branch BACK_adaLN_cond__sliding_local_dilated__glu_gated_reglu__prompt_kernel_57
    s_nop 7
    s_nop 7
SLOW_adaLN_cond__sliding_local_dilated__glu_gated_reglu__prompt_kernel_58:
    s_movk_i32 s86, 30000
SL_adaLN_cond__sliding_local_dilated__glu_gated_reglu__prompt_kernel_273:
    ds_read_b32 v0, v108 offset:1024
    s_waitcnt lgkmcnt(0)
    v_cmp_gt_u32 vcc, 21, v0
    s_cbranch_vccz BACK_adaLN_cond__sliding_local_dilated__glu_gated_reglu__prompt_kernel_59
    s_sub_u32 s86, s86, 1
    s_cmp_lg_u32 s86, 0
    s_cbranch_scc1 SL_adaLN_cond__sliding_local_dilated__glu_gated_reglu__prompt_kernel_273
    s_branch BACK_adaLN_cond__sliding_local_dilated__glu_gated_reglu__prompt_kernel_59
    s_nop 7
    s_nop 7
SLOW_adaLN_cond__sliding_local_dilated__glu_gated_reglu__prompt_kernel_60:
    s_movk_i32 s86, 30000
SL_adaLN_cond__sliding_local_dilated__glu_gated_reglu__prompt_kernel_274:
    ds_read_b32 v0, v108 offset:1024
    s_waitcnt lgkmcnt(0)
    v_cmp_gt_u32 vcc, 22, v0
    s_cbranch_vccz BACK_adaLN_cond__sliding_local_dilated__glu_gated_reglu__prompt_kernel_61
    s_sub_u32 s86, s86, 1
    s_cmp_lg_u32 s86, 0
    s_cbranch_scc1 SL_adaLN_cond__sliding_local_dilated__glu_gated_reglu__prompt_kernel_274
    s_branch BACK_adaLN_cond__sliding_local_dilated__glu_gated_reglu__prompt_kernel_61
    s_nop 7
    s_nop 7
SLOW_adaLN_cond__sliding_local_dilated__glu_gated_reglu__prompt_kernel_62:
    s_movk_i32 s86, 30000
SL_adaLN_cond__sliding_local_dilated__glu_gated_reglu__prompt_kernel_275:
    ds_read_b32 v0, v108 offset:1024
    s_waitcnt lgkmcnt(0)
    v_cmp_gt_u32 vcc, 23, v0
    s_cbranch_vccz BACK_adaLN_cond__sliding_local_dilated__glu_gated_reglu__prompt_kernel_63
    s_sub_u32 s86, s86, 1
    s_cmp_lg_u32 s86, 0
    s_cbranch_scc1 SL_adaLN_cond__sliding_local_dilated__glu_gated_reglu__prompt_kernel_275
    s_branch BACK_adaLN_cond__sliding_local_dilated__glu_gated_reglu__prompt_kernel_63
    s_nop 7
    s_nop 7
SLOW_adaLN_cond__sliding_local_dilated__glu_gated_reglu__prompt_kernel_64:
    s_movk_i32 s86, 30000
SL_adaLN_cond__sliding_local_dilated__glu_gated_reglu__prompt_kernel_276:
    ds_read_b32 v0, v108 offset:1024
    s_waitcnt lgkmcnt(0)
    v_cmp_gt_u32 vcc, 27, v0
    s_cbranch_vccz BACK_adaLN_cond__sliding_local_dilated__glu_gated_reglu__prompt_kernel_65
    s_sub_u32 s86, s86, 1
    s_cmp_lg_u32 s86, 0
    s_cbranch_scc1 SL_adaLN_cond__sliding_local_dilated__glu_gated_reglu__prompt_kernel_276
    s_branch BACK_adaLN_cond__sliding_local_dilated__glu_gated_reglu__prompt_kernel_65
    s_nop 7
    s_nop 7
SLOW_adaLN_cond__sliding_local_dilated__glu_gated_reglu__prompt_kernel_66:
    s_movk_i32 s86, 30000
SL_adaLN_cond__sliding_local_dilated__glu_gated_reglu__prompt_kernel_277:
    ds_read_b32 v0, v108 offset:1024
    s_waitcnt lgkmcnt(0)
    v_cmp_gt_u32 vcc, 25, v0
    s_cbranch_vccz BACK_adaLN_cond__sliding_local_dilated__glu_gated_reglu__prompt_kernel_67
    s_sub_u32 s86, s86, 1
    s_cmp_lg_u32 s86, 0
    s_cbranch_scc1 SL_adaLN_cond__sliding_local_dilated__glu_gated_reglu__prompt_kernel_277
    s_branch BACK_adaLN_cond__sliding_local_dilated__glu_gated_reglu__prompt_kernel_67
    s_nop 7
    s_nop 7
SLOW_adaLN_cond__sliding_local_dilated__glu_gated_reglu__prompt_kernel_68:
    s_movk_i32 s86, 30000
SL_adaLN_cond__sliding_local_dilated__glu_gated_reglu__prompt_kernel_278:
    ds_read_b32 v0, v108 offset:1024
    s_waitcnt lgkmcnt(0)
    v_cmp_gt_u32 vcc, 26, v0
    s_cbranch_vccz BACK_adaLN_cond__sliding_local_dilated__glu_gated_reglu__prompt_kernel_69
    s_sub_u32 s86, s86, 1
    s_cmp_lg_u32 s86, 0
    s_cbranch_scc1 SL_adaLN_cond__sliding_local_dilated__glu_gated_reglu__prompt_kernel_278
    s_branch BACK_adaLN_cond__sliding_local_dilated__glu_gated_reglu__prompt_kernel_69
    s_nop 7
    s_nop 7
SLOW_adaLN_cond__sliding_local_dilated__glu_gated_reglu__prompt_kernel_70:
    s_movk_i32 s86, 30000
SL_adaLN_cond__sliding_local_dilated__glu_gated_reglu__prompt_kernel_279:
    ds_read_b32 v0, v108 offset:1024
    s_waitcnt lgkmcnt(0)
    v_cmp_gt_u32 vcc, 28, v0
    s_cbranch_vccz BACK_adaLN_cond__sliding_local_dilated__glu_gated_reglu__prompt_kernel_71
    s_sub_u32 s86, s86, 1
    s_cmp_lg_u32 s86, 0
    s_cbranch_scc1 SL_adaLN_cond__sliding_local_dilated__glu_gated_reglu__prompt_kernel_279
    s_branch BACK_adaLN_cond__sliding_local_dilated__glu_gated_reglu__prompt_kernel_71
    s_nop 7
    s_nop 7
SLOW_adaLN_cond__sliding_local_dilated__glu_gated_reglu__prompt_kernel_72:
    s_movk_i32 s86, 30000
SL_adaLN_cond__sliding_local_dilated__glu_gated_reglu__prompt_kernel_280:
    ds_read_b32 v0, v108 offset:1024
    s_waitcnt lgkmcnt(0)
    v_cmp_gt_u32 vcc, 29, v0
    s_cbranch_vccz BACK_adaLN_cond__sliding_local_dilated__glu_gated_reglu__prompt_kernel_73
    s_sub_u32 s86, s86, 1
    s_cmp_lg_u32 s86, 0
    s_cbranch_scc1 SL_adaLN_cond__sliding_local_dilated__glu_gated_reglu__prompt_kernel_280
    s_branch BACK_adaLN_cond__sliding_local_dilated__glu_gated_reglu__prompt_kernel_73
    s_nop 7
    s_nop 7
SLOW_adaLN_cond__sliding_local_dilated__glu_gated_reglu__prompt_kernel_74:
    s_movk_i32 s86, 30000
SL_adaLN_cond__sliding_local_dilated__glu_gated_reglu__prompt_kernel_281:
    ds_read_b32 v0, v108 offset:1024
    s_waitcnt lgkmcnt(0)
    v_cmp_gt_u32 vcc, 30, v0
    s_cbranch_vccz BACK_adaLN_cond__sliding_local_dilated__glu_gated_reglu__prompt_kernel_75
    s_sub_u32 s86, s86, 1
    s_cmp_lg_u32 s86, 0
    s_cbranch_scc1 SL_adaLN_cond__sliding_local_dilated__glu_gated_reglu__prompt_kernel_281
    s_branch BACK_adaLN_cond__sliding_local_dilated__glu_gated_reglu__prompt_kernel_75
    s_nop 7
    s_nop 7
SLOW_adaLN_cond__sliding_local_dilated__glu_gated_reglu__prompt_kernel_76:
    s_movk_i32 s86, 30000
SL_adaLN_cond__sliding_local_dilated__glu_gated_reglu__prompt_kernel_282:
    ds_read_b32 v0, v108 offset:1024
    s_waitcnt lgkmcnt(0)
    v_cmp_gt_u32 vcc, 31, v0
    s_cbranch_vccz BACK_adaLN_cond__sliding_local_dilated__glu_gated_reglu__prompt_kernel_77
    s_sub_u32 s86, s86, 1
    s_cmp_lg_u32 s86, 0
    s_cbranch_scc1 SL_adaLN_cond__sliding_local_dilated__glu_gated_reglu__prompt_kernel_282
    s_branch BACK_adaLN_cond__sliding_local_dilated__glu_gated_reglu__prompt_kernel_77
    s_nop 7
    s_nop 7
SLOW_adaLN_cond__sliding_local_dilated__glu_gated_reglu__prompt_kernel_78:
    s_movk_i32 s86, 30000
SL_adaLN_cond__sliding_local_dilated__glu_gated_reglu__prompt_kernel_283:
    ds_read_b32 v0, v108 offset:1024
    s_waitcnt lgkmcnt(0)
    v_cmp_gt_u32 vcc, 32, v0
    s_cbranch_vccz BACK_adaLN_cond__sliding_local_dilated__glu_gated_reglu__prompt_kernel_79
    s_sub_u32 s86, s86, 1
    s_cmp_lg_u32 s86, 0
    s_cbranch_scc1 SL_adaLN_cond__sliding_local_dilated__glu_gated_reglu__prompt_kernel_283
    s_branch BACK_adaLN_cond__sliding_local_dilated__glu_gated_reglu__prompt_kernel_79
    s_nop 7
    s_nop 7
SLOW_adaLN_cond__sliding_local_dilated__glu_gated_reglu__prompt_kernel_80:
    s_movk_i32 s86, 30000
SL_adaLN_cond__sliding_local_dilated__glu_gated_reglu__prompt_kernel_284:
    ds_read_b32 v0, v108 offset:1024
    s_waitcnt lgkmcnt(0)
    v_cmp_gt_u32 vcc, 33, v0
    s_cbranch_vccz BACK_adaLN_cond__sliding_local_dilated__glu_gated_reglu__prompt_kernel_81
    s_sub_u32 s86, s86, 1
    s_cmp_lg_u32 s86, 0
    s_cbranch_scc1 SL_adaLN_cond__sliding_local_dilated__glu_gated_reglu__prompt_kernel_284
    s_branch BACK_adaLN_cond__sliding_local_dilated__glu_gated_reglu__prompt_kernel_81
    s_nop 7
    s_nop 7
WS_adaLN_cond__sliding_local_dilated__glu_gated_reglu__prompt_kernel_82:
    s_mov_b32 s86, s62
WL_adaLN_cond__sliding_local_dilated__glu_gated_reglu__prompt_kernel_285:
    buffer_load_dword v10, v12, s[68:71], s61 offen sc1
    s_waitcnt vmcnt(0)
    v_cmp_ne_u32 vcc, s77, v10
    s_and_b32 s90, vcc_lo, 0x7f
    s_cbranch_scc0 WB_adaLN_cond__sliding_local_dilated__glu_gated_reglu__prompt_kernel_83
    s_sub_u32 s86, s86, 1
    s_cmp_lg_u32 s86, 0
    s_cbranch_scc1 WL_adaLN_cond__sliding_local_dilated__glu_gated_reglu__prompt_kernel_285
    s_mov_b32 s62, 1
    v_lshlrev_b32 v11, 7, v15
    s_add_u32 s91, s100, 4096
    s_movk_i32 s86, 3000
    s_mov_b64 exec, 0xffff
WL_adaLN_cond__sliding_local_dilated__glu_gated_reglu__prompt_kernel_286:
    buffer_load_dword v10, v11, s[68:71], s91 offen sc1
    s_waitcnt vmcnt(0)
    v_cmp_ne_u32 vcc, s77, v10
    s_and_b32 s90, vcc_lo, 0x7f7f
    s_cbranch_scc0 WD_adaLN_cond__sliding_local_dilated__glu_gated_reglu__prompt_kernel_287
    s_sleep 2
    s_sub_u32 s86, s86, 1
    s_cmp_lg_u32 s86, 0
    s_cbranch_scc1 WL_adaLN_cond__sliding_local_dilated__glu_gated_reglu__prompt_kernel_286
WD_adaLN_cond__sliding_local_dilated__glu_gated_reglu__prompt_kernel_287:
    s_mov_b64 exec, -1
    s_branch WB_adaLN_cond__sliding_local_dilated__glu_gated_reglu__prompt_kernel_83
    s_nop 7
    s_nop 7
WS_adaLN_cond__sliding_local_dilated__glu_gated_reglu__prompt_kernel_84:
    s_mov_b32 s62, 1
    v_lshlrev_b32 v11, 7, v15
    s_add_u32 s91, s100, 2048
    s_movk_i32 s86, 3000
    s_mov_b64 exec, 0xffff
WL_adaLN_cond__sliding_local_dilated__glu_gated_reglu__prompt_kernel_289:
    buffer_load_dword v10, v11, s[68:71], s91 offen sc1
    s_waitcnt vmcnt(0)
    v_cmp_ne_u32 vcc, s77, v10
    s_and_b32 s90, vcc_lo, 0xffff
    s_cbranch_scc0 WD_adaLN_cond__sliding_local_dilated__glu_gated_reglu__prompt_kernel_290
    s_sleep 2
    s_sub_u32 s86, s86, 1
    s_cmp_lg_u32 s86, 0
    s_cbranch_scc1 WL_adaLN_cond__sliding_local_dilated__glu_gated_reglu__prompt_kernel_289
WD_adaLN_cond__sliding_local_dilated__glu_gated_reglu__prompt_kernel_290:
    s_mov_b64 exec, -1
    s_branch WB_adaLN_cond__sliding_local_dilated__glu_gated_reglu__prompt_kernel_85
    s_nop 7
    s_nop 7
WS_adaLN_cond__sliding_local_dilated__glu_gated_reglu__prompt_kernel_90:
    s_mov_b32 s86, s62
WL_adaLN_cond__sliding_local_dilated__glu_gated_reglu__prompt_kernel_291:
    s_sleep 4
    buffer_load_dword v10, v12, s[68:71], s61 offen sc1
    s_waitcnt vmcnt(0)
    v_cmp_ne_u32 vcc, s77, v10
    s_and_b32 s90, vcc_lo, 0x7f
    s_cbranch_scc0 WB_adaLN_cond__sliding_local_dilated__glu_gated_reglu__prompt_kernel_91
    s_sub_u32 s86, s86, 1
    s_cmp_lg_u32 s86, 0
    s_cbranch_scc1 WL_adaLN_cond__sliding_local_dilated__glu_gated_reglu__prompt_kernel_291
    s_mov_b32 s62, 1
    v_lshlrev_b32 v11, 7, v15
    s_add_u32 s91, s100, 4096
    s_movk_i32 s86, 3000
    s_mov_b64 exec, 0xffff
WL_adaLN_cond__sliding_local_dilated__glu_gated_reglu__prompt_kernel_292:
    buffer_load_dword v10, v11, s[68:71], s91 offen sc1
    s_waitcnt vmcnt(0)
    v_cmp_ne_u32 vcc, s77, v10
    s_and_b32 s90, vcc_lo, 0x7f7f
    s_cbranch_scc0 WD_adaLN_cond__sliding_local_dilated__glu_gated_reglu__prompt_kernel_293
    s_sleep 2
    s_sub_u32 s86, s86, 1
    s_cmp_lg_u32 s86, 0
    s_cbranch_scc1 WL_adaLN_cond__sliding_local_dilated__glu_gated_reglu__prompt_kernel_292
WD_adaLN_cond__sliding_local_dilated__glu_gated_reglu__prompt_kernel_293:
    s_mov_b64 exec, -1
    s_branch WB_adaLN_cond__sliding_local_dilated__glu_gated_reglu__prompt_kernel_91
    s_nop 7
    s_nop 7
SLOW_adaLN_cond__sliding_local_dilated__glu_gated_reglu__prompt_kernel_94:
    s_movk_i32 s86, 30000
SL_adaLN_cond__sliding_local_dilated__glu_gated_reglu__prompt_kernel_294:
    ds_read_b32 v0, v108 offset:1024
    s_waitcnt lgkmcnt(0)
    v_cmp_gt_u32 vcc, 34, v0
    s_cbranch_vccz BACK_adaLN_cond__sliding_local_dilated__glu_gated_reglu__prompt_kernel_95
    s_sub_u32 s86, s86, 1
    s_cmp_lg_u32 s86, 0
    s_cbranch_scc1 SL_adaLN_cond__sliding_local_dilated__glu_gated_reglu__prompt_kernel_294
    s_branch BACK_adaLN_cond__sliding_local_dilated__glu_gated_reglu__prompt_kernel_95
    s_nop 7
    s_nop 7
SLOW_adaLN_cond__sliding_local_dilated__glu_gated_reglu__prompt_kernel_96:
    s_movk_i32 s86, 30000
SL_adaLN_cond__sliding_local_dilated__glu_gated_reglu__prompt_kernel_295:
    ds_read_b32 v0, v108 offset:1024
    s_waitcnt lgkmcnt(0)
    v_cmp_gt_u32 vcc, 35, v0
    s_cbranch_vccz BACK_adaLN_cond__sliding_local_dilated__glu_gated_reglu__prompt_kernel_97
    s_sub_u32 s86, s86, 1
    s_cmp_lg_u32 s86, 0
    s_cbranch_scc1 SL_adaLN_cond__sliding_local_dilated__glu_gated_reglu__prompt_kernel_295
    s_branch BACK_adaLN_cond__sliding_local_dilated__glu_gated_reglu__prompt_kernel_97
    s_nop 7
    s_nop 7
WS_adaLN_cond__sliding_local_dilated__glu_gated_reglu__prompt_kernel_98:
    s_mov_b32 s86, s62
WL_adaLN_cond__sliding_local_dilated__glu_gated_reglu__prompt_kernel_296:
    buffer_load_dword v10, v12, s[68:71], s61 offen sc1
    s_waitcnt vmcnt(0)
    v_cmp_ne_u32 vcc, s77, v10
    s_and_b32 s90, vcc_lo, 0x7f00
    s_cbranch_scc0 WB_adaLN_cond__sliding_local_dilated__glu_gated_reglu__prompt_kernel_99
    s_sub_u32 s86, s86, 1
    s_cmp_lg_u32 s86, 0
    s_cbranch_scc1 WL_adaLN_cond__sliding_local_dilated__glu_gated_reglu__prompt_kernel_296
    s_mov_b32 s62, 1
    v_lshlrev_b32 v11, 7, v15
    s_add_u32 s91, s100, 6144
    s_movk_i32 s86, 3000
    s_mov_b64 exec, 0xffff
WL_adaLN_cond__sliding_local_dilated__glu_gated_reglu__prompt_kernel_297:
    buffer_load_dword v10, v11, s[68:71], s91 offen sc1
    s_waitcnt vmcnt(0)
    v_cmp_ne_u32 vcc, s77, v10
    s_and_b32 s90, vcc_lo, 0x7f7f
    s_cbranch_scc0 WD_adaLN_cond__sliding_local_dilated__glu_gated_reglu__prompt_kernel_298
    s_sleep 2
    s_sub_u32 s86, s86, 1
    s_cmp_lg_u32 s86, 0
    s_cbranch_scc1 WL_adaLN_cond__sliding_local_dilated__glu_gated_reglu__prompt_kernel_297
WD_adaLN_cond__sliding_local_dilated__glu_gated_reglu__prompt_kernel_298:
    s_mov_b64 exec, -1
    s_branch WB_adaLN_cond__sliding_local_dilated__glu_gated_reglu__prompt_kernel_99
    s_nop 7
    s_nop 7
SLOW_adaLN_cond__sliding_local_dilated__glu_gated_reglu__prompt_kernel_100:
    s_movk_i32 s86, 30000
SL_adaLN_cond__sliding_local_dilated__glu_gated_reglu__prompt_kernel_299:
    ds_read_b32 v0, v108 offset:1024
    s_waitcnt lgkmcnt(0)
    v_cmp_gt_u32 vcc, 36, v0
    s_cbranch_vccz BACK_adaLN_cond__sliding_local_dilated__glu_gated_reglu__prompt_kernel_101
    s_sub_u32 s86, s86, 1
    s_cmp_lg_u32 s86, 0
    s_cbranch_scc1 SL_adaLN_cond__sliding_local_dilated__glu_gated_reglu__prompt_kernel_299
    s_branch BACK_adaLN_cond__sliding_local_dilated__glu_gated_reglu__prompt_kernel_101
    s_nop 7
    s_nop 7
SLOW_adaLN_cond__sliding_local_dilated__glu_gated_reglu__prompt_kernel_102:
    s_movk_i32 s86, 30000
SL_adaLN_cond__sliding_local_dilated__glu_gated_reglu__prompt_kernel_300:
    ds_read_b32 v0, v108 offset:1024
    s_waitcnt lgkmcnt(0)
    v_cmp_gt_u32 vcc, 37, v0
    s_cbranch_vccz BACK_adaLN_cond__sliding_local_dilated__glu_gated_reglu__prompt_kernel_103
    s_sub_u32 s86, s86, 1
    s_cmp_lg_u32 s86, 0
    s_cbranch_scc1 SL_adaLN_cond__sliding_local_dilated__glu_gated_reglu__prompt_kernel_300
    s_branch BACK_adaLN_cond__sliding_local_dilated__glu_gated_reglu__prompt_kernel_103
    s_nop 7
    s_nop 7
SLOW_adaLN_cond__sliding_local_dilated__glu_gated_reglu__prompt_kernel_104:
    s_movk_i32 s86, 30000
SL_adaLN_cond__sliding_local_dilated__glu_gated_reglu__prompt_kernel_301:
    ds_read_b32 v0, v108 offset:1024
    s_waitcnt lgkmcnt(0)
    v_cmp_gt_u32 vcc, 38, v0
    s_cbranch_vccz BACK_adaLN_cond__sliding_local_dilated__glu_gated_reglu__prompt_kernel_105
    s_sub_u32 s86, s86, 1
    s_cmp_lg_u32 s86, 0
    s_cbranch_scc1 SL_adaLN_cond__sliding_local_dilated__glu_gated_reglu__prompt_kernel_301
    s_branch BACK_adaLN_cond__sliding_local_dilated__glu_gated_reglu__prompt_kernel_105
    s_nop 7
    s_nop 7
SLOW_adaLN_cond__sliding_local_dilated__glu_gated_reglu__prompt_kernel_106:
    s_movk_i32 s86, 30000
SL_adaLN_cond__sliding_local_dilated__glu_gated_reglu__prompt_kernel_302:
    ds_read_b32 v0, v108 offset:1024
    s_waitcnt lgkmcnt(0)
    v_cmp_gt_u32 vcc, 39, v0
    s_cbranch_vccz BACK_adaLN_cond__sliding_local_dilated__glu_gated_reglu__prompt_kernel_107
    s_sub_u32 s86, s86, 1
    s_cmp_lg_u32 s86, 0
    s_cbranch_scc1 SL_adaLN_cond__sliding_local_dilated__glu_gated_reglu__prompt_kernel_302
    s_branch BACK_adaLN_cond__sliding_local_dilated__glu_gated_reglu__prompt_kernel_107
    s_nop 7
    s_nop 7
WS_adaLN_cond__sliding_local_dilated__glu_gated_reglu__prompt_kernel_108:
    s_mov_b32 s86, s62
WL_adaLN_cond__sliding_local_dilated__glu_gated_reglu__prompt_kernel_303:
    buffer_load_dword v10, v12, s[68:71], s61 offen sc1
    s_waitcnt vmcnt(0)
    v_cmp_ne_u32 vcc, s77, v10
    s_and_b32 s90, vcc_lo, 0x7f0000
    s_cbranch_scc0 WB_adaLN_cond__sliding_local_dilated__glu_gated_reglu__prompt_kernel_109
    s_sub_u32 s86, s86, 1
    s_cmp_lg_u32 s86, 0
    s_cbranch_scc1 WL_adaLN_cond__sliding_local_dilated__glu_gated_reglu__prompt_kernel_303
    s_mov_b32 s62, 1
    v_lshlrev_b32 v11, 7, v15
    s_add_u32 s91, s100, 8192
    s_movk_i32 s86, 3000
    s_mov_b64 exec, 0xffff
WL_adaLN_cond__sliding_local_dilated__glu_gated_reglu__prompt_kernel_304:
    buffer_load_dword v10, v11, s[68:71], s91 offen sc1
    s_waitcnt vmcnt(0)
    v_cmp_ne_u32 vcc, s77, v10
    s_and_b32 s90, vcc_lo, 0x7f7f
    s_cbranch_scc0 WD_adaLN_cond__sliding_local_dilated__glu_gated_reglu__prompt_kernel_305
    s_sleep 2
    s_sub_u32 s86, s86, 1
    s_cmp_lg_u32 s86, 0
    s_cbranch_scc1 WL_adaLN_cond__sliding_local_dilated__glu_gated_reglu__prompt_kernel_304
WD_adaLN_cond__sliding_local_dilated__glu_gated_reglu__prompt_kernel_305:
    s_mov_b64 exec, -1
    s_branch WB_adaLN_cond__sliding_local_dilated__glu_gated_reglu__prompt_kernel_109
    s_nop 7
    s_nop 7
SLOW_adaLN_cond__sliding_local_dilated__glu_gated_reglu__prompt_kernel_110:
    s_movk_i32 s86, 30000
SL_adaLN_cond__sliding_local_dilated__glu_gated_reglu__prompt_kernel_306:
    ds_read_b32 v0, v108 offset:1024
    s_waitcnt lgkmcnt(0)
    v_cmp_gt_u32 vcc, 40, v0
    s_cbranch_vccz BACK_adaLN_cond__sliding_local_dilated__glu_gated_reglu__prompt_kernel_111
    s_sub_u32 s86, s86, 1
    s_cmp_lg_u32 s86, 0
    s_cbranch_scc1 SL_adaLN_cond__sliding_local_dilated__glu_gated_reglu__prompt_kernel_306
    s_branch BACK_adaLN_cond__sliding_local_dilated__glu_gated_reglu__prompt_kernel_111
    s_nop 7
    s_nop 7
SLOW_adaLN_cond__sliding_local_dilated__glu_gated_reglu__prompt_kernel_112:
    s_movk_i32 s86, 30000
SL_adaLN_cond__sliding_local_dilated__glu_gated_reglu__prompt_kernel_307:
    ds_read_b32 v0, v108 offset:1024
    s_waitcnt lgkmcnt(0)
    v_cmp_gt_u32 vcc, 41, v0
    s_cbranch_vccz BACK_adaLN_cond__sliding_local_dilated__glu_gated_reglu__prompt_kernel_113
    s_sub_u32 s86, s86, 1
    s_cmp_lg_u32 s86, 0
    s_cbranch_scc1 SL_adaLN_cond__sliding_local_dilated__glu_gated_reglu__prompt_kernel_307
    s_branch BACK_adaLN_cond__sliding_local_dilated__glu_gated_reglu__prompt_kernel_113
    s_nop 7
    s_nop 7
SLOW_adaLN_cond__sliding_local_dilated__glu_gated_reglu__prompt_kernel_114:
    s_movk_i32 s86, 30000
SL_adaLN_cond__sliding_local_dilated__glu_gated_reglu__prompt_kernel_308:
    ds_read_b32 v0, v108 offset:1024
    s_waitcnt lgkmcnt(0)
    v_cmp_gt_u32 vcc, 42, v0
    s_cbranch_vccz BACK_adaLN_cond__sliding_local_dilated__glu_gated_reglu__prompt_kernel_115
    s_sub_u32 s86, s86, 1
    s_cmp_lg_u32 s86, 0
    s_cbranch_scc1 SL_adaLN_cond__sliding_local_dilated__glu_gated_reglu__prompt_kernel_308
    s_branch BACK_adaLN_cond__sliding_local_dilated__glu_gated_reglu__prompt_kernel_115
    s_nop 7
    s_nop 7
SLOW_adaLN_cond__sliding_local_dilated__glu_gated_reglu__prompt_kernel_116:
    s_movk_i32 s86, 30000
SL_adaLN_cond__sliding_local_dilated__glu_gated_reglu__prompt_kernel_309:
    ds_read_b32 v0, v108 offset:1024
    s_waitcnt lgkmcnt(0)
    v_cmp_gt_u32 vcc, 43, v0
    s_cbranch_vccz BACK_adaLN_cond__sliding_local_dilated__glu_gated_reglu__prompt_kernel_117
    s_sub_u32 s86, s86, 1
    s_cmp_lg_u32 s86, 0
    s_cbranch_scc1 SL_adaLN_cond__sliding_local_dilated__glu_gated_reglu__prompt_kernel_309
    s_branch BACK_adaLN_cond__sliding_local_dilated__glu_gated_reglu__prompt_kernel_117
    s_nop 7
    s_nop 7
SLOW_adaLN_cond__sliding_local_dilated__glu_gated_reglu__prompt_kernel_118:
    s_movk_i32 s86, 30000
SL_adaLN_cond__sliding_local_dilated__glu_gated_reglu__prompt_kernel_310:
    ds_read_b32 v0, v108 offset:1024
    s_waitcnt lgkmcnt(0)
    v_cmp_gt_u32 vcc, 44, v0
    s_cbranch_vccz BACK_adaLN_cond__sliding_local_dilated__glu_gated_reglu__prompt_kernel_119
    s_sub_u32 s86, s86, 1
    s_cmp_lg_u32 s86, 0
    s_cbranch_scc1 SL_adaLN_cond__sliding_local_dilated__glu_gated_reglu__prompt_kernel_310
    s_branch BACK_adaLN_cond__sliding_local_dilated__glu_gated_reglu__prompt_kernel_119
    s_nop 7
    s_nop 7
SLOW_adaLN_cond__sliding_local_dilated__glu_gated_reglu__prompt_kernel_120:
    s_movk_i32 s86, 30000
SL_adaLN_cond__sliding_local_dilated__glu_gated_reglu__prompt_kernel_311:
    ds_read_b32 v0, v108 offset:1024
    s_waitcnt lgkmcnt(0)
    v_cmp_gt_u32 vcc, 45, v0
    s_cbranch_vccz BACK_adaLN_cond__sliding_local_dilated__glu_gated_reglu__prompt_kernel_121
    s_sub_u32 s86, s86, 1
    s_cmp_lg_u32 s86, 0
    s_cbranch_scc1 SL_adaLN_cond__sliding_local_dilated__glu_gated_reglu__prompt_kernel_311
    s_branch BACK_adaLN_cond__sliding_local_dilated__glu_gated_reglu__prompt_kernel_121
    s_nop 7
    s_nop 7
SLOW_adaLN_cond__sliding_local_dilated__glu_gated_reglu__prompt_kernel_122:
    s_movk_i32 s86, 30000
SL_adaLN_cond__sliding_local_dilated__glu_gated_reglu__prompt_kernel_312:
    ds_read_b32 v0, v108 offset:1024
    s_waitcnt lgkmcnt(0)
    v_cmp_gt_u32 vcc, 46, v0
    s_cbranch_vccz BACK_adaLN_cond__sliding_local_dilated__glu_gated_reglu__prompt_kernel_123
    s_sub_u32 s86, s86, 1
    s_cmp_lg_u32 s86, 0
    s_cbranch_scc1 SL_adaLN_cond__sliding_local_dilated__glu_gated_reglu__prompt_kernel_312
    s_branch BACK_adaLN_cond__sliding_local_dilated__glu_gated_reglu__prompt_kernel_123
    s_nop 7
    s_nop 7
SLOW_adaLN_cond__sliding_local_dilated__glu_gated_reglu__prompt_kernel_124:
    s_movk_i32 s86, 30000
SL_adaLN_cond__sliding_local_dilated__glu_gated_reglu__prompt_kernel_313:
    ds_read_b32 v0, v108 offset:1024
    s_waitcnt lgkmcnt(0)
    v_cmp_gt_u32 vcc, 47, v0
    s_cbranch_vccz BACK_adaLN_cond__sliding_local_dilated__glu_gated_reglu__prompt_kernel_125
    s_sub_u32 s86, s86, 1
    s_cmp_lg_u32 s86, 0
    s_cbranch_scc1 SL_adaLN_cond__sliding_local_dilated__glu_gated_reglu__prompt_kernel_313
    s_branch BACK_adaLN_cond__sliding_local_dilated__glu_gated_reglu__prompt_kernel_125
    s_nop 7
    s_nop 7
SLOW_adaLN_cond__sliding_local_dilated__glu_gated_reglu__prompt_kernel_126:
    s_movk_i32 s86, 30000
SL_adaLN_cond__sliding_local_dilated__glu_gated_reglu__prompt_kernel_314:
    ds_read_b32 v0, v111
    s_waitcnt lgkmcnt(0)
    v_cmp_gt_u32 vcc, 53, v0
    s_cbranch_vccz BACK_adaLN_cond__sliding_local_dilated__glu_gated_reglu__prompt_kernel_127
    s_sub_u32 s86, s86, 1
    s_cmp_lg_u32 s86, 0
    s_cbranch_scc1 SL_adaLN_cond__sliding_local_dilated__glu_gated_reglu__prompt_kernel_314
    s_branch BACK_adaLN_cond__sliding_local_dilated__glu_gated_reglu__prompt_kernel_127
    s_endpgm
.section .rodata,"a"
.p2align 6
.amdhsa_kernel adaLN_cond__sliding_local_dilated__glu_gated_reglu__prompt_kernel
  .amdhsa_next_free_vgpr 256
  .amdhsa_next_free_sgpr 102
  .amdhsa_accum_offset 256
  .amdhsa_group_segment_fixed_size 0
  .amdhsa_kernarg_size 96
  .amdhsa_user_sgpr_count 2
  .amdhsa_user_sgpr_kernarg_segment_ptr 1
  .amdhsa_system_sgpr_workgroup_id_x 1
  .amdhsa_float_denorm_mode_32 3
.end_amdhsa_kernel
```
